```python
import torch

def _softmax(x, axis=-1):
    return torch.softmax(x, dim=axis)
def _gelu(x):
    return torch.nn.functional.gelu(x, approximate="tanh")
def _silu(x):
    return torch.nn.functional.silu(x)
def _sigmoid(x):
    return torch.sigmoid(x)
def _layernorm(x, axis=-1, eps=1e-5):
    m = x.mean(dim=axis, keepdim=True)
    v = x.var(dim=axis, keepdim=True, unbiased=False)
    return (x - m) / torch.sqrt(v + eps)
def _scatter_add(tgt, idx, src, axis=0):
    return tgt.clone().index_add_(axis, idx, src)
def _segment_sum(src, seg, n):
    out = torch.zeros((n,) + src.shape[1:], dtype=src.dtype)
    return out.index_add_(0, seg, src)
def _pad(x, pw):
    flat = tuple(v for pair in reversed(pw) for v in pair)
    return torch.nn.functional.pad(x, flat)

kernel_name = 'sequential_preLN__linear_kernel_hedgehog__glu_gated_geglu__prompt'

def setup_inputs():

    _w = (lambda a: (lambda t: t.to(torch.bfloat16) if t.is_floating_point() else t)(torch.as_tensor(a)))
    def _A_setup():
        B, S, D, H = 1, 2048, 640, 32
        Dh = D // H
        return {
            "x": _w((lambda *s: torch.randn(*s, dtype=torch.bfloat16) * 0.05)(B, S, D)),
            "wqkv": _w((lambda *s: torch.randn(*s, dtype=torch.bfloat16) * 0.2)(D, 3 * D)),
            "w_phi": _w((lambda *s: torch.randn(*s, dtype=torch.bfloat16) * 0.2)(H, Dh, Dh) * (Dh ** -0.5)),
            "wo": _w((lambda *s: torch.randn(*s, dtype=torch.bfloat16) * 0.05)(D, D)),
        }
    _A_in = _A_setup()

    def _B_setup():
        B, S, Dm, Df = 1, 2048, 640, 1728
        return {
            "x": _w((lambda *s: torch.randn(*s, dtype=torch.bfloat16) * 0.05)(B, S, Dm)),
            "w_gate": _w((lambda *s: torch.randn(*s, dtype=torch.bfloat16) * 0.4)(Dm, Df) * (Dm ** -0.5)),
            "w_up": _w((lambda *s: torch.randn(*s, dtype=torch.bfloat16) * 0.4)(Dm, Df) * (Dm ** -0.5)),
            "w_down": _w((lambda *s: torch.randn(*s, dtype=torch.bfloat16) * 0.4)(Df, Dm) * (Df ** -0.5)),
        }
    _B_in = _B_setup()

    return {
        "A_x": _A_in["x"],
        "A_wqkv": _A_in["wqkv"],
        "A_w_phi": _A_in["w_phi"],
        "A_wo": _A_in["wo"],
        "B_x": _B_in["x"],
        "B_w_gate": _B_in["w_gate"],
        "B_w_up": _B_in["w_up"],
        "B_w_down": _B_in["w_down"],
    }

def reference(A_x, A_wqkv, A_w_phi, A_wo, B_x, B_w_gate, B_w_up, B_w_down):
    def _A_ref(x, wqkv, w_phi, wo):
        B, S, D = x.shape
        H = 32; Dh = D // H
        qkv = (lambda x, *d: x.permute(*d))((x @ wqkv).reshape(B, S, 3, H, Dh), 2, 0, 3, 1, 4)
        q, k, v = qkv[0], qkv[1], qkv[2]
        pq = torch.einsum("bhsd,hdf->bhsf", q, w_phi)
        pk = torch.einsum("bhsd,hdf->bhsf", k, w_phi)
        phi_q = torch.concatenate([_softmax(pq, axis=-1), _softmax(-pq, axis=-1)], axis=-1)
        phi_k = torch.concatenate([_softmax(pk, axis=-1), _softmax(-pk, axis=-1)], axis=-1)
        kv = torch.einsum("bhsf,bhsd->bhfd", phi_k, v)
        z  = torch.einsum("bhsf->bhf", phi_k)
        num = torch.einsum("bhqf,bhfd->bhqd", phi_q, kv)
        den = torch.einsum("bhqf,bhf->bhq", phi_q, z)[..., None] + 1e-6
        o = num / den
        return (lambda x, *d: x.permute(*d))(o, 0, 2, 1, 3).reshape(B, S, D) @ wo

    def _B_ref(x, w_gate, w_up, w_down):
        g = torch.einsum("bsd,df->bsf", x, w_gate)
        u = torch.einsum("bsd,df->bsf", x, w_up)
        h = _gelu(g) * u
        return torch.einsum("bsf,fd->bsd", h, w_down)

    x = A_x
    h = x + _A_ref(_layernorm(x, axis=-1), A_wqkv, A_w_phi, A_wo)
    h2 = h + _B_ref(_layernorm(h, axis=-1), B_w_gate, B_w_up, B_w_down)
    return h2
```

```asm
; @launch grid=(256,1,1) block=(512,1,1) lds=160064
.amdgcn_target "amdgcn-amd-amdhsa--gfx950"
.text
.p2align 8
code_begin:
.globl sequential_preLN__linear_kernel_hedgehog__glu_gated_geglu__prompt_kernel
.p2align 8
.type sequential_preLN__linear_kernel_hedgehog__glu_gated_geglu__prompt_kernel,@function
sequential_preLN__linear_kernel_hedgehog__glu_gated_geglu__prompt_kernel:
    s_cmp_ge_u32 s2, 256
    s_cbranch_scc1 end_1
    s_load_dwordx4 s[8:11], s[0:1], 0
    s_load_dwordx4 s[12:15], s[0:1], 16
    s_load_dwordx4 s[16:19], s[0:1], 40
    s_load_dwordx2 s[4:5], s[0:1], 80
    s_load_dwordx2 s[26:27], s[0:1], 56
    s_load_dwordx2 s[28:29], s[0:1], 64
    v_lshrrev_b32 v1, 6, v0
    v_and_b32 v0, 63, v0
    s_and_b32 s20, s2, 7
    s_lshr_b32 s21, s2, 3
    s_and_b32 s23, s21, 3
    s_lshl_b32 s30, s20, 2
    s_add_u32 s30, s30, s23
    s_lshr_b32 s31, s21, 2
    s_mul_i32 s32, s23, 3
    s_add_u32 s32, s32, s31
    s_cmp_ge_u32 s32, 10
    s_cselect_b32 s24, 10, 0
    s_sub_u32 s32, s32, s24
    v_readfirstlane_b32 s35, v1
    s_nop 0
    s_cmp_lt_u32 s35, 4
    s_cbranch_scc1 comp_2
    s_sub_u32 s35, s35, 4
    v_lshrrev_b32 v1, 3, v0
    v_and_b32 v2, 7, v0
    v_lshrrev_b32 v3, 4, v0
    s_lshl_b32 s36, s30, 6
    s_lshl_b32 s37, s35, 4
    s_add_u32 s36, s36, s37
    v_add_u32 v20, s36, v1
    v_mul_u32_u24 v20, 1280, v20
    v_xor_b32 v21, v2, v3
    v_lshl_add_u32 v4, v21, 4, v20
    v_xor_b32 v21, 4, v21
    v_lshl_add_u32 v5, v21, 4, v20
    v_add_u32 v5, 10240, v5
    s_lshl_b32 s64, s35, 11
    s_mov_b32 s66, s32
    s_waitcnt lgkmcnt(0)
    s_mov_b32 s40, s8
    s_mov_b32 s41, s9
    s_mov_b32 s42, 2621440
    s_mov_b32 s43, 0x20000
    s_lshl_b32 s67, s66, 7
    s_add_u32 m0, s64, 61440
    s_nop 0
    buffer_load_dwordx4 v4, s[40:43], s67 offen lds
    s_add_u32 m0, s64, 62464
    s_nop 0
    buffer_load_dwordx4 v5, s[40:43], s67 offen lds
    s_add_u32 s66, s66, 1
    s_cmp_eq_u32 s66, 10
    s_cselect_b32 s66, 0, s66
    s_lshl_b32 s67, s66, 7
    s_add_u32 m0, s64, 69632
    s_nop 0
    buffer_load_dwordx4 v4, s[40:43], s67 offen lds
    s_add_u32 m0, s64, 70656
    s_nop 0
    buffer_load_dwordx4 v5, s[40:43], s67 offen lds
    s_add_u32 s66, s66, 1
    s_cmp_eq_u32 s66, 10
    s_cselect_b32 s66, 0, s66
    s_lshl_b32 s67, s66, 7
    s_add_u32 m0, s64, 77824
    s_nop 0
    buffer_load_dwordx4 v4, s[40:43], s67 offen lds
    s_add_u32 m0, s64, 78848
    s_nop 0
    buffer_load_dwordx4 v5, s[40:43], s67 offen lds
    s_add_u32 s66, s66, 1
    s_cmp_eq_u32 s66, 10
    s_cselect_b32 s66, 0, s66
    s_lshl_b32 s67, s66, 7
    s_add_u32 m0, s64, 86016
    s_nop 0
    buffer_load_dwordx4 v4, s[40:43], s67 offen lds
    s_add_u32 m0, s64, 87040
    s_nop 0
    buffer_load_dwordx4 v5, s[40:43], s67 offen lds
    s_add_u32 s66, s66, 1
    s_cmp_eq_u32 s66, 10
    s_cselect_b32 s66, 0, s66
    s_lshl_b32 s67, s66, 7
    s_add_u32 m0, s64, 94208
    s_nop 0
    buffer_load_dwordx4 v4, s[40:43], s67 offen lds
    s_add_u32 m0, s64, 95232
    s_nop 0
    buffer_load_dwordx4 v5, s[40:43], s67 offen lds
    s_add_u32 s66, s66, 1
    s_cmp_eq_u32 s66, 10
    s_cselect_b32 s66, 0, s66
    s_lshl_b32 s67, s66, 7
    s_add_u32 m0, s64, 102400
    s_nop 0
    buffer_load_dwordx4 v4, s[40:43], s67 offen lds
    s_add_u32 m0, s64, 103424
    s_nop 0
    buffer_load_dwordx4 v5, s[40:43], s67 offen lds
    s_add_u32 s66, s66, 1
    s_cmp_eq_u32 s66, 10
    s_cselect_b32 s66, 0, s66
    s_lshl_b32 s67, s66, 7
    s_add_u32 m0, s64, 110592
    s_nop 0
    buffer_load_dwordx4 v4, s[40:43], s67 offen lds
    s_add_u32 m0, s64, 111616
    s_nop 0
    buffer_load_dwordx4 v5, s[40:43], s67 offen lds
    s_add_u32 s66, s66, 1
    s_cmp_eq_u32 s66, 10
    s_cselect_b32 s66, 0, s66
    s_lshl_b32 s67, s66, 7
    s_add_u32 m0, s64, 118784
    s_nop 0
    buffer_load_dwordx4 v4, s[40:43], s67 offen lds
    s_add_u32 m0, s64, 119808
    s_nop 0
    buffer_load_dwordx4 v5, s[40:43], s67 offen lds
    s_add_u32 s66, s66, 1
    s_cmp_eq_u32 s66, 10
    s_cselect_b32 s66, 0, s66
    s_lshl_b32 s67, s66, 7
    s_add_u32 m0, s64, 126976
    s_nop 0
    buffer_load_dwordx4 v4, s[40:43], s67 offen lds
    s_add_u32 m0, s64, 128000
    s_nop 0
    buffer_load_dwordx4 v5, s[40:43], s67 offen lds
    s_add_u32 s66, s66, 1
    s_cmp_eq_u32 s66, 10
    s_cselect_b32 s66, 0, s66
    s_lshl_b32 s67, s66, 7
    s_add_u32 m0, s64, 135168
    s_nop 0
    buffer_load_dwordx4 v4, s[40:43], s67 offen lds
    s_add_u32 m0, s64, 136192
    s_nop 0
    buffer_load_dwordx4 v5, s[40:43], s67 offen lds
    s_add_u32 s66, s66, 1
    s_cmp_eq_u32 s66, 10
    s_cselect_b32 s66, 0, s66
    s_mov_b32 s44, s10
    s_mov_b32 s45, s11
    s_mov_b32 s46, 2457600
    s_mov_b32 s47, 0x20000
    s_add_u32 s56, s4, 15728640
    s_addc_u32 s57, s5, 0
    s_mov_b32 s58, 335872
    s_mov_b32 s59, 0x20000
    v_mov_b32 v19, 0
    buffer_load_dword v16, v19, s[56:59], 0 offen sc1
    v_add_u32 v20, 0, v0
    v_mul_u32_u24 v21, 6554, v20
    v_lshrrev_b32 v21, 16, v21
    v_mul_u32_u24 v22, 10, v21
    v_sub_u32 v22, v20, v22
    v_and_b32 v23, 0x13, v21
    v_bfe_u32 v24, v21, 2, 1
    v_lshl_or_b32 v23, v24, 3, v23
    v_bfe_u32 v24, v21, 3, 1
    v_lshl_or_b32 v23, v24, 2, v23
    v_mul_u32_u24 v23, 3840, v23
    v_lshl_add_u32 v6, v22, 4, v23
    v_add_u32 v20, 64, v0
    v_mul_u32_u24 v21, 6554, v20
    v_lshrrev_b32 v21, 16, v21
    v_mul_u32_u24 v22, 10, v21
    v_sub_u32 v22, v20, v22
    v_and_b32 v23, 0x13, v21
    v_bfe_u32 v24, v21, 2, 1
    v_lshl_or_b32 v23, v24, 3, v23
    v_bfe_u32 v24, v21, 3, 1
    v_lshl_or_b32 v23, v24, 2, v23
    v_mul_u32_u24 v23, 3840, v23
    v_lshl_add_u32 v7, v22, 4, v23
    v_add_u32 v20, 128, v0
    v_mul_u32_u24 v21, 6554, v20
    v_lshrrev_b32 v21, 16, v21
    v_mul_u32_u24 v22, 10, v21
    v_sub_u32 v22, v20, v22
    v_and_b32 v23, 0x13, v21
    v_bfe_u32 v24, v21, 2, 1
    v_lshl_or_b32 v23, v24, 3, v23
    v_bfe_u32 v24, v21, 3, 1
    v_lshl_or_b32 v23, v24, 2, v23
    v_mul_u32_u24 v23, 3840, v23
    v_lshl_add_u32 v8, v22, 4, v23
    v_add_u32 v20, 192, v0
    v_mul_u32_u24 v21, 6554, v20
    v_lshrrev_b32 v21, 16, v21
    v_mul_u32_u24 v22, 10, v21
    v_sub_u32 v22, v20, v22
    v_and_b32 v23, 0x13, v21
    v_bfe_u32 v24, v21, 2, 1
    v_lshl_or_b32 v23, v24, 3, v23
    v_bfe_u32 v24, v21, 3, 1
    v_lshl_or_b32 v23, v24, 2, v23
    v_mul_u32_u24 v23, 3840, v23
    v_lshl_add_u32 v9, v22, 4, v23
    v_add_u32 v20, 256, v0
    v_mul_u32_u24 v21, 6554, v20
    v_lshrrev_b32 v21, 16, v21
    v_mul_u32_u24 v22, 10, v21
    v_sub_u32 v22, v20, v22
    v_and_b32 v23, 0x13, v21
    v_bfe_u32 v24, v21, 2, 1
    v_lshl_or_b32 v23, v24, 3, v23
    v_bfe_u32 v24, v21, 3, 1
    v_lshl_or_b32 v23, v24, 2, v23
    v_mul_u32_u24 v23, 3840, v23
    v_lshl_add_u32 v10, v22, 4, v23
    v_mov_b32 v13, 147456
    v_add_u32 v12, s35, v13
    v_mov_b32 v14, 1
    s_mul_i32 s65, s35, 5120
    s_mul_i32 s69, s31, 160
    s_lshl_b32 s66, s32, 1
    s_add_u32 s66, s66, s35
    s_cmp_ge_u32 s66, 20
    s_cselect_b32 s67, 20, 0
    s_sub_u32 s66, s66, s67
    s_mov_b32 s48, s12
    s_mov_b32 s49, s13
    s_mov_b32 s50, 25600
    s_mov_b32 s51, 0x20000
    s_lshl_b32 s36, s35, 6
    v_add_u32 v20, s36, v0
    v_cmp_gt_u32 vcc, 200, v20
    v_lshlrev_b32 v20, 4, v20
    v_mov_b32 v21, 1073741824
    v_cndmask_b32 v11, v21, v20, vcc
    s_barrier
    s_mul_i32 s67, s66, 122880
    s_add_u32 s67, s67, s69
    s_add_u32 s67, s67, 1280
    s_add_u32 m0, s65, 0
    s_nop 0
    buffer_load_dwordx4 v6, s[44:47], s67 offen lds
    s_add_u32 m0, s65, 1024
    s_nop 0
    buffer_load_dwordx4 v7, s[44:47], s67 offen lds
    s_add_u32 m0, s65, 2048
    s_nop 0
    buffer_load_dwordx4 v8, s[44:47], s67 offen lds
    s_waitcnt vmcnt(3)
    ds_write_b8 v12, v14 offset:60
    s_add_u32 m0, s65, 3072
    s_nop 0
    buffer_load_dwordx4 v9, s[44:47], s67 offen lds
    s_add_u32 m0, s65, 4096
    s_nop 0
    buffer_load_dwordx4 v10, s[44:47], s67 offen lds
    s_add_u32 s66, s66, 4
    s_cmp_ge_u32 s66, 20
    s_cselect_b32 s67, 20, 0
    s_sub_u32 s66, s66, s67
    s_mul_i32 s67, s66, 122880
    s_add_u32 s67, s67, s69
    s_add_u32 s67, s67, 1280
    s_add_u32 m0, s65, 20480
    s_nop 0
    buffer_load_dwordx4 v6, s[44:47], s67 offen lds
    s_add_u32 m0, s65, 21504
    s_nop 0
    buffer_load_dwordx4 v7, s[44:47], s67 offen lds
    s_add_u32 m0, s65, 22528
    s_nop 0
    buffer_load_dwordx4 v8, s[44:47], s67 offen lds
    s_add_u32 m0, s65, 23552
    s_nop 0
    buffer_load_dwordx4 v9, s[44:47], s67 offen lds
    s_add_u32 m0, s65, 24576
    s_nop 0
    buffer_load_dwordx4 v10, s[44:47], s67 offen lds
    s_mul_i32 s37, s31, 3200
    s_lshl_b32 s36, s35, 10
    s_add_u32 m0, s36, 143360
    s_nop 0
    buffer_load_dwordx4 v11, s[48:51], s37 offen lds
    s_add_u32 s66, s66, 4
    s_cmp_ge_u32 s66, 20
    s_cselect_b32 s67, 20, 0
    s_sub_u32 s66, s66, s67
    s_mul_i32 s67, s66, 122880
    s_add_u32 s67, s67, s69
    s_add_u32 s67, s67, 1280
    s_add_u32 m0, s65, 40960
    s_nop 0
    buffer_load_dwordx4 v6, s[44:47], s67 offen lds
    s_waitcnt vmcnt(7)
    ds_write_b8 v12, v14 offset:0
    s_add_u32 m0, s65, 41984
    s_nop 0
    buffer_load_dwordx4 v7, s[44:47], s67 offen lds
    s_add_u32 m0, s65, 43008
    s_nop 0
    buffer_load_dwordx4 v8, s[44:47], s67 offen lds
    s_add_u32 m0, s65, 44032
    s_nop 0
    buffer_load_dwordx4 v9, s[44:47], s67 offen lds
    s_add_u32 m0, s65, 45056
    s_nop 0
    buffer_load_dwordx4 v10, s[44:47], s67 offen lds
    s_add_u32 s66, s66, 4
    s_cmp_ge_u32 s66, 20
    s_cselect_b32 s67, 20, 0
    s_sub_u32 s66, s66, s67
    ds_read_b32 v15, v13 offset:128
    s_waitcnt lgkmcnt(0)
    v_readfirstlane_b32 s70, v15
    s_nop 0
    s_cmp_eq_u32 s70, 16843009
    s_cbranch_scc0 lslow_3
lback_4:
    s_mul_i32 s67, s66, 122880
    s_add_u32 s67, s67, s69
    s_add_u32 s67, s67, 1280
    s_add_u32 m0, s65, 61440
    s_nop 0
    buffer_load_dwordx4 v6, s[44:47], s67 offen lds
    s_add_u32 m0, s65, 62464
    s_nop 0
    buffer_load_dwordx4 v7, s[44:47], s67 offen lds
    s_waitcnt vmcnt(7)
    ds_write_b8 v12, v14 offset:4
    s_add_u32 m0, s65, 63488
    s_nop 0
    buffer_load_dwordx4 v8, s[44:47], s67 offen lds
    s_add_u32 m0, s65, 64512
    s_nop 0
    buffer_load_dwordx4 v9, s[44:47], s67 offen lds
    s_add_u32 m0, s65, 65536
    s_nop 0
    buffer_load_dwordx4 v10, s[44:47], s67 offen lds
    s_add_u32 s66, s66, 4
    s_cmp_ge_u32 s66, 20
    s_cselect_b32 s67, 20, 0
    s_sub_u32 s66, s66, s67
    s_mul_i32 s67, s66, 122880
    s_add_u32 s67, s67, s69
    s_add_u32 s67, s67, 1280
    s_add_u32 m0, s65, 81920
    s_nop 0
    buffer_load_dwordx4 v6, s[44:47], s67 offen lds
    s_add_u32 m0, s65, 82944
    s_nop 0
    buffer_load_dwordx4 v7, s[44:47], s67 offen lds
    s_waitcnt vmcnt(7)
    ds_write_b8 v12, v14 offset:8
    s_add_u32 m0, s65, 83968
    s_nop 0
    buffer_load_dwordx4 v8, s[44:47], s67 offen lds
    s_add_u32 m0, s65, 84992
    s_nop 0
    buffer_load_dwordx4 v9, s[44:47], s67 offen lds
    s_add_u32 m0, s65, 86016
    s_nop 0
    buffer_load_dwordx4 v10, s[44:47], s67 offen lds
    s_add_u32 s66, s66, 4
    s_cmp_ge_u32 s66, 20
    s_cselect_b32 s67, 20, 0
    s_sub_u32 s66, s66, s67
    s_mul_i32 s67, s66, 122880
    s_add_u32 s67, s67, s69
    s_add_u32 s67, s67, 2560
    s_add_u32 m0, s65, 102400
    s_nop 0
    buffer_load_dwordx4 v6, s[44:47], s67 offen lds
    s_add_u32 m0, s65, 103424
    s_nop 0
    buffer_load_dwordx4 v7, s[44:47], s67 offen lds
    s_waitcnt vmcnt(7)
    ds_write_b8 v12, v14 offset:12
    s_add_u32 m0, s65, 104448
    s_nop 0
    buffer_load_dwordx4 v8, s[44:47], s67 offen lds
    s_add_u32 m0, s65, 105472
    s_nop 0
    buffer_load_dwordx4 v9, s[44:47], s67 offen lds
    s_add_u32 m0, s65, 106496
    s_nop 0
    buffer_load_dwordx4 v10, s[44:47], s67 offen lds
    s_add_u32 s66, s66, 4
    s_cmp_ge_u32 s66, 20
    s_cselect_b32 s67, 20, 0
    s_sub_u32 s66, s66, s67
    s_mul_i32 s67, s66, 122880
    s_add_u32 s67, s67, s69
    s_add_u32 s67, s67, 2560
    s_add_u32 m0, s65, 122880
    s_nop 0
    buffer_load_dwordx4 v6, s[44:47], s67 offen lds
    s_add_u32 m0, s65, 123904
    s_nop 0
    buffer_load_dwordx4 v7, s[44:47], s67 offen lds
    s_waitcnt vmcnt(7)
    ds_write_b8 v12, v14 offset:16
    s_add_u32 m0, s65, 124928
    s_nop 0
    buffer_load_dwordx4 v8, s[44:47], s67 offen lds
    s_add_u32 m0, s65, 125952
    s_nop 0
    buffer_load_dwordx4 v9, s[44:47], s67 offen lds
    s_add_u32 m0, s65, 126976
    s_nop 0
    buffer_load_dwordx4 v10, s[44:47], s67 offen lds
    s_add_u32 s66, s66, 4
    s_cmp_ge_u32 s66, 20
    s_cselect_b32 s67, 20, 0
    s_sub_u32 s66, s66, s67
    ds_read_b32 v15, v13 offset:160
    s_waitcnt lgkmcnt(0)
    v_readfirstlane_b32 s70, v15
    s_nop 0
    s_cmp_eq_u32 s70, 16843009
    s_cbranch_scc0 lslow_6
lback_7:
    s_mul_i32 s67, s66, 122880
    s_add_u32 s67, s67, s69
    s_add_u32 s67, s67, 2560
    s_add_u32 m0, s65, 0
    s_nop 0
    buffer_load_dwordx4 v6, s[44:47], s67 offen lds
    s_add_u32 m0, s65, 1024
    s_nop 0
    buffer_load_dwordx4 v7, s[44:47], s67 offen lds
    s_waitcnt vmcnt(7)
    ds_write_b8 v12, v14 offset:20
    s_add_u32 m0, s65, 2048
    s_nop 0
    buffer_load_dwordx4 v8, s[44:47], s67 offen lds
    s_add_u32 m0, s65, 3072
    s_nop 0
    buffer_load_dwordx4 v9, s[44:47], s67 offen lds
    s_add_u32 m0, s65, 4096
    s_nop 0
    buffer_load_dwordx4 v10, s[44:47], s67 offen lds
    s_add_u32 s66, s66, 4
    s_cmp_ge_u32 s66, 20
    s_cselect_b32 s67, 20, 0
    s_sub_u32 s66, s66, s67
    ds_read_b32 v15, v13 offset:164
    s_waitcnt lgkmcnt(0)
    v_readfirstlane_b32 s70, v15
    s_nop 0
    s_cmp_eq_u32 s70, 16843009
    s_cbranch_scc0 lslow_9
lback_10:
    s_mul_i32 s67, s66, 122880
    s_add_u32 s67, s67, s69
    s_add_u32 s67, s67, 2560
    s_add_u32 m0, s65, 20480
    s_nop 0
    buffer_load_dwordx4 v6, s[44:47], s67 offen lds
    s_add_u32 m0, s65, 21504
    s_nop 0
    buffer_load_dwordx4 v7, s[44:47], s67 offen lds
    s_waitcnt vmcnt(7)
    ds_write_b8 v12, v14 offset:24
    s_add_u32 m0, s65, 22528
    s_nop 0
    buffer_load_dwordx4 v8, s[44:47], s67 offen lds
    s_add_u32 m0, s65, 23552
    s_nop 0
    buffer_load_dwordx4 v9, s[44:47], s67 offen lds
    s_add_u32 m0, s65, 24576
    s_nop 0
    buffer_load_dwordx4 v10, s[44:47], s67 offen lds
    s_add_u32 s66, s66, 4
    s_cmp_ge_u32 s66, 20
    s_cselect_b32 s67, 20, 0
    s_sub_u32 s66, s66, s67
    ds_read_b32 v15, v13 offset:168
    s_waitcnt lgkmcnt(0)
    v_readfirstlane_b32 s70, v15
    s_nop 0
    s_cmp_eq_u32 s70, 16843009
    s_cbranch_scc0 lslow_12
lback_13:
    s_mul_i32 s67, s66, 122880
    s_add_u32 s67, s67, s69
    s_add_u32 s67, s67, 2560
    s_add_u32 m0, s65, 40960
    s_nop 0
    buffer_load_dwordx4 v6, s[44:47], s67 offen lds
    s_add_u32 m0, s65, 41984
    s_nop 0
    buffer_load_dwordx4 v7, s[44:47], s67 offen lds
    s_waitcnt vmcnt(7)
    ds_write_b8 v12, v14 offset:28
    s_add_u32 m0, s65, 43008
    s_nop 0
    buffer_load_dwordx4 v8, s[44:47], s67 offen lds
    s_add_u32 m0, s65, 44032
    s_nop 0
    buffer_load_dwordx4 v9, s[44:47], s67 offen lds
    s_add_u32 m0, s65, 45056
    s_nop 0
    buffer_load_dwordx4 v10, s[44:47], s67 offen lds
    s_add_u32 s66, s66, 4
    s_cmp_ge_u32 s66, 20
    s_cselect_b32 s67, 20, 0
    s_sub_u32 s66, s66, s67
    ds_read_b32 v15, v13 offset:172
    s_waitcnt lgkmcnt(0)
    v_readfirstlane_b32 s70, v15
    s_nop 0
    s_cmp_eq_u32 s70, 16843009
    s_cbranch_scc0 lslow_15
lback_16:
    s_waitcnt vmcnt(5)
    ds_write_b8 v12, v14 offset:32
    s_waitcnt vmcnt(0)
    ds_write_b8 v12, v14 offset:36
    s_lshl_b32 s22, s2, 2
    s_add_u32 s22, s22, s35
    s_mul_i32 s23, s22, 896
    s_mul_i32 s22, s22, 2176
    v_lshlrev_b32 v22, 7, v0
    v_cmp_gt_u32 vcc, 7, v0
    s_nop 1
    v_cndmask_b32 v23, v21, v22, vcc
    v_cmp_gt_u32 vcc, 17, v0
    s_nop 1
    v_cndmask_b32 v22, v21, v22, vcc
    s_mov_b32 s60, s14
    s_mov_b32 s61, s15
    s_mov_b32 s62, 819200
    s_mov_b32 s63, 0x20000
    buffer_load_dword v44, v23, s[60:63], s23 offen
    s_mov_b32 s60, s26
    s_mov_b32 s61, s27
    s_mov_b32 s62, 2211840
    s_mov_b32 s63, 0x20000
    buffer_load_dword v45, v22, s[60:63], s22 offen
    s_mul_i32 s67, s66, 122880
    s_add_u32 s67, s67, s69
    s_add_u32 s67, s67, 0
    s_add_u32 m0, s65, 61440
    s_nop 0
    buffer_load_dwordx4 v6, s[44:47], s67 offen lds
    s_add_u32 m0, s65, 62464
    s_nop 0
    buffer_load_dwordx4 v7, s[44:47], s67 offen lds
    s_add_u32 m0, s65, 63488
    s_nop 0
    buffer_load_dwordx4 v8, s[44:47], s67 offen lds
    s_add_u32 m0, s65, 64512
    s_nop 0
    buffer_load_dwordx4 v9, s[44:47], s67 offen lds
    s_add_u32 m0, s65, 65536
    s_nop 0
    buffer_load_dwordx4 v10, s[44:47], s67 offen lds
    s_add_u32 s66, s66, 4
    s_cmp_ge_u32 s66, 20
    s_cselect_b32 s67, 20, 0
    s_sub_u32 s66, s66, s67
    ds_read_b32 v15, v13 offset:180
    s_waitcnt lgkmcnt(0)
    v_readfirstlane_b32 s70, v15
    s_nop 0
    s_cmp_eq_u32 s70, 16843009
    s_cbranch_scc0 lslow_18
lback_19:
    s_mul_i32 s67, s66, 122880
    s_add_u32 s67, s67, s69
    s_add_u32 s67, s67, 0
    s_add_u32 m0, s65, 102400
    s_nop 0
    buffer_load_dwordx4 v6, s[44:47], s67 offen lds
    s_add_u32 m0, s65, 103424
    s_nop 0
    buffer_load_dwordx4 v7, s[44:47], s67 offen lds
    s_add_u32 m0, s65, 104448
    s_nop 0
    buffer_load_dwordx4 v8, s[44:47], s67 offen lds
    s_add_u32 m0, s65, 105472
    s_nop 0
    buffer_load_dwordx4 v9, s[44:47], s67 offen lds
    s_add_u32 m0, s65, 106496
    s_nop 0
    buffer_load_dwordx4 v10, s[44:47], s67 offen lds
    s_add_u32 s66, s66, 4
    s_cmp_ge_u32 s66, 20
    s_cselect_b32 s67, 20, 0
    s_sub_u32 s66, s66, s67
    ds_read_b32 v15, v13 offset:184
    s_waitcnt lgkmcnt(0)
    v_readfirstlane_b32 s70, v15
    s_nop 0
    s_cmp_eq_u32 s70, 16843009
    s_cbranch_scc0 lslow_21
lback_22:
    s_mul_i32 s67, s66, 122880
    s_add_u32 s67, s67, s69
    s_add_u32 s67, s67, 0
    s_add_u32 m0, s65, 122880
    s_nop 0
    buffer_load_dwordx4 v6, s[44:47], s67 offen lds
    s_add_u32 m0, s65, 123904
    s_nop 0
    buffer_load_dwordx4 v7, s[44:47], s67 offen lds
    s_waitcnt vmcnt(7)
    ds_write_b8 v12, v14 offset:40
    s_add_u32 m0, s65, 124928
    s_nop 0
    buffer_load_dwordx4 v8, s[44:47], s67 offen lds
    s_add_u32 m0, s65, 125952
    s_nop 0
    buffer_load_dwordx4 v9, s[44:47], s67 offen lds
    s_add_u32 m0, s65, 126976
    s_nop 0
    buffer_load_dwordx4 v10, s[44:47], s67 offen lds
    s_add_u32 s66, s66, 4
    s_cmp_ge_u32 s66, 20
    s_cselect_b32 s67, 20, 0
    s_sub_u32 s66, s66, s67
    ds_read_b32 v15, v13 offset:188
    s_waitcnt lgkmcnt(0)
    v_readfirstlane_b32 s70, v15
    s_nop 0
    s_cmp_eq_u32 s70, 16843009
    s_cbranch_scc0 lslow_24
lback_25:
    s_mul_i32 s67, s66, 122880
    s_add_u32 s67, s67, s69
    s_add_u32 s67, s67, 0
    s_add_u32 m0, s65, 0
    s_nop 0
    buffer_load_dwordx4 v6, s[44:47], s67 offen lds
    s_add_u32 m0, s65, 1024
    s_nop 0
    buffer_load_dwordx4 v7, s[44:47], s67 offen lds
    s_waitcnt vmcnt(7)
    ds_write_b8 v12, v14 offset:44
    s_add_u32 m0, s65, 2048
    s_nop 0
    buffer_load_dwordx4 v8, s[44:47], s67 offen lds
    s_add_u32 m0, s65, 3072
    s_nop 0
    buffer_load_dwordx4 v9, s[44:47], s67 offen lds
    s_add_u32 m0, s65, 4096
    s_nop 0
    buffer_load_dwordx4 v10, s[44:47], s67 offen lds
    s_add_u32 s66, s66, 4
    s_cmp_ge_u32 s66, 20
    s_cselect_b32 s67, 20, 0
    s_sub_u32 s66, s66, s67
    ds_read_b32 v15, v13 offset:192
    s_waitcnt lgkmcnt(0)
    v_readfirstlane_b32 s70, v15
    s_nop 0
    s_cmp_eq_u32 s70, 16843009
    s_cbranch_scc0 lslow_27
lback_28:
    s_mul_i32 s67, s66, 122880
    s_add_u32 s67, s67, s69
    s_add_u32 s67, s67, 0
    s_add_u32 m0, s65, 20480
    s_nop 0
    buffer_load_dwordx4 v6, s[44:47], s67 offen lds
    s_add_u32 m0, s65, 21504
    s_nop 0
    buffer_load_dwordx4 v7, s[44:47], s67 offen lds
    s_waitcnt vmcnt(7)
    ds_write_b8 v12, v14 offset:48
    s_add_u32 m0, s65, 22528
    s_nop 0
    buffer_load_dwordx4 v8, s[44:47], s67 offen lds
    s_add_u32 m0, s65, 23552
    s_nop 0
    buffer_load_dwordx4 v9, s[44:47], s67 offen lds
    s_add_u32 m0, s65, 24576
    s_nop 0
    buffer_load_dwordx4 v10, s[44:47], s67 offen lds
    s_add_u32 s66, s66, 4
    s_cmp_ge_u32 s66, 20
    s_cselect_b32 s67, 20, 0
    s_sub_u32 s66, s66, s67
    s_waitcnt vmcnt(5)
    ds_write_b8 v12, v14 offset:52
    s_waitcnt vmcnt(0)
    ds_write_b8 v12, v14 offset:56
    v_add_u32 v16, 1, v16
    s_nop 0
    v_readfirstlane_b32 s33, v16
    s_sub_u32 s36, s35, 1
    s_cmp_lt_u32 s36, 2
    s_cbranch_scc1 cs_30
    s_add_u32 s52, s4, 3145728
    s_addc_u32 s53, s5, 0
    s_mov_b32 s54, 2359296
    s_mov_b32 s55, 0x20000
    s_add_u32 s60, s4, 5767168
    s_addc_u32 s61, s5, 0
    s_mov_b32 s62, 73728
    s_mov_b32 s63, 0x20000
    s_cmp_eq_u32 s35, 0
    s_cselect_b32 s36, 0, 32
    s_add_u32 s36, s36, s30
    s_cmp_ge_u32 s36, 35
    s_cbranch_scc1 tch_32
    s_mov_b32 s72, s33
    s_setprio 3
    s_lshl_b32 s37, s31, 5
    s_mul_i32 s37, s37, 9216
    s_lshl_b32 s38, s36, 8
    s_add_u32 s37, s37, s38
    v_and_b32 v20, 15, v0
    v_lshlrev_b32 v20, 4, v20
    v_mul_u32_u24 v22, 9216, v3
    v_add_u32 v22, v22, v20
    v_mov_b32 v4, 0x00003f80
    v_mov_b32 v5, 0x3f800000
ps_34:
    ds_read_b32 v15, v13 offset:136
    s_waitcnt lgkmcnt(0)
    v_readfirstlane_b32 s70, v15
    s_nop 0
    s_cmp_eq_u32 s70, 16843009
    s_cbranch_scc1 gs_35
    s_sleep 1
    s_branch ps_34
gs_35:
    v_add_u32 v101, 36864, v22
    v_add_u32 v102, 73728, v22
    v_add_u32 v103, 110592, v22
    v_add_u32 v104, 147456, v22
    v_add_u32 v105, 184320, v22
    v_add_u32 v106, 221184, v22
    v_add_u32 v107, 258048, v22
    s_mov_b64 s[40:41], -1
    s_mov_b64 s[42:43], -1
    s_mov_b64 s[44:45], -1
    s_mov_b64 s[46:47], -1
    s_mov_b64 s[48:49], -1
    s_mov_b64 s[50:51], -1
    s_mov_b64 s[64:65], -1
    s_mov_b64 s[66:67], -1
    s_mov_b32 s71, 100000
p1_36:
    s_mov_b64 exec, s[40:41]
    buffer_load_dwordx4 v[32:35], v22, s[52:55], s37 offen sc1
    s_mov_b64 exec, s[42:43]
    buffer_load_dwordx4 v[36:39], v101, s[52:55], s37 offen sc1
    s_mov_b64 exec, s[44:45]
    buffer_load_dwordx4 v[40:43], v102, s[52:55], s37 offen sc1
    s_mov_b64 exec, s[46:47]
    buffer_load_dwordx4 v[44:47], v103, s[52:55], s37 offen sc1
    s_mov_b64 exec, s[48:49]
    buffer_load_dwordx4 v[48:51], v104, s[52:55], s37 offen sc1
    s_mov_b64 exec, s[50:51]
    buffer_load_dwordx4 v[52:55], v105, s[52:55], s37 offen sc1
    s_mov_b64 exec, s[64:65]
    buffer_load_dwordx4 v[56:59], v106, s[52:55], s37 offen sc1
    s_mov_b64 exec, s[66:67]
    buffer_load_dwordx4 v[60:63], v107, s[52:55], s37 offen sc1
    s_mov_b64 exec, -1
    s_mov_b64 s[74:75], 0
    s_waitcnt vmcnt(7)
    v_cmp_ne_u32 s[40:41], s72, v35
    s_nop 0
    s_or_b64 s[74:75], s[74:75], s[40:41]
    s_waitcnt vmcnt(6)
    v_cmp_ne_u32 s[42:43], s72, v39
    s_nop 0
    s_or_b64 s[74:75], s[74:75], s[42:43]
    s_waitcnt vmcnt(5)
    v_cmp_ne_u32 s[44:45], s72, v43
    s_nop 0
    s_or_b64 s[74:75], s[74:75], s[44:45]
    s_waitcnt vmcnt(4)
    v_cmp_ne_u32 s[46:47], s72, v47
    s_nop 0
    s_or_b64 s[74:75], s[74:75], s[46:47]
    s_waitcnt vmcnt(3)
    v_cmp_ne_u32 s[48:49], s72, v51
    s_nop 0
    s_or_b64 s[74:75], s[74:75], s[48:49]
    s_waitcnt vmcnt(2)
    v_cmp_ne_u32 s[50:51], s72, v55
    s_nop 0
    s_or_b64 s[74:75], s[74:75], s[50:51]
    s_waitcnt vmcnt(1)
    v_cmp_ne_u32 s[64:65], s72, v59
    s_nop 0
    s_or_b64 s[74:75], s[74:75], s[64:65]
    s_waitcnt vmcnt(0)
    v_cmp_ne_u32 s[66:67], s72, v63
    s_nop 0
    s_or_b64 s[74:75], s[74:75], s[66:67]
    s_cbranch_scc0 d1_37
    s_sleep 1
    s_sub_u32 s71, s71, 1
    s_cmp_lg_u32 s71, 0
    s_cbranch_scc1 p1_36
d1_37:
    v_lshlrev_b32 v64, 16, v32
    v_and_b32 v65, 0xffff0000, v32
    v_lshlrev_b32 v66, 16, v33
    v_and_b32 v67, 0xffff0000, v33
    v_lshlrev_b32 v68, 16, v34
    v_and_b32 v69, 0xffff0000, v34
    v_dot2c_f32_bf16 v64, v36, v4
    v_dot2c_f32_bf16 v65, v36, v5
    v_dot2c_f32_bf16 v66, v37, v4
    v_dot2c_f32_bf16 v67, v37, v5
    v_dot2c_f32_bf16 v68, v38, v4
    v_dot2c_f32_bf16 v69, v38, v5
    v_dot2c_f32_bf16 v64, v40, v4
    v_dot2c_f32_bf16 v65, v40, v5
    v_dot2c_f32_bf16 v66, v41, v4
    v_dot2c_f32_bf16 v67, v41, v5
    v_dot2c_f32_bf16 v68, v42, v4
    v_dot2c_f32_bf16 v69, v42, v5
    v_dot2c_f32_bf16 v64, v44, v4
    v_dot2c_f32_bf16 v65, v44, v5
    v_dot2c_f32_bf16 v66, v45, v4
    v_dot2c_f32_bf16 v67, v45, v5
    v_dot2c_f32_bf16 v68, v46, v4
    v_dot2c_f32_bf16 v69, v46, v5
    v_dot2c_f32_bf16 v64, v48, v4
    v_dot2c_f32_bf16 v65, v48, v5
    v_dot2c_f32_bf16 v66, v49, v4
    v_dot2c_f32_bf16 v67, v49, v5
    v_dot2c_f32_bf16 v68, v50, v4
    v_dot2c_f32_bf16 v69, v50, v5
    v_dot2c_f32_bf16 v64, v52, v4
    v_dot2c_f32_bf16 v65, v52, v5
    v_dot2c_f32_bf16 v66, v53, v4
    v_dot2c_f32_bf16 v67, v53, v5
    v_dot2c_f32_bf16 v68, v54, v4
    v_dot2c_f32_bf16 v69, v54, v5
    v_dot2c_f32_bf16 v64, v56, v4
    v_dot2c_f32_bf16 v65, v56, v5
    v_dot2c_f32_bf16 v66, v57, v4
    v_dot2c_f32_bf16 v67, v57, v5
    v_dot2c_f32_bf16 v68, v58, v4
    v_dot2c_f32_bf16 v69, v58, v5
    v_dot2c_f32_bf16 v64, v60, v4
    v_dot2c_f32_bf16 v65, v60, v5
    v_dot2c_f32_bf16 v66, v61, v4
    v_dot2c_f32_bf16 v67, v61, v5
    v_dot2c_f32_bf16 v68, v62, v4
    v_dot2c_f32_bf16 v69, v62, v5
    v_permlane32_swap_b32 v64, v72
    v_permlane32_swap_b32 v65, v73
    v_permlane32_swap_b32 v66, v74
    v_permlane32_swap_b32 v67, v75
    v_permlane32_swap_b32 v68, v76
    v_permlane32_swap_b32 v69, v77
    v_pk_add_f32 v[64:65], v[64:65], v[72:73]
    v_pk_add_f32 v[66:67], v[66:67], v[74:75]
    v_pk_add_f32 v[68:69], v[68:69], v[76:77]
    v_permlane16_swap_b32 v64, v72
    v_permlane16_swap_b32 v65, v73
    v_permlane16_swap_b32 v66, v74
    v_permlane16_swap_b32 v67, v75
    v_permlane16_swap_b32 v68, v76
    v_permlane16_swap_b32 v69, v77
    v_pk_add_f32 v[64:65], v[64:65], v[72:73]
    v_pk_add_f32 v[66:67], v[66:67], v[74:75]
    v_pk_add_f32 v[68:69], v[68:69], v[76:77]
    v_cvt_pk_bf16_f32 v28, v64, v65
    v_cvt_pk_bf16_f32 v29, v66, v67
    v_cvt_pk_bf16_f32 v30, v68, v69
    v_mov_b32 v31, s72
    s_mul_i32 s37, s31, 9216
    s_lshl_b32 s38, s36, 8
    s_add_u32 s38, s38, s37
    s_mov_b64 exec, 0xffff
    buffer_store_dwordx4 v[28:31], v20, s[60:63], s38 offen sc1
    s_mov_b64 exec, -1
    s_cmp_eq_u32 s35, 0
    s_cbranch_scc1 h2_33
tch_32:
    s_branch ldone_31
h2_33:
    v_lshlrev_b32 v20, 4, v0
    v_mul_u32_u24 v22, 12, v0
    v_add_u32 v22, 147712, v22
    v_add_u32 v23, 8192, v20
    v_cmp_gt_u32 vcc, 48, v0
    s_nop 1
    v_cndmask_b32 v23, v20, v23, vcc
    s_waitcnt vmcnt(0)
    s_add_u32 s38, s37, 4096
    s_mov_b64 s[40:41], -1
    s_mov_b64 s[42:43], -1
    s_mov_b64 s[44:45], -1
    s_mov_b64 s[46:47], -1
    s_mov_b64 s[48:49], -1
    s_mov_b64 s[50:51], -1
    s_mov_b64 s[64:65], -1
    s_mov_b64 s[66:67], -1
    s_mov_b64 s[68:69], -1
    s_mov_b32 s71, 100000
p2_38:
    s_mov_b64 exec, s[40:41]
    buffer_load_dwordx4 v[32:35], v20, s[60:63], s37 offen offset:0 sc1
    s_mov_b64 exec, s[42:43]
    buffer_load_dwordx4 v[36:39], v20, s[60:63], s37 offen offset:1024 sc1
    s_mov_b64 exec, s[44:45]
    buffer_load_dwordx4 v[40:43], v20, s[60:63], s37 offen offset:2048 sc1
    s_mov_b64 exec, s[46:47]
    buffer_load_dwordx4 v[44:47], v20, s[60:63], s37 offen offset:3072 sc1
    s_mov_b64 exec, s[48:49]
    buffer_load_dwordx4 v[48:51], v20, s[60:63], s38 offen offset:0 sc1
    s_mov_b64 exec, s[50:51]
    buffer_load_dwordx4 v[52:55], v20, s[60:63], s38 offen offset:1024 sc1
    s_mov_b64 exec, s[64:65]
    buffer_load_dwordx4 v[56:59], v20, s[60:63], s38 offen offset:2048 sc1
    s_mov_b64 exec, s[66:67]
    buffer_load_dwordx4 v[60:63], v20, s[60:63], s38 offen offset:3072 sc1
    s_mov_b64 exec, s[68:69]
    buffer_load_dwordx4 v[64:67], v23, s[60:63], s37 offen sc1
    s_mov_b64 exec, -1
    s_mov_b64 s[74:75], 0
    s_waitcnt vmcnt(8)
    v_cmp_ne_u32 s[40:41], s72, v35
    s_nop 0
    s_or_b64 s[74:75], s[74:75], s[40:41]
    s_waitcnt vmcnt(7)
    v_cmp_ne_u32 s[42:43], s72, v39
    s_nop 0
    s_or_b64 s[74:75], s[74:75], s[42:43]
    s_waitcnt vmcnt(6)
    v_cmp_ne_u32 s[44:45], s72, v43
    s_nop 0
    s_or_b64 s[74:75], s[74:75], s[44:45]
    s_waitcnt vmcnt(5)
    v_cmp_ne_u32 s[46:47], s72, v47
    s_nop 0
    s_or_b64 s[74:75], s[74:75], s[46:47]
    s_waitcnt vmcnt(4)
    v_cmp_ne_u32 s[48:49], s72, v51
    s_nop 0
    s_or_b64 s[74:75], s[74:75], s[48:49]
    s_waitcnt vmcnt(3)
    v_cmp_ne_u32 s[50:51], s72, v55
    s_nop 0
    s_or_b64 s[74:75], s[74:75], s[50:51]
    s_waitcnt vmcnt(2)
    v_cmp_ne_u32 s[64:65], s72, v59
    s_nop 0
    s_or_b64 s[74:75], s[74:75], s[64:65]
    s_waitcnt vmcnt(1)
    v_cmp_ne_u32 s[66:67], s72, v63
    s_nop 0
    s_or_b64 s[74:75], s[74:75], s[66:67]
    s_waitcnt vmcnt(0)
    v_cmp_ne_u32 s[68:69], s72, v67
    s_nop 0
    s_or_b64 s[74:75], s[74:75], s[68:69]
    s_cbranch_scc0 d2_39
    s_sleep 1
    s_sub_u32 s71, s71, 1
    s_cmp_lg_u32 s71, 0
    s_cbranch_scc1 p2_38
d2_39:
    ds_write_b32 v22, v32 offset:0
    ds_write_b32 v22, v33 offset:4
    ds_write_b32 v22, v34 offset:8
    ds_write_b32 v22, v36 offset:768
    ds_write_b32 v22, v37 offset:772
    ds_write_b32 v22, v38 offset:776
    ds_write_b32 v22, v40 offset:1536
    ds_write_b32 v22, v41 offset:1540
    ds_write_b32 v22, v42 offset:1544
    ds_write_b32 v22, v44 offset:2304
    ds_write_b32 v22, v45 offset:2308
    ds_write_b32 v22, v46 offset:2312
    ds_write_b32 v22, v48 offset:3072
    ds_write_b32 v22, v49 offset:3076
    ds_write_b32 v22, v50 offset:3080
    ds_write_b32 v22, v52 offset:3840
    ds_write_b32 v22, v53 offset:3844
    ds_write_b32 v22, v54 offset:3848
    ds_write_b32 v22, v56 offset:4608
    ds_write_b32 v22, v57 offset:4612
    ds_write_b32 v22, v58 offset:4616
    ds_write_b32 v22, v60 offset:5376
    ds_write_b32 v22, v61 offset:5380
    ds_write_b32 v22, v62 offset:5384
    ds_write_b32 v22, v64 offset:6144
    ds_write_b32 v22, v65 offset:6148
    ds_write_b32 v22, v66 offset:6152
    ds_write_b8 v12, v14 offset:64
    s_branch ldone_31
cs_30:
    s_mov_b32 s52, s14
    s_mov_b32 s53, s15
    s_mov_b32 s54, 819200
    s_mov_b32 s55, 0x20000
    v_add_u32 v20, 0, v0
    v_mul_u32_u24 v25, 6554, v20
    v_lshrrev_b32 v25, 16, v25
    v_mul_u32_u24 v22, 10, v25
    v_sub_u32 v22, v20, v22
    v_and_b32 v23, 0x13, v25
    v_bfe_u32 v24, v25, 2, 1
    v_lshl_or_b32 v23, v24, 3, v23
    v_bfe_u32 v24, v25, 3, 1
    v_lshl_or_b32 v23, v24, 2, v23
    v_mul_u32_u24 v23, 1280, v23
    v_lshl_add_u32 v6, v22, 4, v23
    v_add_u32 v20, 64, v0
    v_mul_u32_u24 v25, 6554, v20
    v_lshrrev_b32 v25, 16, v25
    v_mul_u32_u24 v22, 10, v25
    v_sub_u32 v22, v20, v22
    v_and_b32 v23, 0x13, v25
    v_bfe_u32 v24, v25, 2, 1
    v_lshl_or_b32 v23, v24, 3, v23
    v_bfe_u32 v24, v25, 3, 1
    v_lshl_or_b32 v23, v24, 2, v23
    v_mul_u32_u24 v23, 1280, v23
    v_lshl_add_u32 v7, v22, 4, v23
    v_add_u32 v20, 128, v0
    v_mul_u32_u24 v25, 6554, v20
    v_lshrrev_b32 v25, 16, v25
    v_mul_u32_u24 v22, 10, v25
    v_sub_u32 v22, v20, v22
    v_and_b32 v23, 0x13, v25
    v_bfe_u32 v24, v25, 2, 1
    v_lshl_or_b32 v23, v24, 3, v23
    v_bfe_u32 v24, v25, 3, 1
    v_lshl_or_b32 v23, v24, 2, v23
    v_mul_u32_u24 v23, 1280, v23
    v_lshl_add_u32 v8, v22, 4, v23
    v_add_u32 v20, 192, v0
    v_mul_u32_u24 v25, 6554, v20
    v_lshrrev_b32 v25, 16, v25
    v_mul_u32_u24 v22, 10, v25
    v_sub_u32 v22, v20, v22
    v_and_b32 v23, 0x13, v25
    v_bfe_u32 v24, v25, 2, 1
    v_lshl_or_b32 v23, v24, 3, v23
    v_bfe_u32 v24, v25, 3, 1
    v_lshl_or_b32 v23, v24, 2, v23
    v_mul_u32_u24 v23, 1280, v23
    v_lshl_add_u32 v9, v22, 4, v23
    v_add_u32 v20, 256, v0
    v_mul_u32_u24 v25, 6554, v20
    v_lshrrev_b32 v25, 16, v25
    v_mul_u32_u24 v22, 10, v25
    v_sub_u32 v22, v20, v22
    v_and_b32 v23, 0x13, v25
    v_bfe_u32 v24, v25, 2, 1
    v_lshl_or_b32 v23, v24, 3, v23
    v_bfe_u32 v24, v25, 3, 1
    v_lshl_or_b32 v23, v24, 2, v23
    v_mul_u32_u24 v23, 1280, v23
    v_lshl_add_u32 v10, v22, 4, v23
    s_mul_i32 s65, s36, 5120
    s_mul_i32 s67, s36, 40960
    s_add_u32 s67, s67, s69
wq_40:
    ds_read_b32 v15, v13 offset:148
    s_waitcnt lgkmcnt(0)
    v_readfirstlane_b32 s70, v15
    s_nop 0
    s_cmp_eq_u32 s70, 16843009
    s_cbranch_scc1 qgo_41
    s_sleep 2
    s_branch wq_40
qgo_41:
    s_add_u32 m0, s65, 0
    s_nop 0
    buffer_load_dwordx4 v6, s[52:55], s67 offen lds
    s_add_u32 m0, s65, 1024
    s_nop 0
    buffer_load_dwordx4 v7, s[52:55], s67 offen lds
    s_add_u32 m0, s65, 2048
    s_nop 0
    buffer_load_dwordx4 v8, s[52:55], s67 offen lds
    s_add_u32 m0, s65, 3072
    s_nop 0
    buffer_load_dwordx4 v9, s[52:55], s67 offen lds
    s_add_u32 m0, s65, 4096
    s_nop 0
    buffer_load_dwordx4 v10, s[52:55], s67 offen lds
    s_add_u32 s67, s67, 81920
    s_add_u32 m0, s65, 10240
    s_nop 0
    buffer_load_dwordx4 v6, s[52:55], s67 offen lds
    s_add_u32 m0, s65, 11264
    s_nop 0
    buffer_load_dwordx4 v7, s[52:55], s67 offen lds
    s_add_u32 m0, s65, 12288
    s_nop 0
    buffer_load_dwordx4 v8, s[52:55], s67 offen lds
    s_add_u32 m0, s65, 13312
    s_nop 0
    buffer_load_dwordx4 v9, s[52:55], s67 offen lds
    s_add_u32 m0, s65, 14336
    s_nop 0
    buffer_load_dwordx4 v10, s[52:55], s67 offen lds
    s_add_u32 s67, s67, 81920
    s_add_u32 m0, s65, 20480
    s_nop 0
    buffer_load_dwordx4 v6, s[52:55], s67 offen lds
    s_add_u32 m0, s65, 21504
    s_nop 0
    buffer_load_dwordx4 v7, s[52:55], s67 offen lds
    s_add_u32 m0, s65, 22528
    s_nop 0
    buffer_load_dwordx4 v8, s[52:55], s67 offen lds
    s_add_u32 m0, s65, 23552
    s_nop 0
    buffer_load_dwordx4 v9, s[52:55], s67 offen lds
    s_add_u32 m0, s65, 24576
    s_nop 0
    buffer_load_dwordx4 v10, s[52:55], s67 offen lds
    s_add_u32 s67, s67, 81920
    s_add_u32 m0, s65, 30720
    s_nop 0
    buffer_load_dwordx4 v6, s[52:55], s67 offen lds
    s_add_u32 m0, s65, 31744
    s_nop 0
    buffer_load_dwordx4 v7, s[52:55], s67 offen lds
    s_add_u32 m0, s65, 32768
    s_nop 0
    buffer_load_dwordx4 v8, s[52:55], s67 offen lds
    s_add_u32 m0, s65, 33792
    s_nop 0
    buffer_load_dwordx4 v9, s[52:55], s67 offen lds
    s_add_u32 m0, s65, 34816
    s_nop 0
    buffer_load_dwordx4 v10, s[52:55], s67 offen lds
    s_add_u32 s67, s67, 81920
    s_add_u32 m0, s65, 61440
    s_nop 0
    buffer_load_dwordx4 v6, s[52:55], s67 offen lds
    s_add_u32 m0, s65, 62464
    s_nop 0
    buffer_load_dwordx4 v7, s[52:55], s67 offen lds
    s_add_u32 m0, s65, 63488
    s_nop 0
    buffer_load_dwordx4 v8, s[52:55], s67 offen lds
    s_add_u32 m0, s65, 64512
    s_nop 0
    buffer_load_dwordx4 v9, s[52:55], s67 offen lds
    s_add_u32 m0, s65, 65536
    s_nop 0
    buffer_load_dwordx4 v10, s[52:55], s67 offen lds
    s_add_u32 s67, s67, 81920
    s_add_u32 m0, s65, 71680
    s_nop 0
    buffer_load_dwordx4 v6, s[52:55], s67 offen lds
    s_add_u32 m0, s65, 72704
    s_nop 0
    buffer_load_dwordx4 v7, s[52:55], s67 offen lds
    s_add_u32 m0, s65, 73728
    s_nop 0
    buffer_load_dwordx4 v8, s[52:55], s67 offen lds
    s_add_u32 m0, s65, 74752
    s_nop 0
    buffer_load_dwordx4 v9, s[52:55], s67 offen lds
    s_add_u32 m0, s65, 75776
    s_nop 0
    buffer_load_dwordx4 v10, s[52:55], s67 offen lds
    s_add_u32 s67, s67, 81920
    s_add_u32 m0, s65, 102400
    s_nop 0
    buffer_load_dwordx4 v6, s[52:55], s67 offen lds
    s_add_u32 m0, s65, 103424
    s_nop 0
    buffer_load_dwordx4 v7, s[52:55], s67 offen lds
    s_add_u32 m0, s65, 104448
    s_nop 0
    buffer_load_dwordx4 v8, s[52:55], s67 offen lds
    s_add_u32 m0, s65, 105472
    s_nop 0
    buffer_load_dwordx4 v9, s[52:55], s67 offen lds
    s_add_u32 m0, s65, 106496
    s_nop 0
    buffer_load_dwordx4 v10, s[52:55], s67 offen lds
    s_add_u32 s67, s67, 81920
    s_add_u32 m0, s65, 112640
    s_nop 0
    buffer_load_dwordx4 v6, s[52:55], s67 offen lds
    s_add_u32 m0, s65, 113664
    s_nop 0
    buffer_load_dwordx4 v7, s[52:55], s67 offen lds
    s_add_u32 m0, s65, 114688
    s_nop 0
    buffer_load_dwordx4 v8, s[52:55], s67 offen lds
    s_add_u32 m0, s65, 115712
    s_nop 0
    buffer_load_dwordx4 v9, s[52:55], s67 offen lds
    s_add_u32 m0, s65, 116736
    s_nop 0
    buffer_load_dwordx4 v10, s[52:55], s67 offen lds
    s_add_u32 s67, s67, 81920
    s_add_u32 m0, s65, 122880
    s_nop 0
    buffer_load_dwordx4 v6, s[52:55], s67 offen lds
    s_add_u32 m0, s65, 123904
    s_nop 0
    buffer_load_dwordx4 v7, s[52:55], s67 offen lds
    s_add_u32 m0, s65, 124928
    s_nop 0
    buffer_load_dwordx4 v8, s[52:55], s67 offen lds
    s_add_u32 m0, s65, 125952
    s_nop 0
    buffer_load_dwordx4 v9, s[52:55], s67 offen lds
    s_add_u32 m0, s65, 126976
    s_nop 0
    buffer_load_dwordx4 v10, s[52:55], s67 offen lds
    s_add_u32 s67, s67, 81920
    s_add_u32 m0, s65, 133120
    s_nop 0
    buffer_load_dwordx4 v6, s[52:55], s67 offen lds
    s_add_u32 m0, s65, 134144
    s_nop 0
    buffer_load_dwordx4 v7, s[52:55], s67 offen lds
    s_add_u32 m0, s65, 135168
    s_nop 0
    buffer_load_dwordx4 v8, s[52:55], s67 offen lds
    s_add_u32 m0, s65, 136192
    s_nop 0
    buffer_load_dwordx4 v9, s[52:55], s67 offen lds
    s_add_u32 m0, s65, 137216
    s_nop 0
    buffer_load_dwordx4 v10, s[52:55], s67 offen lds
    s_add_u32 s67, s67, 81920
    s_waitcnt vmcnt(0)
    ds_write_b8 v12, v14 offset:68
    s_cmp_ge_u32 s2, 216
    s_cbranch_scc1 ldone_31
    s_add_u32 s60, s4, 15204352
    s_addc_u32 s61, s5, 0
    s_mov_b32 s62, 110592
    s_mov_b32 s63, 0x20000
    s_and_b32 s37, s2, 3
    s_lshl_b32 s37, s37, 1
    s_add_u32 s37, s37, s36
    s_lshr_b32 s36, s2, 2
    s_cmp_ge_u32 s36, 27
    s_cselect_b32 s72, s18, s16
    s_cselect_b32 s73, s19, s17
    s_cselect_b32 s38, 27, 0
    s_sub_u32 s38, s36, s38
    s_mov_b32 s74, 2211840
    s_mov_b32 s75, 0x20000
    s_mul_i32 s39, s37, 276480
    s_lshl_b32 s38, s38, 7
    s_add_u32 s39, s39, s38
    v_mul_u32_u24 v20, 3456, v1
    v_lshl_add_u32 v20, v2, 4, v20
    buffer_load_dwordx4 v[24:27], v20, s[72:75], s39 offen
    s_add_u32 s39, s39, 27648
    buffer_load_dwordx4 v[28:31], v20, s[72:75], s39 offen
    s_add_u32 s39, s39, 27648
    buffer_load_dwordx4 v[32:35], v20, s[72:75], s39 offen
    s_add_u32 s39, s39, 27648
    buffer_load_dwordx4 v[36:39], v20, s[72:75], s39 offen
    s_add_u32 s39, s39, 27648
    buffer_load_dwordx4 v[40:43], v20, s[72:75], s39 offen
    s_add_u32 s39, s39, 27648
    buffer_load_dwordx4 v[44:47], v20, s[72:75], s39 offen
    s_add_u32 s39, s39, 27648
    buffer_load_dwordx4 v[48:51], v20, s[72:75], s39 offen
    s_add_u32 s39, s39, 27648
    buffer_load_dwordx4 v[52:55], v20, s[72:75], s39 offen
    s_add_u32 s39, s39, 27648
    buffer_load_dwordx4 v[56:59], v20, s[72:75], s39 offen
    s_add_u32 s39, s39, 27648
    buffer_load_dwordx4 v[60:63], v20, s[72:75], s39 offen
    s_add_u32 s39, s39, 27648
    s_waitcnt vmcnt(9)
    v_lshlrev_b32 v64, 16, v24
    v_and_b32 v65, 0xffff0000, v24
    v_lshlrev_b32 v66, 16, v25
    v_and_b32 v67, 0xffff0000, v25
    v_lshlrev_b32 v68, 16, v26
    v_and_b32 v69, 0xffff0000, v26
    v_lshlrev_b32 v70, 16, v27
    v_and_b32 v71, 0xffff0000, v27
    s_waitcnt vmcnt(8)
    v_lshlrev_b32 v22, 16, v28
    v_and_b32 v23, 0xffff0000, v28
    v_add_f32 v64, v64, v22
    v_add_f32 v65, v65, v23
    v_lshlrev_b32 v22, 16, v29
    v_and_b32 v23, 0xffff0000, v29
    v_add_f32 v66, v66, v22
    v_add_f32 v67, v67, v23
    v_lshlrev_b32 v22, 16, v30
    v_and_b32 v23, 0xffff0000, v30
    v_add_f32 v68, v68, v22
    v_add_f32 v69, v69, v23
    v_lshlrev_b32 v22, 16, v31
    v_and_b32 v23, 0xffff0000, v31
    v_add_f32 v70, v70, v22
    v_add_f32 v71, v71, v23
    s_waitcnt vmcnt(7)
    v_lshlrev_b32 v22, 16, v32
    v_and_b32 v23, 0xffff0000, v32
    v_add_f32 v64, v64, v22
    v_add_f32 v65, v65, v23
    v_lshlrev_b32 v22, 16, v33
    v_and_b32 v23, 0xffff0000, v33
    v_add_f32 v66, v66, v22
    v_add_f32 v67, v67, v23
    v_lshlrev_b32 v22, 16, v34
    v_and_b32 v23, 0xffff0000, v34
    v_add_f32 v68, v68, v22
    v_add_f32 v69, v69, v23
    v_lshlrev_b32 v22, 16, v35
    v_and_b32 v23, 0xffff0000, v35
    v_add_f32 v70, v70, v22
    v_add_f32 v71, v71, v23
    s_waitcnt vmcnt(6)
    v_lshlrev_b32 v22, 16, v36
    v_and_b32 v23, 0xffff0000, v36
    v_add_f32 v64, v64, v22
    v_add_f32 v65, v65, v23
    v_lshlrev_b32 v22, 16, v37
    v_and_b32 v23, 0xffff0000, v37
    v_add_f32 v66, v66, v22
    v_add_f32 v67, v67, v23
    v_lshlrev_b32 v22, 16, v38
    v_and_b32 v23, 0xffff0000, v38
    v_add_f32 v68, v68, v22
    v_add_f32 v69, v69, v23
    v_lshlrev_b32 v22, 16, v39
    v_and_b32 v23, 0xffff0000, v39
    v_add_f32 v70, v70, v22
    v_add_f32 v71, v71, v23
    s_waitcnt vmcnt(5)
    v_lshlrev_b32 v22, 16, v40
    v_and_b32 v23, 0xffff0000, v40
    v_add_f32 v64, v64, v22
    v_add_f32 v65, v65, v23
    v_lshlrev_b32 v22, 16, v41
    v_and_b32 v23, 0xffff0000, v41
    v_add_f32 v66, v66, v22
    v_add_f32 v67, v67, v23
    v_lshlrev_b32 v22, 16, v42
    v_and_b32 v23, 0xffff0000, v42
    v_add_f32 v68, v68, v22
    v_add_f32 v69, v69, v23
    v_lshlrev_b32 v22, 16, v43
    v_and_b32 v23, 0xffff0000, v43
    v_add_f32 v70, v70, v22
    v_add_f32 v71, v71, v23
    s_waitcnt vmcnt(4)
    v_lshlrev_b32 v22, 16, v44
    v_and_b32 v23, 0xffff0000, v44
    v_add_f32 v64, v64, v22
    v_add_f32 v65, v65, v23
    v_lshlrev_b32 v22, 16, v45
    v_and_b32 v23, 0xffff0000, v45
    v_add_f32 v66, v66, v22
    v_add_f32 v67, v67, v23
    v_lshlrev_b32 v22, 16, v46
    v_and_b32 v23, 0xffff0000, v46
    v_add_f32 v68, v68, v22
    v_add_f32 v69, v69, v23
    v_lshlrev_b32 v22, 16, v47
    v_and_b32 v23, 0xffff0000, v47
    v_add_f32 v70, v70, v22
    v_add_f32 v71, v71, v23
    s_waitcnt vmcnt(3)
    v_lshlrev_b32 v22, 16, v48
    v_and_b32 v23, 0xffff0000, v48
    v_add_f32 v64, v64, v22
    v_add_f32 v65, v65, v23
    v_lshlrev_b32 v22, 16, v49
    v_and_b32 v23, 0xffff0000, v49
    v_add_f32 v66, v66, v22
    v_add_f32 v67, v67, v23
    v_lshlrev_b32 v22, 16, v50
    v_and_b32 v23, 0xffff0000, v50
    v_add_f32 v68, v68, v22
    v_add_f32 v69, v69, v23
    v_lshlrev_b32 v22, 16, v51
    v_and_b32 v23, 0xffff0000, v51
    v_add_f32 v70, v70, v22
    v_add_f32 v71, v71, v23
    s_waitcnt vmcnt(2)
    v_lshlrev_b32 v22, 16, v52
    v_and_b32 v23, 0xffff0000, v52
    v_add_f32 v64, v64, v22
    v_add_f32 v65, v65, v23
    v_lshlrev_b32 v22, 16, v53
    v_and_b32 v23, 0xffff0000, v53
    v_add_f32 v66, v66, v22
    v_add_f32 v67, v67, v23
    v_lshlrev_b32 v22, 16, v54
    v_and_b32 v23, 0xffff0000, v54
    v_add_f32 v68, v68, v22
    v_add_f32 v69, v69, v23
    v_lshlrev_b32 v22, 16, v55
    v_and_b32 v23, 0xffff0000, v55
    v_add_f32 v70, v70, v22
    v_add_f32 v71, v71, v23
    s_waitcnt vmcnt(1)
    v_lshlrev_b32 v22, 16, v56
    v_and_b32 v23, 0xffff0000, v56
    v_add_f32 v64, v64, v22
    v_add_f32 v65, v65, v23
    v_lshlrev_b32 v22, 16, v57
    v_and_b32 v23, 0xffff0000, v57
    v_add_f32 v66, v66, v22
    v_add_f32 v67, v67, v23
    v_lshlrev_b32 v22, 16, v58
    v_and_b32 v23, 0xffff0000, v58
    v_add_f32 v68, v68, v22
    v_add_f32 v69, v69, v23
    v_lshlrev_b32 v22, 16, v59
    v_and_b32 v23, 0xffff0000, v59
    v_add_f32 v70, v70, v22
    v_add_f32 v71, v71, v23
    s_waitcnt vmcnt(0)
    v_lshlrev_b32 v22, 16, v60
    v_and_b32 v23, 0xffff0000, v60
    v_add_f32 v64, v64, v22
    v_add_f32 v65, v65, v23
    v_lshlrev_b32 v22, 16, v61
    v_and_b32 v23, 0xffff0000, v61
    v_add_f32 v66, v66, v22
    v_add_f32 v67, v67, v23
    v_lshlrev_b32 v22, 16, v62
    v_and_b32 v23, 0xffff0000, v62
    v_add_f32 v68, v68, v22
    v_add_f32 v69, v69, v23
    v_lshlrev_b32 v22, 16, v63
    v_and_b32 v23, 0xffff0000, v63
    v_add_f32 v70, v70, v22
    v_add_f32 v71, v71, v23
    v_add_f32_dpp v64, v64, v64 row_ror:8 row_mask:0xf bank_mask:0xf
    v_add_f32_dpp v65, v65, v65 row_ror:8 row_mask:0xf bank_mask:0xf
    v_add_f32_dpp v66, v66, v66 row_ror:8 row_mask:0xf bank_mask:0xf
    v_add_f32_dpp v67, v67, v67 row_ror:8 row_mask:0xf bank_mask:0xf
    v_add_f32_dpp v68, v68, v68 row_ror:8 row_mask:0xf bank_mask:0xf
    v_add_f32_dpp v69, v69, v69 row_ror:8 row_mask:0xf bank_mask:0xf
    v_add_f32_dpp v70, v70, v70 row_ror:8 row_mask:0xf bank_mask:0xf
    v_add_f32_dpp v71, v71, v71 row_ror:8 row_mask:0xf bank_mask:0xf
    v_permlane32_swap_b32 v64, v65
    v_permlane32_swap_b32 v66, v67
    v_permlane32_swap_b32 v68, v69
    v_permlane32_swap_b32 v70, v71
    v_add_f32 v64, v64, v65
    v_add_f32 v66, v66, v67
    v_add_f32 v68, v68, v69
    v_add_f32 v70, v70, v71
    v_permlane16_swap_b32 v64, v66
    s_nop 0
    v_permlane16_swap_b32 v68, v70
    v_add_f32 v64, v64, v66
    v_add_f32 v68, v68, v70
    s_mul_i32 s37, s37, 13824
    s_lshl_b32 s36, s36, 8
    s_add_u32 s37, s37, s36
    v_and_b32 v23, 1, v3
    v_lshlrev_b32 v23, 1, v23
    v_lshrrev_b32 v22, 1, v3
    v_add_u32 v22, v22, v23
    v_lshlrev_b32 v22, 2, v22
    v_lshl_add_u32 v22, v2, 5, v22
    buffer_store_dword v64, v22, s[60:63], s37 offen sc1
    buffer_store_dword v68, v22, s[60:63], s37 offen offset:16 sc1
    s_lshl_b32 s36, s2, 7
    s_lshl_b32 s37, s35, 3
    s_add_u32 s36, s36, s37
    s_add_u32 s36, s36, 229368
    v_mov_b32 v17, v16
    s_waitcnt vmcnt(0)
    s_mov_b64 exec, 1
    buffer_store_dwordx2 v[16:17], v19, s[56:59], s36 offen sc1
    s_mov_b64 exec, -1
ldone_31:
    s_mul_i32 s36, s21, 13
    s_lshr_b32 s36, s36, 6
    s_mul_i32 s36, s36, 5
    s_sub_u32 s36, s21, s36
    s_lshr_b32 s37, s20, 2
    s_mul_i32 s37, s37, 5
    s_add_u32 s36, s36, s37
    s_lshl_b32 s66, s36, 7
    v_lshrrev_b32 v28, 5, v0
    v_lshlrev_b32 v28, 3, v28
    v_bfe_u32 v29, v0, 3, 2
    v_add_u32 v28, v28, v29
    s_lshr_b32 s36, s35, 1
    s_lshl_b32 s36, s36, 5
    s_and_b32 s37, s35, 1
    s_lshl_b32 s37, s37, 2
    s_add_u32 s36, s36, s37
    v_add_u32 v28, s36, v28
    v_mul_u32_u24 v28, 1280, v28
    v_lshrrev_b32 v29, 4, v0
    v_lshlrev_b32 v29, 1, v29
    v_and_b32 v30, 7, v0
    v_xor_b32 v29, v30, v29
    v_lshl_add_u32 v28, v29, 4, v28
    v_add_u32 v28, s66, v28
    v_add_u32 v29, 20480, v28
    s_mov_b32 s56, s26
    s_mov_b32 s57, s27
    s_mov_b32 s58, 2211840
    s_mov_b32 s59, 0x20000
    s_setprio 0
    s_waitcnt vmcnt(0) lgkmcnt(0)
    s_cmp_eq_u32 s35, 3
    s_cbranch_scc1 prego_43
wpre_42:
    ds_read_b32 v15, v13 offset:216
    s_waitcnt lgkmcnt(0)
    v_readfirstlane_b32 s70, v15
    s_nop 0
    s_cmp_eq_u32 s70, 16843009
    s_cbranch_scc1 prego_43
    s_sleep 2
    s_branch wpre_42
prego_43:
    s_mov_b32 s63, 1474560
    buffer_load_dwordx4 v[40:43], v28, s[56:59], s63 offen
    buffer_load_dwordx4 v[44:47], v29, s[56:59], s63 offen
    s_mov_b32 s63, 1556480
    buffer_load_dwordx4 v[48:51], v28, s[56:59], s63 offen
    buffer_load_dwordx4 v[52:55], v29, s[56:59], s63 offen
    s_mov_b32 s63, 1638400
    buffer_load_dwordx4 v[56:59], v28, s[56:59], s63 offen
    buffer_load_dwordx4 v[60:63], v29, s[56:59], s63 offen
    s_mov_b32 s63, 1720320
    buffer_load_dwordx4 v[64:67], v28, s[56:59], s63 offen
    buffer_load_dwordx4 v[68:71], v29, s[56:59], s63 offen
    s_mov_b32 s63, 1802240
    buffer_load_dwordx4 v[72:75], v28, s[56:59], s63 offen
    buffer_load_dwordx4 v[76:79], v29, s[56:59], s63 offen
    s_mov_b32 s63, 1884160
    buffer_load_dwordx4 v[80:83], v28, s[56:59], s63 offen
    buffer_load_dwordx4 v[84:87], v29, s[56:59], s63 offen
    s_mov_b32 s63, 1966080
    buffer_load_dwordx4 v[88:91], v28, s[56:59], s63 offen
    buffer_load_dwordx4 v[92:95], v29, s[56:59], s63 offen
    s_mov_b32 s63, 2048000
    buffer_load_dwordx4 v[96:99], v28, s[56:59], s63 offen
    buffer_load_dwordx4 v[100:103], v29, s[56:59], s63 offen
    s_mov_b32 s63, 2129920
    buffer_load_dwordx4 v[104:107], v28, s[56:59], s63 offen
    buffer_load_dwordx4 v[108:111], v29, s[56:59], s63 offen
    s_mov_b32 s63, 1392640
    buffer_load_dwordx4 v[112:115], v28, s[56:59], s63 offen
    buffer_load_dwordx4 v[116:119], v29, s[56:59], s63 offen
    s_mov_b32 s63, 1310720
    buffer_load_dwordx4 v[120:123], v28, s[56:59], s63 offen
    buffer_load_dwordx4 v[124:127], v29, s[56:59], s63 offen
    s_mov_b32 s63, 1228800
    buffer_load_dwordx4 v[128:131], v28, s[56:59], s63 offen
    buffer_load_dwordx4 v[132:135], v29, s[56:59], s63 offen
    s_mov_b32 s63, 1146880
    buffer_load_dwordx4 v[136:139], v28, s[56:59], s63 offen
    buffer_load_dwordx4 v[140:143], v29, s[56:59], s63 offen
    s_mov_b32 s63, 1064960
    buffer_load_dwordx4 v[144:147], v28, s[56:59], s63 offen
    buffer_load_dwordx4 v[148:151], v29, s[56:59], s63 offen
    s_mov_b32 s63, 983040
    buffer_load_dwordx4 v[152:155], v28, s[56:59], s63 offen
    buffer_load_dwordx4 v[156:159], v29, s[56:59], s63 offen
    s_mov_b32 s63, 901120
    buffer_load_dwordx4 v[160:163], v28, s[56:59], s63 offen
    buffer_load_dwordx4 v[164:167], v29, s[56:59], s63 offen
    s_mov_b32 s63, 819200
    buffer_load_dwordx4 v[168:171], v28, s[56:59], s63 offen
    buffer_load_dwordx4 v[172:175], v29, s[56:59], s63 offen
    s_mov_b32 s63, 737280
    buffer_load_dwordx4 v[176:179], v28, s[56:59], s63 offen
    buffer_load_dwordx4 v[180:183], v29, s[56:59], s63 offen
    s_setprio 0
wp2_44:
    ds_read_b32 v15, v13 offset:208
    s_waitcnt lgkmcnt(0)
    v_readfirstlane_b32 s70, v15
    s_nop 0
    s_cmp_eq_u32 s70, 16843009
    s_cbranch_scc1 p2go_45
    s_sleep 2
    s_branch wp2_44
p2go_45:
    s_mul_i32 s23, s20, 30
    s_add_u32 s23, s23, s21
    s_sub_u32 s24, s21, 30
    s_lshl_b32 s24, s24, 3
    s_add_u32 s24, s24, s20
    s_add_u32 s25, s24, 240
    s_cmp_ge_u32 s21, 30
    s_cselect_b32 s23, s25, s23
    s_cmp_ge_u32 s23, 243
    s_cselect_b32 s75, 1, 0
    s_cmp_ge_u32 s23, 252
    s_cselect_b32 s75, 2, s75
    s_sub_u32 s24, s23, 126
    s_cmp_ge_u32 s23, 126
    s_cselect_b32 s24, s24, s23
    s_mul_i32 s22, s24, 147
    s_lshr_b32 s22, s22, 11
    s_mul_i32 s25, s24, 79
    s_lshr_b32 s25, s25, 10
    s_cmp_ge_u32 s23, 126
    s_cselect_b32 s22, s25, s22
    s_cselect_b32 s25, 13, 14
    s_cselect_b32 s31, 14, 0
    s_mul_i32 s25, s25, s22
    s_sub_u32 s24, s24, s25
    s_add_u32 s31, s31, s24
    s_sub_u32 s24, s23, 243
    s_mul_i32 s24, s24, 3
    s_cmp_eq_u32 s75, 1
    s_cselect_b32 s31, s24, s31
    s_cselect_b32 s22, 9, s22
    s_waitcnt vmcnt(0)
    s_cmp_eq_u32 s75, 2
    s_cbranch_scc1 l4_46
    s_cmp_eq_u32 s75, 1
    s_cbranch_scc1 lsmall_48
    s_mul_i32 s30, s22, 224
    s_lshl_b32 s34, s31, 7
    v_lshrrev_b32 v1, 3, v0
    v_and_b32 v2, 7, v0
    v_lshrrev_b32 v3, 4, v0
    v_lshrrev_b32 v22, 5, v0
    v_lshlrev_b32 v22, 3, v22
    v_and_b32 v23, 3, v1
    v_add_u32 v22, v22, v23
    s_lshr_b32 s36, s35, 1
    s_lshl_b32 s36, s36, 5
    s_and_b32 s37, s35, 1
    s_lshl_b32 s37, s37, 2
    s_add_u32 s36, s36, s37
    v_add_u32 v22, s36, v22
    v_mul_u32_u24 v22, 3456, v22
    v_lshlrev_b32 v23, 1, v3
    v_xor_b32 v23, v2, v23
    v_lshl_add_u32 v26, v23, 4, v22
    v_add_u32 v26, s34, v26
    v_add_u32 v27, 55296, v26
    s_lshl_b32 s64, s35, 10
    s_lshl_b32 s65, s35, 11
    s_mov_b32 s44, s16
    s_mov_b32 s45, s17
    s_mov_b32 s46, 2211840
    s_mov_b32 s47, 0x20000
    s_mov_b32 s48, s18
    s_mov_b32 s49, s19
    s_mov_b32 s50, 2211840
    s_mov_b32 s51, 0x20000
    s_add_u32 s40, s4, 11534336
    s_addc_u32 s41, s5, 0
    s_mov_b32 s42, 2621440
    s_mov_b32 s43, 0x20000
    s_mov_b32 s68, 0
    s_add_u32 m0, s65, 98304
    s_nop 0
    buffer_load_dwordx4 v26, s[44:47], s68 offen lds
    s_add_u32 m0, s65, 99328
    s_nop 0
    buffer_load_dwordx4 v27, s[44:47], s68 offen lds
    s_add_u32 m0, s65, 106496
    s_nop 0
    buffer_load_dwordx4 v26, s[48:51], s68 offen lds
    s_add_u32 m0, s65, 107520
    s_nop 0
    buffer_load_dwordx4 v27, s[48:51], s68 offen lds
    s_mov_b32 s68, 221184
    s_add_u32 m0, s65, 114688
    s_nop 0
    buffer_load_dwordx4 v26, s[44:47], s68 offen lds
    s_add_u32 m0, s65, 115712
    s_nop 0
    buffer_load_dwordx4 v27, s[44:47], s68 offen lds
    s_add_u32 m0, s65, 122880
    s_nop 0
    buffer_load_dwordx4 v26, s[48:51], s68 offen lds
    s_add_u32 m0, s65, 123904
    s_nop 0
    buffer_load_dwordx4 v27, s[48:51], s68 offen lds
    s_lshr_b32 s36, s35, 1
    s_lshl_b32 s38, s36, 4
    s_add_u32 s38, s38, s30
    s_and_b32 s37, s35, 1
    s_lshl_b32 s37, s37, 10
    s_mul_i32 s39, s38, 1280
    s_add_u32 s39, s39, s37
    v_lshlrev_b32 v3, 4, v0
    v_add_u32 v4, s39, v3
    v_mov_b32 v21, 1073741824
    v_add_u32 v5, 40960, v4
    v_add_u32 v6, 81920, v4
    v_add_u32 v7, 122880, v4
    v_add_u32 v8, 163840, v4
    v_add_u32 v9, 204800, v4
    v_add_u32 v10, 245760, v4
    s_barrier
    s_mov_b32 s67, 0
    s_add_u32 m0, s64, 0
    s_nop 0
    buffer_load_dwordx4 v4, s[40:43], s67 offen sc1 lds
    s_add_u32 m0, s64, 4096
    s_nop 0
    buffer_load_dwordx4 v5, s[40:43], s67 offen sc1 lds
    s_add_u32 m0, s64, 8192
    s_nop 0
    buffer_load_dwordx4 v6, s[40:43], s67 offen sc1 lds
    s_add_u32 m0, s64, 12288
    s_nop 0
    buffer_load_dwordx4 v7, s[40:43], s67 offen sc1 lds
    s_add_u32 m0, s64, 16384
    s_nop 0
    buffer_load_dwordx4 v8, s[40:43], s67 offen sc1 lds
    s_add_u32 m0, s64, 20480
    s_nop 0
    buffer_load_dwordx4 v9, s[40:43], s67 offen sc1 lds
    s_add_u32 m0, s64, 24576
    s_nop 0
    buffer_load_dwordx4 v10, s[40:43], s67 offen sc1 lds
    s_mov_b32 s67, 2048
    s_add_u32 m0, s64, 32768
    s_nop 0
    buffer_load_dwordx4 v4, s[40:43], s67 offen sc1 lds
    s_add_u32 m0, s64, 36864
    s_nop 0
    buffer_load_dwordx4 v5, s[40:43], s67 offen sc1 lds
    s_add_u32 m0, s64, 40960
    s_nop 0
    buffer_load_dwordx4 v6, s[40:43], s67 offen sc1 lds
    s_add_u32 m0, s64, 45056
    s_nop 0
    buffer_load_dwordx4 v7, s[40:43], s67 offen sc1 lds
    s_add_u32 m0, s64, 49152
    s_nop 0
    buffer_load_dwordx4 v8, s[40:43], s67 offen sc1 lds
    s_add_u32 m0, s64, 53248
    s_nop 0
    buffer_load_dwordx4 v9, s[40:43], s67 offen sc1 lds
    s_add_u32 m0, s64, 57344
    s_nop 0
    buffer_load_dwordx4 v10, s[40:43], s67 offen sc1 lds
    s_mov_b32 s68, 442368
    s_add_u32 m0, s65, 131072
    s_nop 0
    buffer_load_dwordx4 v26, s[44:47], s68 offen lds
    s_add_u32 m0, s65, 132096
    s_nop 0
    buffer_load_dwordx4 v27, s[44:47], s68 offen lds
    s_add_u32 m0, s65, 139264
    s_nop 0
    buffer_load_dwordx4 v26, s[48:51], s68 offen lds
    s_add_u32 m0, s65, 140288
    s_nop 0
    buffer_load_dwordx4 v27, s[48:51], s68 offen lds
    s_waitcnt vmcnt(11)
    s_barrier
    s_mov_b32 s67, 4096
    s_add_u32 m0, s64, 65536
    s_nop 0
    buffer_load_dwordx4 v4, s[40:43], s67 offen sc1 lds
    s_add_u32 m0, s64, 69632
    s_nop 0
    buffer_load_dwordx4 v5, s[40:43], s67 offen sc1 lds
    s_add_u32 m0, s64, 73728
    s_nop 0
    buffer_load_dwordx4 v6, s[40:43], s67 offen sc1 lds
    s_add_u32 m0, s64, 77824
    s_nop 0
    buffer_load_dwordx4 v7, s[40:43], s67 offen sc1 lds
    s_add_u32 m0, s64, 81920
    s_nop 0
    buffer_load_dwordx4 v8, s[40:43], s67 offen sc1 lds
    s_add_u32 m0, s64, 86016
    s_nop 0
    buffer_load_dwordx4 v9, s[40:43], s67 offen sc1 lds
    s_add_u32 m0, s64, 90112
    s_nop 0
    buffer_load_dwordx4 v10, s[40:43], s67 offen sc1 lds
    s_waitcnt vmcnt(11)
    s_barrier
    s_mov_b32 s67, 6144
    s_add_u32 m0, s64, 0
    s_nop 0
    buffer_load_dwordx4 v4, s[40:43], s67 offen sc1 lds
    s_add_u32 m0, s64, 4096
    s_nop 0
    buffer_load_dwordx4 v5, s[40:43], s67 offen sc1 lds
    s_add_u32 m0, s64, 8192
    s_nop 0
    buffer_load_dwordx4 v6, s[40:43], s67 offen sc1 lds
    s_add_u32 m0, s64, 12288
    s_nop 0
    buffer_load_dwordx4 v7, s[40:43], s67 offen sc1 lds
    s_add_u32 m0, s64, 16384
    s_nop 0
    buffer_load_dwordx4 v8, s[40:43], s67 offen sc1 lds
    s_add_u32 m0, s64, 20480
    s_nop 0
    buffer_load_dwordx4 v9, s[40:43], s67 offen sc1 lds
    s_add_u32 m0, s64, 24576
    s_nop 0
    buffer_load_dwordx4 v10, s[40:43], s67 offen sc1 lds
    s_mov_b32 s68, 663552
    s_add_u32 m0, s65, 98304
    s_nop 0
    buffer_load_dwordx4 v26, s[44:47], s68 offen lds
    s_add_u32 m0, s65, 99328
    s_nop 0
    buffer_load_dwordx4 v27, s[44:47], s68 offen lds
    s_add_u32 m0, s65, 106496
    s_nop 0
    buffer_load_dwordx4 v26, s[48:51], s68 offen lds
    s_add_u32 m0, s65, 107520
    s_nop 0
    buffer_load_dwordx4 v27, s[48:51], s68 offen lds
    s_waitcnt vmcnt(11)
    s_barrier
    s_mov_b32 s67, 8192
    s_add_u32 m0, s64, 32768
    s_nop 0
    buffer_load_dwordx4 v4, s[40:43], s67 offen sc1 lds
    s_add_u32 m0, s64, 36864
    s_nop 0
    buffer_load_dwordx4 v5, s[40:43], s67 offen sc1 lds
    s_add_u32 m0, s64, 40960
    s_nop 0
    buffer_load_dwordx4 v6, s[40:43], s67 offen sc1 lds
    s_add_u32 m0, s64, 45056
    s_nop 0
    buffer_load_dwordx4 v7, s[40:43], s67 offen sc1 lds
    s_add_u32 m0, s64, 49152
    s_nop 0
    buffer_load_dwordx4 v8, s[40:43], s67 offen sc1 lds
    s_add_u32 m0, s64, 53248
    s_nop 0
    buffer_load_dwordx4 v9, s[40:43], s67 offen sc1 lds
    s_add_u32 m0, s64, 57344
    s_nop 0
    buffer_load_dwordx4 v10, s[40:43], s67 offen sc1 lds
    s_mov_b32 s68, 884736
    s_add_u32 m0, s65, 114688
    s_nop 0
    buffer_load_dwordx4 v26, s[44:47], s68 offen lds
    s_add_u32 m0, s65, 115712
    s_nop 0
    buffer_load_dwordx4 v27, s[44:47], s68 offen lds
    s_add_u32 m0, s65, 122880
    s_nop 0
    buffer_load_dwordx4 v26, s[48:51], s68 offen lds
    s_add_u32 m0, s65, 123904
    s_nop 0
    buffer_load_dwordx4 v27, s[48:51], s68 offen lds
    s_waitcnt vmcnt(11)
    s_barrier
    s_mov_b32 s67, 10240
    s_add_u32 m0, s64, 65536
    s_nop 0
    buffer_load_dwordx4 v4, s[40:43], s67 offen sc1 lds
    s_add_u32 m0, s64, 69632
    s_nop 0
    buffer_load_dwordx4 v5, s[40:43], s67 offen sc1 lds
    s_add_u32 m0, s64, 73728
    s_nop 0
    buffer_load_dwordx4 v6, s[40:43], s67 offen sc1 lds
    s_add_u32 m0, s64, 77824
    s_nop 0
    buffer_load_dwordx4 v7, s[40:43], s67 offen sc1 lds
    s_add_u32 m0, s64, 81920
    s_nop 0
    buffer_load_dwordx4 v8, s[40:43], s67 offen sc1 lds
    s_add_u32 m0, s64, 86016
    s_nop 0
    buffer_load_dwordx4 v9, s[40:43], s67 offen sc1 lds
    s_add_u32 m0, s64, 90112
    s_nop 0
    buffer_load_dwordx4 v10, s[40:43], s67 offen sc1 lds
    s_mov_b32 s68, 1105920
    s_add_u32 m0, s65, 131072
    s_nop 0
    buffer_load_dwordx4 v26, s[44:47], s68 offen lds
    s_add_u32 m0, s65, 132096
    s_nop 0
    buffer_load_dwordx4 v27, s[44:47], s68 offen lds
    s_add_u32 m0, s65, 139264
    s_nop 0
    buffer_load_dwordx4 v26, s[48:51], s68 offen lds
    s_add_u32 m0, s65, 140288
    s_nop 0
    buffer_load_dwordx4 v27, s[48:51], s68 offen lds
    s_waitcnt vmcnt(11)
    s_barrier
    s_mov_b32 s67, 12288
    s_add_u32 m0, s64, 0
    s_nop 0
    buffer_load_dwordx4 v4, s[40:43], s67 offen sc1 lds
    s_add_u32 m0, s64, 4096
    s_nop 0
    buffer_load_dwordx4 v5, s[40:43], s67 offen sc1 lds
    s_add_u32 m0, s64, 8192
    s_nop 0
    buffer_load_dwordx4 v6, s[40:43], s67 offen sc1 lds
    s_add_u32 m0, s64, 12288
    s_nop 0
    buffer_load_dwordx4 v7, s[40:43], s67 offen sc1 lds
    s_add_u32 m0, s64, 16384
    s_nop 0
    buffer_load_dwordx4 v8, s[40:43], s67 offen sc1 lds
    s_add_u32 m0, s64, 20480
    s_nop 0
    buffer_load_dwordx4 v9, s[40:43], s67 offen sc1 lds
    s_add_u32 m0, s64, 24576
    s_nop 0
    buffer_load_dwordx4 v10, s[40:43], s67 offen sc1 lds
    s_mov_b32 s68, 1327104
    s_add_u32 m0, s65, 98304
    s_nop 0
    buffer_load_dwordx4 v26, s[44:47], s68 offen lds
    s_add_u32 m0, s65, 99328
    s_nop 0
    buffer_load_dwordx4 v27, s[44:47], s68 offen lds
    s_add_u32 m0, s65, 106496
    s_nop 0
    buffer_load_dwordx4 v26, s[48:51], s68 offen lds
    s_add_u32 m0, s65, 107520
    s_nop 0
    buffer_load_dwordx4 v27, s[48:51], s68 offen lds
    s_waitcnt vmcnt(11)
    s_barrier
    s_mov_b32 s67, 14336
    s_add_u32 m0, s64, 32768
    s_nop 0
    buffer_load_dwordx4 v4, s[40:43], s67 offen sc1 lds
    s_add_u32 m0, s64, 36864
    s_nop 0
    buffer_load_dwordx4 v5, s[40:43], s67 offen sc1 lds
    s_add_u32 m0, s64, 40960
    s_nop 0
    buffer_load_dwordx4 v6, s[40:43], s67 offen sc1 lds
    s_add_u32 m0, s64, 45056
    s_nop 0
    buffer_load_dwordx4 v7, s[40:43], s67 offen sc1 lds
    s_add_u32 m0, s64, 49152
    s_nop 0
    buffer_load_dwordx4 v8, s[40:43], s67 offen sc1 lds
    s_add_u32 m0, s64, 53248
    s_nop 0
    buffer_load_dwordx4 v9, s[40:43], s67 offen sc1 lds
    s_add_u32 m0, s64, 57344
    s_nop 0
    buffer_load_dwordx4 v10, s[40:43], s67 offen sc1 lds
    s_mov_b32 s68, 1548288
    s_add_u32 m0, s65, 114688
    s_nop 0
    buffer_load_dwordx4 v26, s[44:47], s68 offen lds
    s_add_u32 m0, s65, 115712
    s_nop 0
    buffer_load_dwordx4 v27, s[44:47], s68 offen lds
    s_add_u32 m0, s65, 122880
    s_nop 0
    buffer_load_dwordx4 v26, s[48:51], s68 offen lds
    s_add_u32 m0, s65, 123904
    s_nop 0
    buffer_load_dwordx4 v27, s[48:51], s68 offen lds
    s_waitcnt vmcnt(11)
    s_barrier
    s_mov_b32 s67, 16384
    s_add_u32 m0, s64, 65536
    s_nop 0
    buffer_load_dwordx4 v4, s[40:43], s67 offen sc1 lds
    s_add_u32 m0, s64, 69632
    s_nop 0
    buffer_load_dwordx4 v5, s[40:43], s67 offen sc1 lds
    s_add_u32 m0, s64, 73728
    s_nop 0
    buffer_load_dwordx4 v6, s[40:43], s67 offen sc1 lds
    s_add_u32 m0, s64, 77824
    s_nop 0
    buffer_load_dwordx4 v7, s[40:43], s67 offen sc1 lds
    s_add_u32 m0, s64, 81920
    s_nop 0
    buffer_load_dwordx4 v8, s[40:43], s67 offen sc1 lds
    s_add_u32 m0, s64, 86016
    s_nop 0
    buffer_load_dwordx4 v9, s[40:43], s67 offen sc1 lds
    s_add_u32 m0, s64, 90112
    s_nop 0
    buffer_load_dwordx4 v10, s[40:43], s67 offen sc1 lds
    s_mov_b32 s68, 1769472
    s_add_u32 m0, s65, 131072
    s_nop 0
    buffer_load_dwordx4 v26, s[44:47], s68 offen lds
    s_add_u32 m0, s65, 132096
    s_nop 0
    buffer_load_dwordx4 v27, s[44:47], s68 offen lds
    s_add_u32 m0, s65, 139264
    s_nop 0
    buffer_load_dwordx4 v26, s[48:51], s68 offen lds
    s_add_u32 m0, s65, 140288
    s_nop 0
    buffer_load_dwordx4 v27, s[48:51], s68 offen lds
    s_waitcnt vmcnt(11)
    s_barrier
    s_mov_b32 s67, 18432
    s_add_u32 m0, s64, 0
    s_nop 0
    buffer_load_dwordx4 v4, s[40:43], s67 offen sc1 lds
    s_add_u32 m0, s64, 4096
    s_nop 0
    buffer_load_dwordx4 v5, s[40:43], s67 offen sc1 lds
    s_add_u32 m0, s64, 8192
    s_nop 0
    buffer_load_dwordx4 v6, s[40:43], s67 offen sc1 lds
    s_add_u32 m0, s64, 12288
    s_nop 0
    buffer_load_dwordx4 v7, s[40:43], s67 offen sc1 lds
    s_add_u32 m0, s64, 16384
    s_nop 0
    buffer_load_dwordx4 v8, s[40:43], s67 offen sc1 lds
    s_add_u32 m0, s64, 20480
    s_nop 0
    buffer_load_dwordx4 v9, s[40:43], s67 offen sc1 lds
    s_add_u32 m0, s64, 24576
    s_nop 0
    buffer_load_dwordx4 v10, s[40:43], s67 offen sc1 lds
    s_mov_b32 s68, 1990656
    s_add_u32 m0, s65, 98304
    s_nop 0
    buffer_load_dwordx4 v26, s[44:47], s68 offen lds
    s_add_u32 m0, s65, 99328
    s_nop 0
    buffer_load_dwordx4 v27, s[44:47], s68 offen lds
    s_add_u32 m0, s65, 106496
    s_nop 0
    buffer_load_dwordx4 v26, s[48:51], s68 offen lds
    s_add_u32 m0, s65, 107520
    s_nop 0
    buffer_load_dwordx4 v27, s[48:51], s68 offen lds
    s_waitcnt vmcnt(11)
    s_barrier
    s_waitcnt vmcnt(0)
    s_barrier
    s_barrier
    s_branch l4_46
lsmall_48:
    s_mul_i32 s30, s22, 224
    s_lshl_b32 s34, s31, 7
    v_lshrrev_b32 v1, 3, v0
    v_and_b32 v2, 7, v0
    v_lshrrev_b32 v3, 4, v0
    v_lshrrev_b32 v22, 5, v0
    v_lshlrev_b32 v22, 3, v22
    v_and_b32 v23, 3, v1
    v_add_u32 v22, v22, v23
    s_lshr_b32 s36, s35, 1
    s_lshl_b32 s36, s36, 5
    s_and_b32 s37, s35, 1
    s_lshl_b32 s37, s37, 2
    s_add_u32 s36, s36, s37
    v_add_u32 v22, s36, v22
    v_mul_u32_u24 v22, 3456, v22
    v_lshlrev_b32 v23, 1, v3
    v_xor_b32 v23, v2, v23
    v_lshl_add_u32 v26, v23, 4, v22
    v_add_u32 v26, s34, v26
    v_add_u32 v27, 55296, v26
    s_lshl_b32 s64, s35, 10
    s_lshl_b32 s65, s35, 11
    s_mov_b32 s44, s16
    s_mov_b32 s45, s17
    s_mov_b32 s46, 2211840
    s_mov_b32 s47, 0x20000
    s_mov_b32 s48, s18
    s_mov_b32 s49, s19
    s_mov_b32 s50, 2211840
    s_mov_b32 s51, 0x20000
    s_add_u32 s40, s4, 11534336
    s_addc_u32 s41, s5, 0
    s_mov_b32 s42, 2621440
    s_mov_b32 s43, 0x20000
    s_mov_b32 s68, 0
    s_add_u32 m0, s65, 40960
    s_nop 0
    buffer_load_dwordx4 v26, s[44:47], s68 offen lds
    s_add_u32 m0, s65, 41984
    s_nop 0
    buffer_load_dwordx4 v27, s[44:47], s68 offen lds
    s_add_u32 m0, s65, 49152
    s_nop 0
    buffer_load_dwordx4 v26, s[48:51], s68 offen lds
    s_add_u32 m0, s65, 50176
    s_nop 0
    buffer_load_dwordx4 v27, s[48:51], s68 offen lds
    s_mov_b32 s68, 221184
    s_add_u32 m0, s65, 57344
    s_nop 0
    buffer_load_dwordx4 v26, s[44:47], s68 offen lds
    s_add_u32 m0, s65, 58368
    s_nop 0
    buffer_load_dwordx4 v27, s[44:47], s68 offen lds
    s_add_u32 m0, s65, 65536
    s_nop 0
    buffer_load_dwordx4 v26, s[48:51], s68 offen lds
    s_add_u32 m0, s65, 66560
    s_nop 0
    buffer_load_dwordx4 v27, s[48:51], s68 offen lds
    s_mov_b32 s68, 442368
    s_add_u32 m0, s65, 73728
    s_nop 0
    buffer_load_dwordx4 v26, s[44:47], s68 offen lds
    s_add_u32 m0, s65, 74752
    s_nop 0
    buffer_load_dwordx4 v27, s[44:47], s68 offen lds
    s_add_u32 m0, s65, 81920
    s_nop 0
    buffer_load_dwordx4 v26, s[48:51], s68 offen lds
    s_add_u32 m0, s65, 82944
    s_nop 0
    buffer_load_dwordx4 v27, s[48:51], s68 offen lds
    s_mov_b32 s68, 663552
    s_add_u32 m0, s65, 90112
    s_nop 0
    buffer_load_dwordx4 v26, s[44:47], s68 offen lds
    s_add_u32 m0, s65, 91136
    s_nop 0
    buffer_load_dwordx4 v27, s[44:47], s68 offen lds
    s_add_u32 m0, s65, 98304
    s_nop 0
    buffer_load_dwordx4 v26, s[48:51], s68 offen lds
    s_add_u32 m0, s65, 99328
    s_nop 0
    buffer_load_dwordx4 v27, s[48:51], s68 offen lds
    s_mov_b32 s68, 884736
    s_add_u32 m0, s65, 106496
    s_nop 0
    buffer_load_dwordx4 v26, s[44:47], s68 offen lds
    s_add_u32 m0, s65, 107520
    s_nop 0
    buffer_load_dwordx4 v27, s[44:47], s68 offen lds
    s_add_u32 m0, s65, 114688
    s_nop 0
    buffer_load_dwordx4 v26, s[48:51], s68 offen lds
    s_add_u32 m0, s65, 115712
    s_nop 0
    buffer_load_dwordx4 v27, s[48:51], s68 offen lds
    s_mov_b32 s68, 1105920
    s_add_u32 m0, s65, 122880
    s_nop 0
    buffer_load_dwordx4 v26, s[44:47], s68 offen lds
    s_add_u32 m0, s65, 123904
    s_nop 0
    buffer_load_dwordx4 v27, s[44:47], s68 offen lds
    s_add_u32 m0, s65, 131072
    s_nop 0
    buffer_load_dwordx4 v26, s[48:51], s68 offen lds
    s_add_u32 m0, s65, 132096
    s_nop 0
    buffer_load_dwordx4 v27, s[48:51], s68 offen lds
    s_lshr_b32 s36, s35, 1
    s_lshl_b32 s38, s36, 4
    s_add_u32 s38, s38, s30
    s_and_b32 s37, s35, 1
    s_lshl_b32 s37, s37, 10
    s_mul_i32 s39, s38, 1280
    s_add_u32 s39, s39, s37
    v_lshlrev_b32 v3, 4, v0
    v_add_u32 v4, s39, v3
    v_mov_b32 v21, 1073741824
    s_barrier
    s_mov_b32 s67, 0
    s_add_u32 m0, s64, 0
    s_nop 0
    buffer_load_dwordx4 v4, s[40:43], s67 offen sc1 lds
    s_mov_b32 s67, 2048
    s_add_u32 m0, s64, 4096
    s_nop 0
    buffer_load_dwordx4 v4, s[40:43], s67 offen sc1 lds
    s_mov_b32 s67, 4096
    s_add_u32 m0, s64, 8192
    s_nop 0
    buffer_load_dwordx4 v4, s[40:43], s67 offen sc1 lds
    s_mov_b32 s67, 6144
    s_add_u32 m0, s64, 12288
    s_nop 0
    buffer_load_dwordx4 v4, s[40:43], s67 offen sc1 lds
    s_mov_b32 s67, 8192
    s_add_u32 m0, s64, 16384
    s_nop 0
    buffer_load_dwordx4 v4, s[40:43], s67 offen sc1 lds
    s_mov_b32 s67, 10240
    s_add_u32 m0, s64, 20480
    s_nop 0
    buffer_load_dwordx4 v4, s[40:43], s67 offen sc1 lds
    s_mov_b32 s67, 12288
    s_add_u32 m0, s64, 24576
    s_nop 0
    buffer_load_dwordx4 v4, s[40:43], s67 offen sc1 lds
    s_mov_b32 s67, 14336
    s_add_u32 m0, s64, 28672
    s_nop 0
    buffer_load_dwordx4 v4, s[40:43], s67 offen sc1 lds
    s_mov_b32 s67, 16384
    s_add_u32 m0, s64, 32768
    s_nop 0
    buffer_load_dwordx4 v4, s[40:43], s67 offen sc1 lds
    s_mov_b32 s67, 18432
    s_add_u32 m0, s64, 36864
    s_nop 0
    buffer_load_dwordx4 v4, s[40:43], s67 offen sc1 lds
    s_waitcnt vmcnt(9)
    s_barrier
    s_waitcnt vmcnt(8)
    s_barrier
    s_mov_b32 s68, 1327104
    s_add_u32 m0, s65, 40960
    s_nop 0
    buffer_load_dwordx4 v26, s[44:47], s68 offen lds
    s_add_u32 m0, s65, 41984
    s_nop 0
    buffer_load_dwordx4 v27, s[44:47], s68 offen lds
    s_add_u32 m0, s65, 49152
    s_nop 0
    buffer_load_dwordx4 v26, s[48:51], s68 offen lds
    s_add_u32 m0, s65, 50176
    s_nop 0
    buffer_load_dwordx4 v27, s[48:51], s68 offen lds
    s_waitcnt vmcnt(11)
    s_barrier
    s_mov_b32 s68, 1548288
    s_add_u32 m0, s65, 57344
    s_nop 0
    buffer_load_dwordx4 v26, s[44:47], s68 offen lds
    s_add_u32 m0, s65, 58368
    s_nop 0
    buffer_load_dwordx4 v27, s[44:47], s68 offen lds
    s_add_u32 m0, s65, 65536
    s_nop 0
    buffer_load_dwordx4 v26, s[48:51], s68 offen lds
    s_add_u32 m0, s65, 66560
    s_nop 0
    buffer_load_dwordx4 v27, s[48:51], s68 offen lds
    s_waitcnt vmcnt(14)
    s_barrier
    s_mov_b32 s68, 1769472
    s_add_u32 m0, s65, 73728
    s_nop 0
    buffer_load_dwordx4 v26, s[44:47], s68 offen lds
    s_add_u32 m0, s65, 74752
    s_nop 0
    buffer_load_dwordx4 v27, s[44:47], s68 offen lds
    s_add_u32 m0, s65, 81920
    s_nop 0
    buffer_load_dwordx4 v26, s[48:51], s68 offen lds
    s_add_u32 m0, s65, 82944
    s_nop 0
    buffer_load_dwordx4 v27, s[48:51], s68 offen lds
    s_waitcnt vmcnt(17)
    s_barrier
    s_mov_b32 s68, 1990656
    s_add_u32 m0, s65, 90112
    s_nop 0
    buffer_load_dwordx4 v26, s[44:47], s68 offen lds
    s_add_u32 m0, s65, 91136
    s_nop 0
    buffer_load_dwordx4 v27, s[44:47], s68 offen lds
    s_add_u32 m0, s65, 98304
    s_nop 0
    buffer_load_dwordx4 v26, s[48:51], s68 offen lds
    s_add_u32 m0, s65, 99328
    s_nop 0
    buffer_load_dwordx4 v27, s[48:51], s68 offen lds
    s_waitcnt vmcnt(20)
    s_barrier
    s_mov_b32 s68, 128
    s_add_u32 m0, s65, 106496
    s_nop 0
    buffer_load_dwordx4 v26, s[44:47], s68 offen lds
    s_add_u32 m0, s65, 107520
    s_nop 0
    buffer_load_dwordx4 v27, s[44:47], s68 offen lds
    s_add_u32 m0, s65, 114688
    s_nop 0
    buffer_load_dwordx4 v26, s[48:51], s68 offen lds
    s_add_u32 m0, s65, 115712
    s_nop 0
    buffer_load_dwordx4 v27, s[48:51], s68 offen lds
    s_waitcnt vmcnt(16)
    s_barrier
    s_mov_b32 s68, 221312
    s_add_u32 m0, s65, 122880
    s_nop 0
    buffer_load_dwordx4 v26, s[44:47], s68 offen lds
    s_add_u32 m0, s65, 123904
    s_nop 0
    buffer_load_dwordx4 v27, s[44:47], s68 offen lds
    s_add_u32 m0, s65, 131072
    s_nop 0
    buffer_load_dwordx4 v26, s[48:51], s68 offen lds
    s_add_u32 m0, s65, 132096
    s_nop 0
    buffer_load_dwordx4 v27, s[48:51], s68 offen lds
    s_waitcnt vmcnt(16)
    s_barrier
    s_mov_b32 s68, 442496
    s_add_u32 m0, s65, 40960
    s_nop 0
    buffer_load_dwordx4 v26, s[44:47], s68 offen lds
    s_add_u32 m0, s65, 41984
    s_nop 0
    buffer_load_dwordx4 v27, s[44:47], s68 offen lds
    s_add_u32 m0, s65, 49152
    s_nop 0
    buffer_load_dwordx4 v26, s[48:51], s68 offen lds
    s_add_u32 m0, s65, 50176
    s_nop 0
    buffer_load_dwordx4 v27, s[48:51], s68 offen lds
    s_waitcnt vmcnt(16)
    s_barrier
    s_mov_b32 s68, 663680
    s_add_u32 m0, s65, 57344
    s_nop 0
    buffer_load_dwordx4 v26, s[44:47], s68 offen lds
    s_add_u32 m0, s65, 58368
    s_nop 0
    buffer_load_dwordx4 v27, s[44:47], s68 offen lds
    s_add_u32 m0, s65, 65536
    s_nop 0
    buffer_load_dwordx4 v26, s[48:51], s68 offen lds
    s_add_u32 m0, s65, 66560
    s_nop 0
    buffer_load_dwordx4 v27, s[48:51], s68 offen lds
    s_waitcnt vmcnt(16)
    s_barrier
    s_mov_b32 s68, 884864
    s_add_u32 m0, s65, 73728
    s_nop 0
    buffer_load_dwordx4 v26, s[44:47], s68 offen lds
    s_add_u32 m0, s65, 74752
    s_nop 0
    buffer_load_dwordx4 v27, s[44:47], s68 offen lds
    s_add_u32 m0, s65, 81920
    s_nop 0
    buffer_load_dwordx4 v26, s[48:51], s68 offen lds
    s_add_u32 m0, s65, 82944
    s_nop 0
    buffer_load_dwordx4 v27, s[48:51], s68 offen lds
    s_waitcnt vmcnt(16)
    s_barrier
    s_mov_b32 s68, 1106048
    s_add_u32 m0, s65, 90112
    s_nop 0
    buffer_load_dwordx4 v26, s[44:47], s68 offen lds
    s_add_u32 m0, s65, 91136
    s_nop 0
    buffer_load_dwordx4 v27, s[44:47], s68 offen lds
    s_add_u32 m0, s65, 98304
    s_nop 0
    buffer_load_dwordx4 v26, s[48:51], s68 offen lds
    s_add_u32 m0, s65, 99328
    s_nop 0
    buffer_load_dwordx4 v27, s[48:51], s68 offen lds
    s_waitcnt vmcnt(16)
    s_barrier
    s_mov_b32 s68, 1327232
    s_add_u32 m0, s65, 106496
    s_nop 0
    buffer_load_dwordx4 v26, s[44:47], s68 offen lds
    s_add_u32 m0, s65, 107520
    s_nop 0
    buffer_load_dwordx4 v27, s[44:47], s68 offen lds
    s_add_u32 m0, s65, 114688
    s_nop 0
    buffer_load_dwordx4 v26, s[48:51], s68 offen lds
    s_add_u32 m0, s65, 115712
    s_nop 0
    buffer_load_dwordx4 v27, s[48:51], s68 offen lds
    s_waitcnt vmcnt(16)
    s_barrier
    s_mov_b32 s68, 1548416
    s_add_u32 m0, s65, 122880
    s_nop 0
    buffer_load_dwordx4 v26, s[44:47], s68 offen lds
    s_add_u32 m0, s65, 123904
    s_nop 0
    buffer_load_dwordx4 v27, s[44:47], s68 offen lds
    s_add_u32 m0, s65, 131072
    s_nop 0
    buffer_load_dwordx4 v26, s[48:51], s68 offen lds
    s_add_u32 m0, s65, 132096
    s_nop 0
    buffer_load_dwordx4 v27, s[48:51], s68 offen lds
    s_waitcnt vmcnt(16)
    s_barrier
    s_mov_b32 s68, 1769600
    s_add_u32 m0, s65, 40960
    s_nop 0
    buffer_load_dwordx4 v26, s[44:47], s68 offen lds
    s_add_u32 m0, s65, 41984
    s_nop 0
    buffer_load_dwordx4 v27, s[44:47], s68 offen lds
    s_add_u32 m0, s65, 49152
    s_nop 0
    buffer_load_dwordx4 v26, s[48:51], s68 offen lds
    s_add_u32 m0, s65, 50176
    s_nop 0
    buffer_load_dwordx4 v27, s[48:51], s68 offen lds
    s_waitcnt vmcnt(16)
    s_barrier
    s_mov_b32 s68, 1990784
    s_add_u32 m0, s65, 57344
    s_nop 0
    buffer_load_dwordx4 v26, s[44:47], s68 offen lds
    s_add_u32 m0, s65, 58368
    s_nop 0
    buffer_load_dwordx4 v27, s[44:47], s68 offen lds
    s_add_u32 m0, s65, 65536
    s_nop 0
    buffer_load_dwordx4 v26, s[48:51], s68 offen lds
    s_add_u32 m0, s65, 66560
    s_nop 0
    buffer_load_dwordx4 v27, s[48:51], s68 offen lds
    s_waitcnt vmcnt(16)
    s_barrier
    s_mov_b32 s68, 256
    s_add_u32 m0, s65, 73728
    s_nop 0
    buffer_load_dwordx4 v26, s[44:47], s68 offen lds
    s_add_u32 m0, s65, 74752
    s_nop 0
    buffer_load_dwordx4 v27, s[44:47], s68 offen lds
    s_add_u32 m0, s65, 81920
    s_nop 0
    buffer_load_dwordx4 v26, s[48:51], s68 offen lds
    s_add_u32 m0, s65, 82944
    s_nop 0
    buffer_load_dwordx4 v27, s[48:51], s68 offen lds
    s_waitcnt vmcnt(16)
    s_barrier
    s_mov_b32 s68, 221440
    s_add_u32 m0, s65, 90112
    s_nop 0
    buffer_load_dwordx4 v26, s[44:47], s68 offen lds
    s_add_u32 m0, s65, 91136
    s_nop 0
    buffer_load_dwordx4 v27, s[44:47], s68 offen lds
    s_add_u32 m0, s65, 98304
    s_nop 0
    buffer_load_dwordx4 v26, s[48:51], s68 offen lds
    s_add_u32 m0, s65, 99328
    s_nop 0
    buffer_load_dwordx4 v27, s[48:51], s68 offen lds
    s_waitcnt vmcnt(16)
    s_barrier
    s_mov_b32 s68, 442624
    s_add_u32 m0, s65, 106496
    s_nop 0
    buffer_load_dwordx4 v26, s[44:47], s68 offen lds
    s_add_u32 m0, s65, 107520
    s_nop 0
    buffer_load_dwordx4 v27, s[44:47], s68 offen lds
    s_add_u32 m0, s65, 114688
    s_nop 0
    buffer_load_dwordx4 v26, s[48:51], s68 offen lds
    s_add_u32 m0, s65, 115712
    s_nop 0
    buffer_load_dwordx4 v27, s[48:51], s68 offen lds
    s_waitcnt vmcnt(16)
    s_barrier
    s_mov_b32 s68, 663808
    s_add_u32 m0, s65, 122880
    s_nop 0
    buffer_load_dwordx4 v26, s[44:47], s68 offen lds
    s_add_u32 m0, s65, 123904
    s_nop 0
    buffer_load_dwordx4 v27, s[44:47], s68 offen lds
    s_add_u32 m0, s65, 131072
    s_nop 0
    buffer_load_dwordx4 v26, s[48:51], s68 offen lds
    s_add_u32 m0, s65, 132096
    s_nop 0
    buffer_load_dwordx4 v27, s[48:51], s68 offen lds
    s_waitcnt vmcnt(16)
    s_barrier
    s_mov_b32 s68, 884992
    s_add_u32 m0, s65, 40960
    s_nop 0
    buffer_load_dwordx4 v26, s[44:47], s68 offen lds
    s_add_u32 m0, s65, 41984
    s_nop 0
    buffer_load_dwordx4 v27, s[44:47], s68 offen lds
    s_add_u32 m0, s65, 49152
    s_nop 0
    buffer_load_dwordx4 v26, s[48:51], s68 offen lds
    s_add_u32 m0, s65, 50176
    s_nop 0
    buffer_load_dwordx4 v27, s[48:51], s68 offen lds
    s_waitcnt vmcnt(16)
    s_barrier
    s_mov_b32 s68, 1106176
    s_add_u32 m0, s65, 57344
    s_nop 0
    buffer_load_dwordx4 v26, s[44:47], s68 offen lds
    s_add_u32 m0, s65, 58368
    s_nop 0
    buffer_load_dwordx4 v27, s[44:47], s68 offen lds
    s_add_u32 m0, s65, 65536
    s_nop 0
    buffer_load_dwordx4 v26, s[48:51], s68 offen lds
    s_add_u32 m0, s65, 66560
    s_nop 0
    buffer_load_dwordx4 v27, s[48:51], s68 offen lds
    s_waitcnt vmcnt(16)
    s_barrier
    s_mov_b32 s68, 1327360
    s_add_u32 m0, s65, 73728
    s_nop 0
    buffer_load_dwordx4 v26, s[44:47], s68 offen lds
    s_add_u32 m0, s65, 74752
    s_nop 0
    buffer_load_dwordx4 v27, s[44:47], s68 offen lds
    s_add_u32 m0, s65, 81920
    s_nop 0
    buffer_load_dwordx4 v26, s[48:51], s68 offen lds
    s_add_u32 m0, s65, 82944
    s_nop 0
    buffer_load_dwordx4 v27, s[48:51], s68 offen lds
    s_waitcnt vmcnt(16)
    s_barrier
    s_mov_b32 s68, 1548544
    s_add_u32 m0, s65, 90112
    s_nop 0
    buffer_load_dwordx4 v26, s[44:47], s68 offen lds
    s_add_u32 m0, s65, 91136
    s_nop 0
    buffer_load_dwordx4 v27, s[44:47], s68 offen lds
    s_add_u32 m0, s65, 98304
    s_nop 0
    buffer_load_dwordx4 v26, s[48:51], s68 offen lds
    s_add_u32 m0, s65, 99328
    s_nop 0
    buffer_load_dwordx4 v27, s[48:51], s68 offen lds
    s_waitcnt vmcnt(16)
    s_barrier
    s_mov_b32 s68, 1769728
    s_add_u32 m0, s65, 106496
    s_nop 0
    buffer_load_dwordx4 v26, s[44:47], s68 offen lds
    s_add_u32 m0, s65, 107520
    s_nop 0
    buffer_load_dwordx4 v27, s[44:47], s68 offen lds
    s_add_u32 m0, s65, 114688
    s_nop 0
    buffer_load_dwordx4 v26, s[48:51], s68 offen lds
    s_add_u32 m0, s65, 115712
    s_nop 0
    buffer_load_dwordx4 v27, s[48:51], s68 offen lds
    s_waitcnt vmcnt(16)
    s_barrier
    s_mov_b32 s68, 1990912
    s_add_u32 m0, s65, 122880
    s_nop 0
    buffer_load_dwordx4 v26, s[44:47], s68 offen lds
    s_add_u32 m0, s65, 123904
    s_nop 0
    buffer_load_dwordx4 v27, s[44:47], s68 offen lds
    s_add_u32 m0, s65, 131072
    s_nop 0
    buffer_load_dwordx4 v26, s[48:51], s68 offen lds
    s_add_u32 m0, s65, 132096
    s_nop 0
    buffer_load_dwordx4 v27, s[48:51], s68 offen lds
    s_waitcnt vmcnt(16)
    s_barrier
    s_waitcnt vmcnt(12)
    s_barrier
    s_waitcnt vmcnt(8)
    s_barrier
    s_waitcnt vmcnt(4)
    s_barrier
    s_waitcnt vmcnt(0)
    s_barrier
    s_barrier
l4_46:
    s_cmp_ge_u32 s21, 30
    s_cbranch_scc1 lx_47
    s_lshl_b32 s65, s35, 11
    s_mov_b32 s68, 0
    s_add_u32 m0, s65, 0
    s_nop 0
    buffer_load_dwordx4 v28, s[56:59], s68 offen lds
    s_add_u32 m0, s65, 1024
    s_nop 0
    buffer_load_dwordx4 v29, s[56:59], s68 offen lds
    s_mov_b32 s68, 81920
    s_add_u32 m0, s65, 8192
    s_nop 0
    buffer_load_dwordx4 v28, s[56:59], s68 offen lds
    s_add_u32 m0, s65, 9216
    s_nop 0
    buffer_load_dwordx4 v29, s[56:59], s68 offen lds
    s_mov_b32 s68, 163840
    s_add_u32 m0, s65, 16384
    s_nop 0
    buffer_load_dwordx4 v28, s[56:59], s68 offen lds
    s_add_u32 m0, s65, 17408
    s_nop 0
    buffer_load_dwordx4 v29, s[56:59], s68 offen lds
    s_mov_b32 s68, 245760
    s_add_u32 m0, s65, 24576
    s_nop 0
    buffer_load_dwordx4 v28, s[56:59], s68 offen lds
    s_add_u32 m0, s65, 25600
    s_nop 0
    buffer_load_dwordx4 v29, s[56:59], s68 offen lds
    s_mov_b32 s68, 327680
    s_add_u32 m0, s65, 32768
    s_nop 0
    buffer_load_dwordx4 v28, s[56:59], s68 offen lds
    s_add_u32 m0, s65, 33792
    s_nop 0
    buffer_load_dwordx4 v29, s[56:59], s68 offen lds
    s_mov_b32 s68, 409600
    s_add_u32 m0, s65, 40960
    s_nop 0
    buffer_load_dwordx4 v28, s[56:59], s68 offen lds
    s_add_u32 m0, s65, 41984
    s_nop 0
    buffer_load_dwordx4 v29, s[56:59], s68 offen lds
    s_mov_b32 s68, 491520
    s_add_u32 m0, s65, 49152
    s_nop 0
    buffer_load_dwordx4 v28, s[56:59], s68 offen lds
    s_add_u32 m0, s65, 50176
    s_nop 0
    buffer_load_dwordx4 v29, s[56:59], s68 offen lds
    s_mov_b32 s68, 573440
    s_add_u32 m0, s65, 57344
    s_nop 0
    buffer_load_dwordx4 v28, s[56:59], s68 offen lds
    s_add_u32 m0, s65, 58368
    s_nop 0
    buffer_load_dwordx4 v29, s[56:59], s68 offen lds
    s_mov_b32 s68, 655360
    s_add_u32 m0, s65, 65536
    s_nop 0
    buffer_load_dwordx4 v28, s[56:59], s68 offen lds
    s_add_u32 m0, s65, 66560
    s_nop 0
    buffer_load_dwordx4 v29, s[56:59], s68 offen lds
    v_lshlrev_b32 v26, 4, v0
    v_add_u32 v26, s65, v26
    v_add_u32 v27, 32768, v26
    v_add_u32 v25, 139264, v26
    ds_write_b128 v25, v[112:115] offset:0
    ds_write_b128 v25, v[116:119] offset:1024
    v_add_u32 v25, 131072, v26
    ds_write_b128 v25, v[120:123] offset:0
    ds_write_b128 v25, v[124:127] offset:1024
    v_add_u32 v25, 122880, v26
    ds_write_b128 v25, v[128:131] offset:0
    ds_write_b128 v25, v[132:135] offset:1024
    v_add_u32 v25, 114688, v26
    ds_write_b128 v25, v[136:139] offset:0
    ds_write_b128 v25, v[140:143] offset:1024
    v_add_u32 v25, 106496, v26
    ds_write_b128 v25, v[144:147] offset:0
    ds_write_b128 v25, v[148:151] offset:1024
    v_add_u32 v25, 98304, v26
    ds_write_b128 v25, v[152:155] offset:0
    ds_write_b128 v25, v[156:159] offset:1024
    v_add_u32 v25, 90112, v26
    ds_write_b128 v25, v[160:163] offset:0
    ds_write_b128 v25, v[164:167] offset:1024
    v_add_u32 v25, 81920, v26
    ds_write_b128 v25, v[168:171] offset:0
    ds_write_b128 v25, v[172:175] offset:1024
    v_add_u32 v25, 73728, v26
    ds_write_b128 v25, v[176:179] offset:0
    ds_write_b128 v25, v[180:183] offset:1024
    s_waitcnt vmcnt(0) lgkmcnt(0)
    s_barrier
    s_barrier
    ds_write_b128 v26, v[40:43] offset:0
    ds_write_b128 v26, v[44:47] offset:1024
    ds_write_b128 v26, v[48:51] offset:8192
    ds_write_b128 v26, v[52:55] offset:9216
    ds_write_b128 v26, v[56:59] offset:16384
    ds_write_b128 v26, v[60:63] offset:17408
    ds_write_b128 v26, v[64:67] offset:24576
    ds_write_b128 v26, v[68:71] offset:25600
    ds_write_b128 v27, v[72:75] offset:0
    ds_write_b128 v27, v[76:79] offset:1024
    ds_write_b128 v27, v[80:83] offset:8192
    ds_write_b128 v27, v[84:87] offset:9216
    ds_write_b128 v27, v[88:91] offset:16384
    ds_write_b128 v27, v[92:95] offset:17408
    ds_write_b128 v27, v[96:99] offset:24576
    ds_write_b128 v27, v[100:103] offset:25600
    ds_write_b128 v27, v[104:107] offset:32768
    ds_write_b128 v27, v[108:111] offset:33792
    s_waitcnt vmcnt(0) lgkmcnt(0)
    s_barrier
lx_47:
end_1:
    s_endpgm
lslow_3:
    s_waitcnt vmcnt(5)
    ds_write_b8 v12, v14 offset:4
    s_waitcnt vmcnt(0)
    ds_write_b8 v12, v14 offset:8
lpoll_5:
    ds_read_b32 v15, v13 offset:128
    s_waitcnt lgkmcnt(0)
    v_readfirstlane_b32 s70, v15
    s_nop 0
    s_cmp_eq_u32 s70, 16843009
    s_cbranch_scc1 lback_4
    s_sleep 1
    s_branch lpoll_5
lslow_6:
    s_waitcnt vmcnt(5)
    ds_write_b8 v12, v14 offset:20
    s_waitcnt vmcnt(0)
    ds_write_b8 v12, v14 offset:24
lpoll_8:
    ds_read_b32 v15, v13 offset:160
    s_waitcnt lgkmcnt(0)
    v_readfirstlane_b32 s70, v15
    s_nop 0
    s_cmp_eq_u32 s70, 16843009
    s_cbranch_scc1 lback_7
    s_sleep 1
    s_branch lpoll_8
lslow_9:
    s_waitcnt vmcnt(5)
    ds_write_b8 v12, v14 offset:24
    s_waitcnt vmcnt(0)
    ds_write_b8 v12, v14 offset:28
lpoll_11:
    ds_read_b32 v15, v13 offset:164
    s_waitcnt lgkmcnt(0)
    v_readfirstlane_b32 s70, v15
    s_nop 0
    s_cmp_eq_u32 s70, 16843009
    s_cbranch_scc1 lback_10
    s_sleep 1
    s_branch lpoll_11
lslow_12:
    s_waitcnt vmcnt(5)
    ds_write_b8 v12, v14 offset:28
    s_waitcnt vmcnt(0)
    ds_write_b8 v12, v14 offset:32
lpoll_14:
    ds_read_b32 v15, v13 offset:168
    s_waitcnt lgkmcnt(0)
    v_readfirstlane_b32 s70, v15
    s_nop 0
    s_cmp_eq_u32 s70, 16843009
    s_cbranch_scc1 lback_13
    s_sleep 1
    s_branch lpoll_14
lslow_15:
    s_waitcnt vmcnt(5)
    ds_write_b8 v12, v14 offset:32
    s_waitcnt vmcnt(0)
    ds_write_b8 v12, v14 offset:36
lpoll_17:
    ds_read_b32 v15, v13 offset:172
    s_waitcnt lgkmcnt(0)
    v_readfirstlane_b32 s70, v15
    s_nop 0
    s_cmp_eq_u32 s70, 16843009
    s_cbranch_scc1 lback_16
    s_sleep 1
    s_branch lpoll_17
lslow_18:
    s_waitcnt vmcnt(0)
    ds_write_b8 v12, v14 offset:40
lpoll_20:
    ds_read_b32 v15, v13 offset:180
    s_waitcnt lgkmcnt(0)
    v_readfirstlane_b32 s70, v15
    s_nop 0
    s_cmp_eq_u32 s70, 16843009
    s_cbranch_scc1 lback_19
    s_sleep 1
    s_branch lpoll_20
lslow_21:
    s_waitcnt vmcnt(5)
    ds_write_b8 v12, v14 offset:40
    s_waitcnt vmcnt(0)
    ds_write_b8 v12, v14 offset:44
lpoll_23:
    ds_read_b32 v15, v13 offset:184
    s_waitcnt lgkmcnt(0)
    v_readfirstlane_b32 s70, v15
    s_nop 0
    s_cmp_eq_u32 s70, 16843009
    s_cbranch_scc1 lback_22
    s_sleep 1
    s_branch lpoll_23
lslow_24:
    s_waitcnt vmcnt(5)
    ds_write_b8 v12, v14 offset:44
    s_waitcnt vmcnt(0)
    ds_write_b8 v12, v14 offset:48
lpoll_26:
    ds_read_b32 v15, v13 offset:188
    s_waitcnt lgkmcnt(0)
    v_readfirstlane_b32 s70, v15
    s_nop 0
    s_cmp_eq_u32 s70, 16843009
    s_cbranch_scc1 lback_25
    s_sleep 1
    s_branch lpoll_26
lslow_27:
    s_waitcnt vmcnt(5)
    ds_write_b8 v12, v14 offset:48
    s_waitcnt vmcnt(0)
    ds_write_b8 v12, v14 offset:52
lpoll_29:
    ds_read_b32 v15, v13 offset:192
    s_waitcnt lgkmcnt(0)
    v_readfirstlane_b32 s70, v15
    s_nop 0
    s_cmp_eq_u32 s70, 16843009
    s_cbranch_scc1 lback_28
    s_sleep 1
    s_branch lpoll_29
comp_2:
    v_mov_b32 v17, 147456
    v_add_u32 v16, s35, v17
    v_mov_b32 v18, 1
    v_lshl_add_u32 v19, v0, 2, v17
    v_mov_b32 v18, 0
    ds_write_b32 v19, v18
    s_waitcnt lgkmcnt(0)
    v_mov_b32 v18, 1
    v_mov_b32 v15, 1073741824
    s_getpc_b64 s[76:77]
code_pc_anchor:
    s_sub_u32 s76, s76, code_pc_anchor-code_begin
    s_subb_u32 s77, s77, 0
    s_mov_b32 s78, code_end-code_begin
    s_mov_b32 s79, 0x20000
    s_lshl_b32 s36, s21, 2
    s_add_u32 s36, s36, s35
    s_lshl_b32 s36, s36, 7
    v_lshlrev_b32 v11, 14, v0
    v_cmp_gt_u32 vcc, 8, v0
    s_nop 1
    v_cndmask_b32 v11, v15, v11, vcc
    buffer_load_dword v1, v11, s[76:79], s36 offen
    v_and_b32 v2, 15, v0
    v_lshrrev_b32 v3, 4, v0
    v_lshrrev_b32 v8, 1, v2
    v_xor_b32 v8, v3, v8
    v_lshlrev_b32 v8, 4, v8
    v_lshl_add_u32 v4, v2, 7, v8
    s_lshl_b32 s36, s35, 11
    s_add_u32 s36, s36, 61440
    v_add_u32 v4, s36, v4
    v_xor_b32 v5, 64, v4
    v_add_u32 v6, 40960, v4
    v_add_u32 v7, 40960, v5
    v_lshrrev_b32 v11, 5, v0
    v_lshlrev_b32 v11, 4, v11
    v_bfe_u32 v12, v0, 4, 1
    v_lshl_add_u32 v11, v12, 2, v11
    v_bfe_u32 v12, v0, 2, 2
    v_add_u32 v11, v11, v12
    v_mul_u32_u24 v11, 160, v11
    v_and_b32 v12, 3, v0
    v_mul_u32_u24 v12, 40, v12
    v_add_u32 v8, v11, v12
    v_add_u32 v9, 61440, v8
    v_add_u32 v10, 122880, v8
    v_and_b32 v11, 3, v0
    v_cmp_eq_u32 vcc, v11, v3
    v_mul_u32_u24 v11, 800, v3
    v_bfe_u32 v12, v0, 2, 2
    v_mul_u32_u24 v12, 40, v12
    v_add3_u32 v11, v11, v12, 0
    v_add_u32 v11, 143360, v11
    v_mov_b32 v12, 146560
    v_cndmask_b32 v11, v12, v11, vcc
    s_waitcnt lgkmcnt(0)
    s_add_u32 s44, s4, 15728640
    s_addc_u32 s45, s5, 0
    s_mov_b32 s46, 335872
    s_mov_b32 s47, 0x20000
    v_mov_b32 v20, 0
    buffer_load_dword v248, v20, s[44:47], 0 offen sc1
    s_add_u32 s56, s4, 3145728
    s_addc_u32 s57, s5, 0
    s_mov_b32 s58, 2359296
    s_mov_b32 s59, 0x20000
    s_add_u32 s60, s4, 8388608
    s_addc_u32 s61, s5, 0
    s_mov_b32 s62, 2621440
    s_mov_b32 s63, 0x20000
    s_lshl_b32 s36, s35, 4
    v_add_u32 v22, s36, v2
    v_mul_u32_u24 v249, 80, v22
    v_mul_u32_u24 v13, 5120, v3
    v_add3_u32 v249, v249, v13, 0
    v_add_u32 v249, 81920, v249
    v_mul_u32_u24 v250, 48, v22
    v_mul_u32_u24 v13, 3072, v3
    v_add3_u32 v250, v250, v13, 0
    v_add_u32 v250, 147712, v250
    v_bfe_u32 v12, v0, 2, 2
    v_lshl_add_u32 v12, v3, 3, v12
    v_and_b32 v13, 3, v0
    v_lshlrev_b32 v13, 3, v13
    s_mul_i32 s38, s35, 5120
    s_add_u32 s38, s38, 81920
    s_mul_i32 s37, s35, 3072
    s_add_u32 s37, s37, 147712
    v_mul_u32_u24 v251, 80, v12
    v_add3_u32 v251, v251, v13, s38
    v_mul_u32_u24 v252, 48, v12
    v_add3_u32 v252, v252, v13, s37
    s_lshl_b32 s68, s31, 5
    s_add_u32 s68, s68, s30
    s_mul_i32 s68, s68, 9216
    s_mul_i32 s37, s35, 2240
    s_add_u32 s68, s68, s37
    v_mul_u32_u24 v21, 80, v2
    v_lshl_add_u32 v21, v3, 3, v21
    v_add_u32 v21, s38, v21
    v_cmp_gt_u32 s[50:51], 5, v2
    v_cmp_gt_u32 s[52:53], 2, v3
    s_nop 0
    s_and_b64 s[54:55], s[50:51], s[52:53]
    v_mul_u32_u24 v253, 12, v0
    v_add_u32 v253, s38, v253
    v_lshlrev_b32 v254, 4, v0
    v_cmp_gt_u32 vcc, 12, v0
    s_nop 1
    v_cndmask_b32 v255, v15, v254, vcc
    s_barrier
    ds_read_b32 v19, v17 offset:60
    s_waitcnt lgkmcnt(0)
    v_readfirstlane_b32 s70, v19
    s_nop 0
    s_cmp_eq_u32 s70, 16843009
    s_cbranch_scc0 slow_50
back_51:
    s_waitcnt vmcnt(0)
    v_add_u32 v248, 1, v248
    s_nop 0
    v_readfirstlane_b32 s33, v248
    ds_read_b128 v[24:27], v4 offset:0
    ds_read_b128 v[28:31], v5 offset:0
    ds_read_b128 v[32:35], v4 offset:8192
    ds_read_b128 v[36:39], v5 offset:8192
    ds_read_b128 v[40:43], v4 offset:16384
    ds_read_b128 v[44:47], v5 offset:16384
    ds_read_b128 v[48:51], v4 offset:24576
    ds_read_b128 v[52:55], v5 offset:24576
    ds_read_b128 v[56:59], v4 offset:32768
    ds_read_b128 v[60:63], v5 offset:32768
    ds_read_b128 v[64:67], v6 offset:0
    ds_read_b128 v[68:71], v7 offset:0
    ds_read_b128 v[72:75], v6 offset:8192
    ds_read_b128 v[76:79], v7 offset:8192
    ds_read_b128 v[80:83], v6 offset:16384
    ds_read_b128 v[84:87], v7 offset:16384
    ds_read_b128 v[88:91], v6 offset:24576
    ds_read_b128 v[92:95], v7 offset:24576
    ds_read_b128 v[96:99], v6 offset:32768
    ds_read_b128 v[100:103], v7 offset:32768
    v_mov_b32 v20, 0x3f803f80
    v_mov_b32 v228, 0
    v_mov_b32 v229, 0
    v_mov_b32 v230, 0
    v_mov_b32 v231, 0
    s_waitcnt lgkmcnt(15)
    v_dot2c_f32_bf16 v228, v24, v20
    v_dot2c_f32_bf16 v229, v25, v20
    v_dot2c_f32_bf16 v230, v26, v20
    v_dot2c_f32_bf16 v231, v27, v20
    v_dot2c_f32_bf16 v228, v28, v20
    v_dot2c_f32_bf16 v229, v29, v20
    v_dot2c_f32_bf16 v230, v30, v20
    v_dot2c_f32_bf16 v231, v31, v20
    v_dot2c_f32_bf16 v228, v32, v20
    v_dot2c_f32_bf16 v229, v33, v20
    v_dot2c_f32_bf16 v230, v34, v20
    v_dot2c_f32_bf16 v231, v35, v20
    v_dot2c_f32_bf16 v228, v36, v20
    v_dot2c_f32_bf16 v229, v37, v20
    v_dot2c_f32_bf16 v230, v38, v20
    v_dot2c_f32_bf16 v231, v39, v20
    s_waitcnt lgkmcnt(12)
    v_dot2c_f32_bf16 v228, v40, v20
    v_dot2c_f32_bf16 v229, v41, v20
    v_dot2c_f32_bf16 v230, v42, v20
    v_dot2c_f32_bf16 v231, v43, v20
    v_dot2c_f32_bf16 v228, v44, v20
    v_dot2c_f32_bf16 v229, v45, v20
    v_dot2c_f32_bf16 v230, v46, v20
    v_dot2c_f32_bf16 v231, v47, v20
    v_dot2c_f32_bf16 v228, v48, v20
    v_dot2c_f32_bf16 v229, v49, v20
    v_dot2c_f32_bf16 v230, v50, v20
    v_dot2c_f32_bf16 v231, v51, v20
    v_dot2c_f32_bf16 v228, v52, v20
    v_dot2c_f32_bf16 v229, v53, v20
    v_dot2c_f32_bf16 v230, v54, v20
    v_dot2c_f32_bf16 v231, v55, v20
    s_waitcnt lgkmcnt(8)
    v_dot2c_f32_bf16 v228, v56, v20
    v_dot2c_f32_bf16 v229, v57, v20
    v_dot2c_f32_bf16 v230, v58, v20
    v_dot2c_f32_bf16 v231, v59, v20
    v_dot2c_f32_bf16 v228, v60, v20
    v_dot2c_f32_bf16 v229, v61, v20
    v_dot2c_f32_bf16 v230, v62, v20
    v_dot2c_f32_bf16 v231, v63, v20
    v_dot2c_f32_bf16 v228, v64, v20
    v_dot2c_f32_bf16 v229, v65, v20
    v_dot2c_f32_bf16 v230, v66, v20
    v_dot2c_f32_bf16 v231, v67, v20
    v_dot2c_f32_bf16 v228, v68, v20
    v_dot2c_f32_bf16 v229, v69, v20
    v_dot2c_f32_bf16 v230, v70, v20
    v_dot2c_f32_bf16 v231, v71, v20
    s_waitcnt lgkmcnt(4)
    v_dot2c_f32_bf16 v228, v72, v20
    v_dot2c_f32_bf16 v229, v73, v20
    v_dot2c_f32_bf16 v230, v74, v20
    v_dot2c_f32_bf16 v231, v75, v20
    v_dot2c_f32_bf16 v228, v76, v20
    v_dot2c_f32_bf16 v229, v77, v20
    v_dot2c_f32_bf16 v230, v78, v20
    v_dot2c_f32_bf16 v231, v79, v20
    v_dot2c_f32_bf16 v228, v80, v20
    v_dot2c_f32_bf16 v229, v81, v20
    v_dot2c_f32_bf16 v230, v82, v20
    v_dot2c_f32_bf16 v231, v83, v20
    v_dot2c_f32_bf16 v228, v84, v20
    v_dot2c_f32_bf16 v229, v85, v20
    v_dot2c_f32_bf16 v230, v86, v20
    v_dot2c_f32_bf16 v231, v87, v20
    s_waitcnt lgkmcnt(0)
    v_dot2c_f32_bf16 v228, v88, v20
    v_dot2c_f32_bf16 v229, v89, v20
    v_dot2c_f32_bf16 v230, v90, v20
    v_dot2c_f32_bf16 v231, v91, v20
    ds_write_b8 v16, v18 offset:128
    v_dot2c_f32_bf16 v228, v92, v20
    v_dot2c_f32_bf16 v229, v93, v20
    v_dot2c_f32_bf16 v230, v94, v20
    v_dot2c_f32_bf16 v231, v95, v20
    v_dot2c_f32_bf16 v228, v96, v20
    v_dot2c_f32_bf16 v229, v97, v20
    v_dot2c_f32_bf16 v230, v98, v20
    v_dot2c_f32_bf16 v231, v99, v20
    v_dot2c_f32_bf16 v228, v100, v20
    v_dot2c_f32_bf16 v229, v101, v20
    v_dot2c_f32_bf16 v230, v102, v20
    v_dot2c_f32_bf16 v231, v103, v20
    s_nop 0
    v_add_f32 v228, v228, v229
    s_nop 0
    v_add_f32 v230, v230, v231
    v_add_f32 v228, v228, v230
    v_mov_b32 v229, v228
    s_nop 1
    v_permlane32_swap_b32 v228, v229
    v_add_f32 v228, v228, v229
    v_mov_b32 v229, v228
    s_nop 1
    v_permlane16_swap_b32 v228, v229
    v_add_f32 v228, v228, v229
    v_mul_f32 v12, 3133983949, v228
    s_mov_b32 s40, 0x00003f80
    s_mov_b32 s41, 0x3f800000
    v_dot2_f32_bf16 v232, v24, s40, v12
    v_dot2_f32_bf16 v233, v24, s41, v12
    v_dot2_f32_bf16 v234, v25, s40, v12
    v_dot2_f32_bf16 v235, v25, s41, v12
    v_dot2_f32_bf16 v236, v26, s40, v12
    v_dot2_f32_bf16 v237, v26, s41, v12
    v_cvt_pk_bf16_f32 v24, v232, v233
    v_dot2_f32_bf16 v238, v27, s40, v12
    v_dot2_f32_bf16 v239, v27, s41, v12
    v_cvt_pk_bf16_f32 v25, v234, v235
    v_dot2_f32_bf16 v232, v28, s40, v12
    v_dot2_f32_bf16 v233, v28, s41, v12
    v_cvt_pk_bf16_f32 v26, v236, v237
    v_dot2_f32_bf16 v234, v29, s40, v12
    v_dot2_f32_bf16 v235, v29, s41, v12
    v_cvt_pk_bf16_f32 v27, v238, v239
    v_dot2_f32_bf16 v236, v30, s40, v12
    v_dot2_f32_bf16 v237, v30, s41, v12
    v_cvt_pk_bf16_f32 v28, v232, v233
    v_dot2_f32_bf16 v238, v31, s40, v12
    v_dot2_f32_bf16 v239, v31, s41, v12
    v_cvt_pk_bf16_f32 v29, v234, v235
    v_dot2_f32_bf16 v232, v32, s40, v12
    v_dot2_f32_bf16 v233, v32, s41, v12
    v_cvt_pk_bf16_f32 v30, v236, v237
    v_dot2_f32_bf16 v234, v33, s40, v12
    v_dot2_f32_bf16 v235, v33, s41, v12
    v_cvt_pk_bf16_f32 v31, v238, v239
    v_dot2_f32_bf16 v236, v34, s40, v12
    v_dot2_f32_bf16 v237, v34, s41, v12
    v_cvt_pk_bf16_f32 v32, v232, v233
    v_dot2_f32_bf16 v238, v35, s40, v12
    v_dot2_f32_bf16 v239, v35, s41, v12
    v_cvt_pk_bf16_f32 v33, v234, v235
    v_dot2_f32_bf16 v232, v36, s40, v12
    v_dot2_f32_bf16 v233, v36, s41, v12
    v_cvt_pk_bf16_f32 v34, v236, v237
    v_dot2_f32_bf16 v234, v37, s40, v12
    v_dot2_f32_bf16 v235, v37, s41, v12
    v_cvt_pk_bf16_f32 v35, v238, v239
    v_dot2_f32_bf16 v236, v38, s40, v12
    v_dot2_f32_bf16 v237, v38, s41, v12
    v_cvt_pk_bf16_f32 v36, v232, v233
    v_dot2_f32_bf16 v238, v39, s40, v12
    v_dot2_f32_bf16 v239, v39, s41, v12
    v_cvt_pk_bf16_f32 v37, v234, v235
    v_dot2_f32_bf16 v232, v40, s40, v12
    v_dot2_f32_bf16 v233, v40, s41, v12
    v_cvt_pk_bf16_f32 v38, v236, v237
    v_dot2_f32_bf16 v234, v41, s40, v12
    v_dot2_f32_bf16 v235, v41, s41, v12
    v_cvt_pk_bf16_f32 v39, v238, v239
    v_dot2_f32_bf16 v236, v42, s40, v12
    v_dot2_f32_bf16 v237, v42, s41, v12
    v_cvt_pk_bf16_f32 v40, v232, v233
    v_dot2_f32_bf16 v238, v43, s40, v12
    v_dot2_f32_bf16 v239, v43, s41, v12
    v_cvt_pk_bf16_f32 v41, v234, v235
    v_dot2_f32_bf16 v232, v44, s40, v12
    v_dot2_f32_bf16 v233, v44, s41, v12
    v_cvt_pk_bf16_f32 v42, v236, v237
    v_dot2_f32_bf16 v234, v45, s40, v12
    v_dot2_f32_bf16 v235, v45, s41, v12
    v_cvt_pk_bf16_f32 v43, v238, v239
    v_dot2_f32_bf16 v236, v46, s40, v12
    v_dot2_f32_bf16 v237, v46, s41, v12
    v_cvt_pk_bf16_f32 v44, v232, v233
    v_dot2_f32_bf16 v238, v47, s40, v12
    v_dot2_f32_bf16 v239, v47, s41, v12
    v_cvt_pk_bf16_f32 v45, v234, v235
    v_dot2_f32_bf16 v232, v48, s40, v12
    v_dot2_f32_bf16 v233, v48, s41, v12
    v_cvt_pk_bf16_f32 v46, v236, v237
    v_dot2_f32_bf16 v234, v49, s40, v12
    v_dot2_f32_bf16 v235, v49, s41, v12
    v_cvt_pk_bf16_f32 v47, v238, v239
    v_dot2_f32_bf16 v236, v50, s40, v12
    v_dot2_f32_bf16 v237, v50, s41, v12
    v_cvt_pk_bf16_f32 v48, v232, v233
    v_dot2_f32_bf16 v238, v51, s40, v12
    v_dot2_f32_bf16 v239, v51, s41, v12
    v_cvt_pk_bf16_f32 v49, v234, v235
    v_dot2_f32_bf16 v232, v52, s40, v12
    v_dot2_f32_bf16 v233, v52, s41, v12
    v_cvt_pk_bf16_f32 v50, v236, v237
    v_dot2_f32_bf16 v234, v53, s40, v12
    v_dot2_f32_bf16 v235, v53, s41, v12
    v_cvt_pk_bf16_f32 v51, v238, v239
    v_dot2_f32_bf16 v236, v54, s40, v12
    v_dot2_f32_bf16 v237, v54, s41, v12
    v_cvt_pk_bf16_f32 v52, v232, v233
    v_dot2_f32_bf16 v238, v55, s40, v12
    v_dot2_f32_bf16 v239, v55, s41, v12
    v_cvt_pk_bf16_f32 v53, v234, v235
    v_dot2_f32_bf16 v232, v56, s40, v12
    v_dot2_f32_bf16 v233, v56, s41, v12
    v_cvt_pk_bf16_f32 v54, v236, v237
    v_dot2_f32_bf16 v234, v57, s40, v12
    v_dot2_f32_bf16 v235, v57, s41, v12
    v_cvt_pk_bf16_f32 v55, v238, v239
    v_dot2_f32_bf16 v236, v58, s40, v12
    v_dot2_f32_bf16 v237, v58, s41, v12
    v_cvt_pk_bf16_f32 v56, v232, v233
    v_dot2_f32_bf16 v238, v59, s40, v12
    v_dot2_f32_bf16 v239, v59, s41, v12
    v_cvt_pk_bf16_f32 v57, v234, v235
    v_dot2_f32_bf16 v232, v60, s40, v12
    v_dot2_f32_bf16 v233, v60, s41, v12
    v_cvt_pk_bf16_f32 v58, v236, v237
    v_dot2_f32_bf16 v234, v61, s40, v12
    v_dot2_f32_bf16 v235, v61, s41, v12
    v_cvt_pk_bf16_f32 v59, v238, v239
    v_dot2_f32_bf16 v236, v62, s40, v12
    v_dot2_f32_bf16 v237, v62, s41, v12
    v_cvt_pk_bf16_f32 v60, v232, v233
    v_dot2_f32_bf16 v238, v63, s40, v12
    v_dot2_f32_bf16 v239, v63, s41, v12
    v_cvt_pk_bf16_f32 v61, v234, v235
    v_dot2_f32_bf16 v232, v64, s40, v12
    v_dot2_f32_bf16 v233, v64, s41, v12
    v_cvt_pk_bf16_f32 v62, v236, v237
    v_dot2_f32_bf16 v234, v65, s40, v12
    v_dot2_f32_bf16 v235, v65, s41, v12
    v_cvt_pk_bf16_f32 v63, v238, v239
    v_dot2_f32_bf16 v236, v66, s40, v12
    v_dot2_f32_bf16 v237, v66, s41, v12
    v_cvt_pk_bf16_f32 v64, v232, v233
    v_dot2_f32_bf16 v238, v67, s40, v12
    v_dot2_f32_bf16 v239, v67, s41, v12
    v_cvt_pk_bf16_f32 v65, v234, v235
    v_dot2_f32_bf16 v232, v68, s40, v12
    v_dot2_f32_bf16 v233, v68, s41, v12
    v_cvt_pk_bf16_f32 v66, v236, v237
    v_dot2_f32_bf16 v234, v69, s40, v12
    v_dot2_f32_bf16 v235, v69, s41, v12
    v_cvt_pk_bf16_f32 v67, v238, v239
    v_dot2_f32_bf16 v236, v70, s40, v12
    v_dot2_f32_bf16 v237, v70, s41, v12
    v_cvt_pk_bf16_f32 v68, v232, v233
    v_dot2_f32_bf16 v238, v71, s40, v12
    v_dot2_f32_bf16 v239, v71, s41, v12
    v_cvt_pk_bf16_f32 v69, v234, v235
    v_dot2_f32_bf16 v232, v72, s40, v12
    v_dot2_f32_bf16 v233, v72, s41, v12
    v_cvt_pk_bf16_f32 v70, v236, v237
    v_dot2_f32_bf16 v234, v73, s40, v12
    v_dot2_f32_bf16 v235, v73, s41, v12
    v_cvt_pk_bf16_f32 v71, v238, v239
    v_dot2_f32_bf16 v236, v74, s40, v12
    v_dot2_f32_bf16 v237, v74, s41, v12
    v_cvt_pk_bf16_f32 v72, v232, v233
    v_dot2_f32_bf16 v238, v75, s40, v12
    v_dot2_f32_bf16 v239, v75, s41, v12
    v_cvt_pk_bf16_f32 v73, v234, v235
    v_dot2_f32_bf16 v232, v76, s40, v12
    v_dot2_f32_bf16 v233, v76, s41, v12
    v_cvt_pk_bf16_f32 v74, v236, v237
    v_dot2_f32_bf16 v234, v77, s40, v12
    v_dot2_f32_bf16 v235, v77, s41, v12
    v_cvt_pk_bf16_f32 v75, v238, v239
    v_dot2_f32_bf16 v236, v78, s40, v12
    v_dot2_f32_bf16 v237, v78, s41, v12
    v_cvt_pk_bf16_f32 v76, v232, v233
    v_dot2_f32_bf16 v238, v79, s40, v12
    v_dot2_f32_bf16 v239, v79, s41, v12
    v_cvt_pk_bf16_f32 v77, v234, v235
    v_dot2_f32_bf16 v232, v80, s40, v12
    v_dot2_f32_bf16 v233, v80, s41, v12
    v_cvt_pk_bf16_f32 v78, v236, v237
    v_dot2_f32_bf16 v234, v81, s40, v12
    v_dot2_f32_bf16 v235, v81, s41, v12
    v_cvt_pk_bf16_f32 v79, v238, v239
    v_dot2_f32_bf16 v236, v82, s40, v12
    v_dot2_f32_bf16 v237, v82, s41, v12
    v_cvt_pk_bf16_f32 v80, v232, v233
    v_dot2_f32_bf16 v238, v83, s40, v12
    v_dot2_f32_bf16 v239, v83, s41, v12
    v_cvt_pk_bf16_f32 v81, v234, v235
    v_dot2_f32_bf16 v232, v84, s40, v12
    v_dot2_f32_bf16 v233, v84, s41, v12
    v_cvt_pk_bf16_f32 v82, v236, v237
    v_dot2_f32_bf16 v234, v85, s40, v12
    v_dot2_f32_bf16 v235, v85, s41, v12
    v_cvt_pk_bf16_f32 v83, v238, v239
    v_dot2_f32_bf16 v236, v86, s40, v12
    v_dot2_f32_bf16 v237, v86, s41, v12
    v_cvt_pk_bf16_f32 v84, v232, v233
    v_dot2_f32_bf16 v238, v87, s40, v12
    v_dot2_f32_bf16 v239, v87, s41, v12
    v_cvt_pk_bf16_f32 v85, v234, v235
    v_dot2_f32_bf16 v232, v88, s40, v12
    v_dot2_f32_bf16 v233, v88, s41, v12
    v_cvt_pk_bf16_f32 v86, v236, v237
    v_dot2_f32_bf16 v234, v89, s40, v12
    v_dot2_f32_bf16 v235, v89, s41, v12
    v_cvt_pk_bf16_f32 v87, v238, v239
    v_dot2_f32_bf16 v236, v90, s40, v12
    v_dot2_f32_bf16 v237, v90, s41, v12
    v_cvt_pk_bf16_f32 v88, v232, v233
    v_dot2_f32_bf16 v238, v91, s40, v12
    v_dot2_f32_bf16 v239, v91, s41, v12
    v_cvt_pk_bf16_f32 v89, v234, v235
    v_dot2_f32_bf16 v232, v92, s40, v12
    v_dot2_f32_bf16 v233, v92, s41, v12
    v_cvt_pk_bf16_f32 v90, v236, v237
    v_dot2_f32_bf16 v234, v93, s40, v12
    v_dot2_f32_bf16 v235, v93, s41, v12
    v_cvt_pk_bf16_f32 v91, v238, v239
    v_dot2_f32_bf16 v236, v94, s40, v12
    v_dot2_f32_bf16 v237, v94, s41, v12
    v_cvt_pk_bf16_f32 v92, v232, v233
    ds_read_b32 v19, v17 offset:0
    v_dot2_f32_bf16 v238, v95, s40, v12
    v_dot2_f32_bf16 v239, v95, s41, v12
    v_cvt_pk_bf16_f32 v93, v234, v235
    v_dot2_f32_bf16 v232, v96, s40, v12
    v_dot2_f32_bf16 v233, v96, s41, v12
    v_cvt_pk_bf16_f32 v94, v236, v237
    v_dot2_f32_bf16 v234, v97, s40, v12
    v_dot2_f32_bf16 v235, v97, s41, v12
    v_cvt_pk_bf16_f32 v95, v238, v239
    v_dot2_f32_bf16 v236, v98, s40, v12
    v_dot2_f32_bf16 v237, v98, s41, v12
    v_cvt_pk_bf16_f32 v96, v232, v233
    v_dot2_f32_bf16 v238, v99, s40, v12
    v_dot2_f32_bf16 v239, v99, s41, v12
    v_cvt_pk_bf16_f32 v97, v234, v235
    v_dot2_f32_bf16 v232, v100, s40, v12
    v_dot2_f32_bf16 v233, v100, s41, v12
    v_cvt_pk_bf16_f32 v98, v236, v237
    v_dot2_f32_bf16 v234, v101, s40, v12
    v_dot2_f32_bf16 v235, v101, s41, v12
    v_cvt_pk_bf16_f32 v99, v238, v239
    v_dot2_f32_bf16 v236, v102, s40, v12
    v_dot2_f32_bf16 v237, v102, s41, v12
    v_cvt_pk_bf16_f32 v100, v232, v233
    v_dot2_f32_bf16 v238, v103, s40, v12
    v_dot2_f32_bf16 v239, v103, s41, v12
    v_cvt_pk_bf16_f32 v101, v234, v235
    v_cvt_pk_bf16_f32 v102, v236, v237
    s_nop 0
    v_cvt_pk_bf16_f32 v103, v238, v239
    s_waitcnt lgkmcnt(0)
    v_readfirstlane_b32 s70, v19
    s_nop 0
    s_cmp_eq_u32 s70, 16843009
    s_cbranch_scc0 slow_52
back_53:
    ds_read_b64_tr_b16 v[104:105], v8 offset:0
    ds_read_b64_tr_b16 v[106:107], v8 offset:1280
    ds_read_b64_tr_b16 v[108:109], v8 offset:8
    ds_read_b64_tr_b16 v[110:111], v8 offset:1288
    ds_read_b64_tr_b16 v[112:113], v8 offset:16
    ds_read_b64_tr_b16 v[114:115], v8 offset:1296
    ds_read_b64_tr_b16 v[116:117], v8 offset:24
    ds_read_b64_tr_b16 v[118:119], v8 offset:1304
    ds_read_b64_tr_b16 v[120:121], v8 offset:32
    ds_read_b64_tr_b16 v[122:123], v8 offset:1312
    ds_read_b64_tr_b16 v[124:125], v8 offset:5120
    ds_read_b64_tr_b16 v[126:127], v8 offset:6400
    ds_read_b64_tr_b16 v[128:129], v8 offset:5128
    ds_read_b64_tr_b16 v[130:131], v8 offset:6408
    ds_read_b64_tr_b16 v[132:133], v8 offset:5136
    ds_read_b64_tr_b16 v[134:135], v8 offset:6416
    ds_read_b64_tr_b16 v[136:137], v8 offset:5144
    ds_read_b64_tr_b16 v[138:139], v8 offset:6424
    ds_read_b64_tr_b16 v[140:141], v8 offset:5152
    ds_read_b64_tr_b16 v[142:143], v8 offset:6432
    s_waitcnt lgkmcnt(10)
    ds_read_b64_tr_b16 v[144:145], v8 offset:10240
    ds_read_b64_tr_b16 v[146:147], v8 offset:11520
    v_mfma_f32_16x16x32_bf16 v[204:207], v[24:27], v[24:27], 0
    ds_read_b64_tr_b16 v[148:149], v8 offset:10248
    ds_read_b64_tr_b16 v[150:151], v8 offset:11528
    v_mfma_f32_16x16x32_bf16 v[164:167], v[104:107], v[24:27], 0
    ds_read_b64_tr_b16 v[152:153], v8 offset:10256
    ds_read_b64_tr_b16 v[154:155], v8 offset:11536
    v_mfma_f32_16x16x32_bf16 v[168:171], v[108:111], v[24:27], 0
    ds_read_b64_tr_b16 v[156:157], v8 offset:10264
    ds_read_b64_tr_b16 v[158:159], v8 offset:11544
    v_mfma_f32_16x16x32_bf16 v[172:175], v[112:115], v[24:27], 0
    ds_read_b64_tr_b16 v[160:161], v8 offset:10272
    ds_read_b64_tr_b16 v[162:163], v8 offset:11552
    v_mfma_f32_16x16x32_bf16 v[176:179], v[116:119], v[24:27], 0
    ds_read_b32 v19, v17 offset:4
    v_mfma_f32_16x16x32_bf16 v[180:183], v[120:123], v[24:27], 0
    s_waitcnt lgkmcnt(11)
    ds_read_b64_tr_b16 v[104:105], v8 offset:15360
    ds_read_b64_tr_b16 v[106:107], v8 offset:16640
    v_mfma_f32_16x16x32_bf16 v[204:207], v[28:31], v[28:31], v[204:207]
    ds_read_b64_tr_b16 v[108:109], v8 offset:15368
    ds_read_b64_tr_b16 v[110:111], v8 offset:16648
    v_mfma_f32_16x16x32_bf16 v[164:167], v[124:127], v[28:31], v[164:167]
    ds_read_b64_tr_b16 v[112:113], v8 offset:15376
    ds_read_b64_tr_b16 v[114:115], v8 offset:16656
    v_mfma_f32_16x16x32_bf16 v[168:171], v[128:131], v[28:31], v[168:171]
    ds_read_b64_tr_b16 v[116:117], v8 offset:15384
    ds_read_b64_tr_b16 v[118:119], v8 offset:16664
    v_mfma_f32_16x16x32_bf16 v[172:175], v[132:135], v[28:31], v[172:175]
    ds_read_b64_tr_b16 v[120:121], v8 offset:15392
    ds_read_b64_tr_b16 v[122:123], v8 offset:16672
    v_mfma_f32_16x16x32_bf16 v[176:179], v[136:139], v[28:31], v[176:179]
    v_mfma_f32_16x16x32_bf16 v[180:183], v[140:143], v[28:31], v[180:183]
    s_waitcnt lgkmcnt(10)
    v_readfirstlane_b32 s70, v19
    s_nop 0
    s_cmp_eq_u32 s70, 16843009
    s_cbranch_scc0 slow_54
back_55:
    s_waitcnt lgkmcnt(10)
    ds_read_b64_tr_b16 v[124:125], v8 offset:20480
    ds_read_b64_tr_b16 v[126:127], v8 offset:21760
    v_mfma_f32_16x16x32_bf16 v[204:207], v[32:35], v[32:35], v[204:207]
    ds_read_b64_tr_b16 v[128:129], v8 offset:20488
    ds_read_b64_tr_b16 v[130:131], v8 offset:21768
    v_mfma_f32_16x16x32_bf16 v[164:167], v[144:147], v[32:35], v[164:167]
    ds_read_b64_tr_b16 v[132:133], v8 offset:20496
    ds_read_b64_tr_b16 v[134:135], v8 offset:21776
    v_mfma_f32_16x16x32_bf16 v[168:171], v[148:151], v[32:35], v[168:171]
    ds_read_b64_tr_b16 v[136:137], v8 offset:20504
    ds_read_b64_tr_b16 v[138:139], v8 offset:21784
    v_mfma_f32_16x16x32_bf16 v[172:175], v[152:155], v[32:35], v[172:175]
    ds_read_b64_tr_b16 v[140:141], v8 offset:20512
    ds_read_b64_tr_b16 v[142:143], v8 offset:21792
    v_mfma_f32_16x16x32_bf16 v[176:179], v[156:159], v[32:35], v[176:179]
    v_mfma_f32_16x16x32_bf16 v[180:183], v[160:163], v[32:35], v[180:183]
    s_waitcnt lgkmcnt(10)
    ds_read_b64_tr_b16 v[144:145], v8 offset:25600
    ds_read_b64_tr_b16 v[146:147], v8 offset:26880
    v_mfma_f32_16x16x32_bf16 v[204:207], v[36:39], v[36:39], v[204:207]
    ds_read_b64_tr_b16 v[148:149], v8 offset:25608
    ds_read_b64_tr_b16 v[150:151], v8 offset:26888
    v_mfma_f32_16x16x32_bf16 v[164:167], v[104:107], v[36:39], v[164:167]
    ds_read_b64_tr_b16 v[152:153], v8 offset:25616
    ds_read_b64_tr_b16 v[154:155], v8 offset:26896
    v_mfma_f32_16x16x32_bf16 v[168:171], v[108:111], v[36:39], v[168:171]
    ds_read_b64_tr_b16 v[156:157], v8 offset:25624
    ds_read_b64_tr_b16 v[158:159], v8 offset:26904
    v_mfma_f32_16x16x32_bf16 v[172:175], v[112:115], v[36:39], v[172:175]
    ds_read_b64_tr_b16 v[160:161], v8 offset:25632
    ds_read_b64_tr_b16 v[162:163], v8 offset:26912
    v_mfma_f32_16x16x32_bf16 v[176:179], v[116:119], v[36:39], v[176:179]
    v_mfma_f32_16x16x32_bf16 v[180:183], v[120:123], v[36:39], v[180:183]
    ds_write_b8 v16, v18 offset:160
    s_waitcnt lgkmcnt(10)
    ds_read_b64_tr_b16 v[104:105], v8 offset:30720
    ds_read_b64_tr_b16 v[106:107], v8 offset:32000
    v_mfma_f32_16x16x32_bf16 v[204:207], v[40:43], v[40:43], v[204:207]
    ds_read_b64_tr_b16 v[108:109], v8 offset:30728
    ds_read_b64_tr_b16 v[110:111], v8 offset:32008
    v_mfma_f32_16x16x32_bf16 v[164:167], v[124:127], v[40:43], v[164:167]
    ds_read_b64_tr_b16 v[112:113], v8 offset:30736
    ds_read_b64_tr_b16 v[114:115], v8 offset:32016
    v_mfma_f32_16x16x32_bf16 v[168:171], v[128:131], v[40:43], v[168:171]
    ds_read_b64_tr_b16 v[116:117], v8 offset:30744
    ds_read_b64_tr_b16 v[118:119], v8 offset:32024
    v_mfma_f32_16x16x32_bf16 v[172:175], v[132:135], v[40:43], v[172:175]
    ds_read_b64_tr_b16 v[120:121], v8 offset:30752
    ds_read_b64_tr_b16 v[122:123], v8 offset:32032
    v_mfma_f32_16x16x32_bf16 v[176:179], v[136:139], v[40:43], v[176:179]
    ds_read_b32 v19, v17 offset:8
    v_mfma_f32_16x16x32_bf16 v[180:183], v[140:143], v[40:43], v[180:183]
    s_waitcnt lgkmcnt(11)
    ds_read_b64_tr_b16 v[124:125], v8 offset:35840
    ds_read_b64_tr_b16 v[126:127], v8 offset:37120
    v_mfma_f32_16x16x32_bf16 v[204:207], v[44:47], v[44:47], v[204:207]
    ds_read_b64_tr_b16 v[128:129], v8 offset:35848
    ds_read_b64_tr_b16 v[130:131], v8 offset:37128
    v_mfma_f32_16x16x32_bf16 v[164:167], v[144:147], v[44:47], v[164:167]
    ds_read_b64_tr_b16 v[132:133], v8 offset:35856
    ds_read_b64_tr_b16 v[134:135], v8 offset:37136
    v_mfma_f32_16x16x32_bf16 v[168:171], v[148:151], v[44:47], v[168:171]
    ds_read_b64_tr_b16 v[136:137], v8 offset:35864
    ds_read_b64_tr_b16 v[138:139], v8 offset:37144
    v_mfma_f32_16x16x32_bf16 v[172:175], v[152:155], v[44:47], v[172:175]
    ds_read_b64_tr_b16 v[140:141], v8 offset:35872
    ds_read_b64_tr_b16 v[142:143], v8 offset:37152
    v_mfma_f32_16x16x32_bf16 v[176:179], v[156:159], v[44:47], v[176:179]
    v_mfma_f32_16x16x32_bf16 v[180:183], v[160:163], v[44:47], v[180:183]
    s_waitcnt lgkmcnt(10)
    v_readfirstlane_b32 s70, v19
    s_nop 0
    s_cmp_eq_u32 s70, 16843009
    s_cbranch_scc0 slow_56
back_57:
    s_waitcnt lgkmcnt(10)
    ds_read_b64_tr_b16 v[144:145], v8 offset:40960
    ds_read_b64_tr_b16 v[146:147], v8 offset:42240
    v_mfma_f32_16x16x32_bf16 v[204:207], v[48:51], v[48:51], v[204:207]
    ds_read_b64_tr_b16 v[148:149], v8 offset:40968
    ds_read_b64_tr_b16 v[150:151], v8 offset:42248
    v_mfma_f32_16x16x32_bf16 v[164:167], v[104:107], v[48:51], v[164:167]
    ds_read_b64_tr_b16 v[152:153], v8 offset:40976
    ds_read_b64_tr_b16 v[154:155], v8 offset:42256
    v_mfma_f32_16x16x32_bf16 v[168:171], v[108:111], v[48:51], v[168:171]
    ds_read_b64_tr_b16 v[156:157], v8 offset:40984
    ds_read_b64_tr_b16 v[158:159], v8 offset:42264
    v_mfma_f32_16x16x32_bf16 v[172:175], v[112:115], v[48:51], v[172:175]
    ds_read_b64_tr_b16 v[160:161], v8 offset:40992
    ds_read_b64_tr_b16 v[162:163], v8 offset:42272
    v_mfma_f32_16x16x32_bf16 v[176:179], v[116:119], v[48:51], v[176:179]
    v_mfma_f32_16x16x32_bf16 v[180:183], v[120:123], v[48:51], v[180:183]
    s_waitcnt lgkmcnt(10)
    ds_read_b64_tr_b16 v[104:105], v8 offset:46080
    ds_read_b64_tr_b16 v[106:107], v8 offset:47360
    v_mfma_f32_16x16x32_bf16 v[204:207], v[52:55], v[52:55], v[204:207]
    ds_read_b64_tr_b16 v[108:109], v8 offset:46088
    ds_read_b64_tr_b16 v[110:111], v8 offset:47368
    v_mfma_f32_16x16x32_bf16 v[164:167], v[124:127], v[52:55], v[164:167]
    ds_read_b64_tr_b16 v[112:113], v8 offset:46096
    ds_read_b64_tr_b16 v[114:115], v8 offset:47376
    v_mfma_f32_16x16x32_bf16 v[168:171], v[128:131], v[52:55], v[168:171]
    ds_read_b64_tr_b16 v[116:117], v8 offset:46104
    ds_read_b64_tr_b16 v[118:119], v8 offset:47384
    v_mfma_f32_16x16x32_bf16 v[172:175], v[132:135], v[52:55], v[172:175]
    ds_read_b64_tr_b16 v[120:121], v8 offset:46112
    ds_read_b64_tr_b16 v[122:123], v8 offset:47392
    v_mfma_f32_16x16x32_bf16 v[176:179], v[136:139], v[52:55], v[176:179]
    v_mfma_f32_16x16x32_bf16 v[180:183], v[140:143], v[52:55], v[180:183]
    ds_write_b8 v16, v18 offset:164
    s_waitcnt lgkmcnt(10)
    ds_read_b64_tr_b16 v[124:125], v8 offset:51200
    ds_read_b64_tr_b16 v[126:127], v8 offset:52480
    v_mfma_f32_16x16x32_bf16 v[204:207], v[56:59], v[56:59], v[204:207]
    ds_read_b64_tr_b16 v[128:129], v8 offset:51208
    ds_read_b64_tr_b16 v[130:131], v8 offset:52488
    v_mfma_f32_16x16x32_bf16 v[164:167], v[144:147], v[56:59], v[164:167]
    ds_read_b64_tr_b16 v[132:133], v8 offset:51216
    ds_read_b64_tr_b16 v[134:135], v8 offset:52496
    v_mfma_f32_16x16x32_bf16 v[168:171], v[148:151], v[56:59], v[168:171]
    ds_read_b64_tr_b16 v[136:137], v8 offset:51224
    ds_read_b64_tr_b16 v[138:139], v8 offset:52504
    v_mfma_f32_16x16x32_bf16 v[172:175], v[152:155], v[56:59], v[172:175]
    ds_read_b64_tr_b16 v[140:141], v8 offset:51232
    ds_read_b64_tr_b16 v[142:143], v8 offset:52512
    v_mfma_f32_16x16x32_bf16 v[176:179], v[156:159], v[56:59], v[176:179]
    ds_read_b32 v19, v17 offset:12
    v_mfma_f32_16x16x32_bf16 v[180:183], v[160:163], v[56:59], v[180:183]
    s_waitcnt lgkmcnt(11)
    ds_read_b64_tr_b16 v[144:145], v8 offset:56320
    ds_read_b64_tr_b16 v[146:147], v8 offset:57600
    v_mfma_f32_16x16x32_bf16 v[204:207], v[60:63], v[60:63], v[204:207]
    ds_read_b64_tr_b16 v[148:149], v8 offset:56328
    ds_read_b64_tr_b16 v[150:151], v8 offset:57608
    v_mfma_f32_16x16x32_bf16 v[164:167], v[104:107], v[60:63], v[164:167]
    ds_read_b64_tr_b16 v[152:153], v8 offset:56336
    ds_read_b64_tr_b16 v[154:155], v8 offset:57616
    v_mfma_f32_16x16x32_bf16 v[168:171], v[108:111], v[60:63], v[168:171]
    ds_read_b64_tr_b16 v[156:157], v8 offset:56344
    ds_read_b64_tr_b16 v[158:159], v8 offset:57624
    v_mfma_f32_16x16x32_bf16 v[172:175], v[112:115], v[60:63], v[172:175]
    ds_read_b64_tr_b16 v[160:161], v8 offset:56352
    ds_read_b64_tr_b16 v[162:163], v8 offset:57632
    v_mfma_f32_16x16x32_bf16 v[176:179], v[116:119], v[60:63], v[176:179]
    v_mfma_f32_16x16x32_bf16 v[180:183], v[120:123], v[60:63], v[180:183]
    s_waitcnt lgkmcnt(10)
    v_readfirstlane_b32 s70, v19
    s_nop 0
    s_cmp_eq_u32 s70, 16843009
    s_cbranch_scc0 slow_58
back_59:
    s_waitcnt lgkmcnt(10)
    ds_read_b64_tr_b16 v[104:105], v9 offset:0
    ds_read_b64_tr_b16 v[106:107], v9 offset:1280
    v_mfma_f32_16x16x32_bf16 v[204:207], v[64:67], v[64:67], v[204:207]
    ds_read_b64_tr_b16 v[108:109], v9 offset:8
    ds_read_b64_tr_b16 v[110:111], v9 offset:1288
    v_mfma_f32_16x16x32_bf16 v[164:167], v[124:127], v[64:67], v[164:167]
    ds_read_b64_tr_b16 v[112:113], v9 offset:16
    ds_read_b64_tr_b16 v[114:115], v9 offset:1296
    v_mfma_f32_16x16x32_bf16 v[168:171], v[128:131], v[64:67], v[168:171]
    ds_read_b64_tr_b16 v[116:117], v9 offset:24
    ds_read_b64_tr_b16 v[118:119], v9 offset:1304
    v_mfma_f32_16x16x32_bf16 v[172:175], v[132:135], v[64:67], v[172:175]
    ds_read_b64_tr_b16 v[120:121], v9 offset:32
    ds_read_b64_tr_b16 v[122:123], v9 offset:1312
    v_mfma_f32_16x16x32_bf16 v[176:179], v[136:139], v[64:67], v[176:179]
    v_mfma_f32_16x16x32_bf16 v[180:183], v[140:143], v[64:67], v[180:183]
    s_waitcnt lgkmcnt(10)
    ds_read_b64_tr_b16 v[124:125], v9 offset:5120
    ds_read_b64_tr_b16 v[126:127], v9 offset:6400
    v_mfma_f32_16x16x32_bf16 v[204:207], v[68:71], v[68:71], v[204:207]
    ds_read_b64_tr_b16 v[128:129], v9 offset:5128
    ds_read_b64_tr_b16 v[130:131], v9 offset:6408
    v_mfma_f32_16x16x32_bf16 v[164:167], v[144:147], v[68:71], v[164:167]
    ds_read_b64_tr_b16 v[132:133], v9 offset:5136
    ds_read_b64_tr_b16 v[134:135], v9 offset:6416
    v_mfma_f32_16x16x32_bf16 v[168:171], v[148:151], v[68:71], v[168:171]
    ds_read_b64_tr_b16 v[136:137], v9 offset:5144
    ds_read_b64_tr_b16 v[138:139], v9 offset:6424
    v_mfma_f32_16x16x32_bf16 v[172:175], v[152:155], v[68:71], v[172:175]
    ds_read_b64_tr_b16 v[140:141], v9 offset:5152
    ds_read_b64_tr_b16 v[142:143], v9 offset:6432
    v_mfma_f32_16x16x32_bf16 v[176:179], v[156:159], v[68:71], v[176:179]
    v_mfma_f32_16x16x32_bf16 v[180:183], v[160:163], v[68:71], v[180:183]
    ds_write_b8 v16, v18 offset:168
    s_waitcnt lgkmcnt(10)
    ds_read_b64_tr_b16 v[144:145], v9 offset:10240
    ds_read_b64_tr_b16 v[146:147], v9 offset:11520
    v_mfma_f32_16x16x32_bf16 v[204:207], v[72:75], v[72:75], v[204:207]
    ds_read_b64_tr_b16 v[148:149], v9 offset:10248
    ds_read_b64_tr_b16 v[150:151], v9 offset:11528
    v_mfma_f32_16x16x32_bf16 v[164:167], v[104:107], v[72:75], v[164:167]
    ds_read_b64_tr_b16 v[152:153], v9 offset:10256
    ds_read_b64_tr_b16 v[154:155], v9 offset:11536
    v_mfma_f32_16x16x32_bf16 v[168:171], v[108:111], v[72:75], v[168:171]
    ds_read_b64_tr_b16 v[156:157], v9 offset:10264
    ds_read_b64_tr_b16 v[158:159], v9 offset:11544
    v_mfma_f32_16x16x32_bf16 v[172:175], v[112:115], v[72:75], v[172:175]
    ds_read_b64_tr_b16 v[160:161], v9 offset:10272
    ds_read_b64_tr_b16 v[162:163], v9 offset:11552
    v_mfma_f32_16x16x32_bf16 v[176:179], v[116:119], v[72:75], v[176:179]
    ds_read_b32 v19, v17 offset:16
    v_mfma_f32_16x16x32_bf16 v[180:183], v[120:123], v[72:75], v[180:183]
    s_waitcnt lgkmcnt(11)
    ds_read_b64_tr_b16 v[104:105], v9 offset:15360
    ds_read_b64_tr_b16 v[106:107], v9 offset:16640
    v_mfma_f32_16x16x32_bf16 v[204:207], v[76:79], v[76:79], v[204:207]
    ds_read_b64_tr_b16 v[108:109], v9 offset:15368
    ds_read_b64_tr_b16 v[110:111], v9 offset:16648
    v_mfma_f32_16x16x32_bf16 v[164:167], v[124:127], v[76:79], v[164:167]
    ds_read_b64_tr_b16 v[112:113], v9 offset:15376
    ds_read_b64_tr_b16 v[114:115], v9 offset:16656
    v_mfma_f32_16x16x32_bf16 v[168:171], v[128:131], v[76:79], v[168:171]
    ds_read_b64_tr_b16 v[116:117], v9 offset:15384
    ds_read_b64_tr_b16 v[118:119], v9 offset:16664
    v_mfma_f32_16x16x32_bf16 v[172:175], v[132:135], v[76:79], v[172:175]
    ds_read_b64_tr_b16 v[120:121], v9 offset:15392
    ds_read_b64_tr_b16 v[122:123], v9 offset:16672
    v_mfma_f32_16x16x32_bf16 v[176:179], v[136:139], v[76:79], v[176:179]
    v_mfma_f32_16x16x32_bf16 v[180:183], v[140:143], v[76:79], v[180:183]
    s_waitcnt lgkmcnt(10)
    v_readfirstlane_b32 s70, v19
    s_nop 0
    s_cmp_eq_u32 s70, 16843009
    s_cbranch_scc0 slow_60
back_61:
    s_waitcnt lgkmcnt(10)
    ds_read_b64_tr_b16 v[124:125], v9 offset:20480
    ds_read_b64_tr_b16 v[126:127], v9 offset:21760
    v_mfma_f32_16x16x32_bf16 v[204:207], v[80:83], v[80:83], v[204:207]
    ds_read_b64_tr_b16 v[128:129], v9 offset:20488
    ds_read_b64_tr_b16 v[130:131], v9 offset:21768
    v_mfma_f32_16x16x32_bf16 v[164:167], v[144:147], v[80:83], v[164:167]
    ds_read_b64_tr_b16 v[132:133], v9 offset:20496
    ds_read_b64_tr_b16 v[134:135], v9 offset:21776
    v_mfma_f32_16x16x32_bf16 v[168:171], v[148:151], v[80:83], v[168:171]
    ds_read_b64_tr_b16 v[136:137], v9 offset:20504
    ds_read_b64_tr_b16 v[138:139], v9 offset:21784
    v_mfma_f32_16x16x32_bf16 v[172:175], v[152:155], v[80:83], v[172:175]
    ds_read_b64_tr_b16 v[140:141], v9 offset:20512
    ds_read_b64_tr_b16 v[142:143], v9 offset:21792
    v_mfma_f32_16x16x32_bf16 v[176:179], v[156:159], v[80:83], v[176:179]
    v_mfma_f32_16x16x32_bf16 v[180:183], v[160:163], v[80:83], v[180:183]
    s_waitcnt lgkmcnt(10)
    ds_read_b64_tr_b16 v[144:145], v9 offset:25600
    ds_read_b64_tr_b16 v[146:147], v9 offset:26880
    v_mfma_f32_16x16x32_bf16 v[204:207], v[84:87], v[84:87], v[204:207]
    ds_read_b64_tr_b16 v[148:149], v9 offset:25608
    ds_read_b64_tr_b16 v[150:151], v9 offset:26888
    v_mfma_f32_16x16x32_bf16 v[164:167], v[104:107], v[84:87], v[164:167]
    ds_read_b64_tr_b16 v[152:153], v9 offset:25616
    ds_read_b64_tr_b16 v[154:155], v9 offset:26896
    v_mfma_f32_16x16x32_bf16 v[168:171], v[108:111], v[84:87], v[168:171]
    ds_read_b64_tr_b16 v[156:157], v9 offset:25624
    ds_read_b64_tr_b16 v[158:159], v9 offset:26904
    v_mfma_f32_16x16x32_bf16 v[172:175], v[112:115], v[84:87], v[172:175]
    ds_read_b64_tr_b16 v[160:161], v9 offset:25632
    ds_read_b64_tr_b16 v[162:163], v9 offset:26912
    v_mfma_f32_16x16x32_bf16 v[176:179], v[116:119], v[84:87], v[176:179]
    v_mfma_f32_16x16x32_bf16 v[180:183], v[120:123], v[84:87], v[180:183]
    ds_write_b8 v16, v18 offset:172
    s_waitcnt lgkmcnt(10)
    ds_read_b64_tr_b16 v[104:105], v9 offset:30720
    ds_read_b64_tr_b16 v[106:107], v9 offset:32000
    v_mfma_f32_16x16x32_bf16 v[204:207], v[88:91], v[88:91], v[204:207]
    ds_read_b64_tr_b16 v[108:109], v9 offset:30728
    ds_read_b64_tr_b16 v[110:111], v9 offset:32008
    v_mfma_f32_16x16x32_bf16 v[164:167], v[124:127], v[88:91], v[164:167]
    ds_read_b64_tr_b16 v[112:113], v9 offset:30736
    ds_read_b64_tr_b16 v[114:115], v9 offset:32016
    v_mfma_f32_16x16x32_bf16 v[168:171], v[128:131], v[88:91], v[168:171]
    ds_read_b64_tr_b16 v[116:117], v9 offset:30744
    ds_read_b64_tr_b16 v[118:119], v9 offset:32024
    v_mfma_f32_16x16x32_bf16 v[172:175], v[132:135], v[88:91], v[172:175]
    ds_read_b64_tr_b16 v[120:121], v9 offset:30752
    ds_read_b64_tr_b16 v[122:123], v9 offset:32032
    v_mfma_f32_16x16x32_bf16 v[176:179], v[136:139], v[88:91], v[176:179]
    v_mfma_f32_16x16x32_bf16 v[180:183], v[140:143], v[88:91], v[180:183]
    s_waitcnt lgkmcnt(10)
    ds_read_b64_tr_b16 v[124:125], v9 offset:35840
    ds_read_b64_tr_b16 v[126:127], v9 offset:37120
    v_mfma_f32_16x16x32_bf16 v[204:207], v[92:95], v[92:95], v[204:207]
    ds_read_b64_tr_b16 v[128:129], v9 offset:35848
    ds_read_b64_tr_b16 v[130:131], v9 offset:37128
    v_mfma_f32_16x16x32_bf16 v[164:167], v[144:147], v[92:95], v[164:167]
    ds_read_b64_tr_b16 v[132:133], v9 offset:35856
    ds_read_b64_tr_b16 v[134:135], v9 offset:37136
    v_mfma_f32_16x16x32_bf16 v[168:171], v[148:151], v[92:95], v[168:171]
    ds_read_b64_tr_b16 v[136:137], v9 offset:35864
    ds_read_b64_tr_b16 v[138:139], v9 offset:37144
    v_mfma_f32_16x16x32_bf16 v[172:175], v[152:155], v[92:95], v[172:175]
    ds_read_b64_tr_b16 v[140:141], v9 offset:35872
    ds_read_b64_tr_b16 v[142:143], v9 offset:37152
    v_mfma_f32_16x16x32_bf16 v[176:179], v[156:159], v[92:95], v[176:179]
    v_mfma_f32_16x16x32_bf16 v[180:183], v[160:163], v[92:95], v[180:183]
    s_waitcnt lgkmcnt(10)
    v_mfma_f32_16x16x32_bf16 v[204:207], v[96:99], v[96:99], v[204:207]
    v_mfma_f32_16x16x32_bf16 v[164:167], v[104:107], v[96:99], v[164:167]
    v_mfma_f32_16x16x32_bf16 v[168:171], v[108:111], v[96:99], v[168:171]
    v_mfma_f32_16x16x32_bf16 v[172:175], v[112:115], v[96:99], v[172:175]
    v_mfma_f32_16x16x32_bf16 v[176:179], v[116:119], v[96:99], v[176:179]
    v_mfma_f32_16x16x32_bf16 v[180:183], v[120:123], v[96:99], v[180:183]
    s_waitcnt lgkmcnt(0)
    v_mfma_f32_16x16x32_bf16 v[204:207], v[100:103], v[100:103], v[204:207]
    v_mfma_f32_16x16x32_bf16 v[164:167], v[124:127], v[100:103], v[164:167]
    v_mfma_f32_16x16x32_bf16 v[168:171], v[128:131], v[100:103], v[168:171]
    v_mfma_f32_16x16x32_bf16 v[172:175], v[132:135], v[100:103], v[172:175]
    v_mfma_f32_16x16x32_bf16 v[176:179], v[136:139], v[100:103], v[176:179]
    v_mfma_f32_16x16x32_bf16 v[180:183], v[140:143], v[100:103], v[180:183]
    ds_write_b8 v16, v18 offset:132
    ds_read_b64_tr_b16 v[104:105], v11 offset:0
    ds_read_b64_tr_b16 v[106:107], v11 offset:160
    ds_read_b64_tr_b16 v[108:109], v11 offset:320
    ds_read_b64_tr_b16 v[110:111], v11 offset:480
    ds_read_b64_tr_b16 v[112:113], v11 offset:640
    v_mov_b32 v114, 0
    v_mov_b32 v115, 0
    ds_read_b64_tr_b16 v[116:117], v11 offset:8
    ds_read_b64_tr_b16 v[118:119], v11 offset:168
    ds_read_b64_tr_b16 v[120:121], v11 offset:328
    ds_read_b64_tr_b16 v[122:123], v11 offset:488
    ds_read_b64_tr_b16 v[124:125], v11 offset:648
    v_mov_b32 v126, 0
    v_mov_b32 v127, 0
    ds_read_b64_tr_b16 v[128:129], v11 offset:16
    ds_read_b64_tr_b16 v[130:131], v11 offset:176
    ds_read_b64_tr_b16 v[132:133], v11 offset:336
    ds_read_b64_tr_b16 v[134:135], v11 offset:496
    ds_read_b64_tr_b16 v[136:137], v11 offset:656
    v_mov_b32 v138, 0
    v_mov_b32 v139, 0
    ds_read_b64_tr_b16 v[140:141], v11 offset:24
    ds_read_b64_tr_b16 v[142:143], v11 offset:184
    ds_read_b64_tr_b16 v[144:145], v11 offset:344
    ds_read_b64_tr_b16 v[146:147], v11 offset:504
    ds_read_b64_tr_b16 v[148:149], v11 offset:664
    v_mov_b32 v150, 0
    v_mov_b32 v151, 0
    ds_read_b64_tr_b16 v[152:153], v11 offset:32
    ds_read_b64_tr_b16 v[154:155], v11 offset:192
    ds_read_b64_tr_b16 v[156:157], v11 offset:352
    ds_read_b64_tr_b16 v[158:159], v11 offset:512
    ds_read_b64_tr_b16 v[160:161], v11 offset:672
    v_mov_b32 v162, 0
    v_mov_b32 v163, 0
    v_and_b32 v12, 3, v2
    v_cmp_eq_u32 vcc, 1, v12
    s_nop 1
    v_cndmask_b32 v13, v204, v205, vcc
    v_cmp_eq_u32 vcc, 2, v12
    s_nop 1
    v_cndmask_b32 v13, v13, v206, vcc
    v_cmp_eq_u32 vcc, 3, v12
    s_nop 1
    v_cndmask_b32 v13, v13, v207, vcc
    v_lshrrev_b32 v12, 2, v2
    v_cmp_eq_u32 vcc, v12, v3
    s_nop 1
    v_cndmask_b32 v13, 0, v13, vcc
    v_mov_b32 v12, v13
    s_nop 1
    v_permlane32_swap_b32 v13, v12
    v_add_f32 v13, v13, v12
    v_mov_b32 v12, v13
    s_nop 1
    v_permlane16_swap_b32 v13, v12
    v_add_f32 v13, v13, v12
    v_mov_b32 v12, 925353388
    v_fmac_f32 v12, 986500301, v13
    v_rsq_f32 v14, v12
    s_nop 0
    v_pk_mul_f32 v[164:165], v[164:165], v[14:15] op_sel_hi:[1,0]
    v_pk_mul_f32 v[166:167], v[166:167], v[14:15] op_sel_hi:[1,0]
    v_pk_mul_f32 v[168:169], v[168:169], v[14:15] op_sel_hi:[1,0]
    v_pk_mul_f32 v[170:171], v[170:171], v[14:15] op_sel_hi:[1,0]
    v_pk_mul_f32 v[172:173], v[172:173], v[14:15] op_sel_hi:[1,0]
    v_pk_mul_f32 v[174:175], v[174:175], v[14:15] op_sel_hi:[1,0]
    v_pk_mul_f32 v[176:177], v[176:177], v[14:15] op_sel_hi:[1,0]
    v_pk_mul_f32 v[178:179], v[178:179], v[14:15] op_sel_hi:[1,0]
    v_pk_mul_f32 v[180:181], v[180:181], v[14:15] op_sel_hi:[1,0]
    v_pk_mul_f32 v[182:183], v[182:183], v[14:15] op_sel_hi:[1,0]
    v_cvt_pk_bf16_f32 v236, v164, v165
    v_cvt_pk_bf16_f32 v237, v166, v167
    v_cvt_pk_bf16_f32 v238, v168, v169
    v_cvt_pk_bf16_f32 v239, v170, v171
    v_cvt_pk_bf16_f32 v240, v172, v173
    v_cvt_pk_bf16_f32 v241, v174, v175
    v_cvt_pk_bf16_f32 v242, v176, v177
    v_cvt_pk_bf16_f32 v243, v178, v179
    v_cvt_pk_bf16_f32 v244, v180, v181
    v_cvt_pk_bf16_f32 v245, v182, v183
    v_mov_b32 v246, 0
    v_mov_b32 v247, 0
    s_waitcnt lgkmcnt(0)
    v_mfma_f32_16x16x32_bf16 v[184:187], v[104:107], v[236:239], 0
    v_mfma_f32_16x16x32_bf16 v[184:187], v[108:111], v[240:243], v[184:187]
    v_mfma_f32_16x16x32_bf16 v[184:187], v[112:115], v[244:247], v[184:187]
    v_mfma_f32_16x16x32_bf16 v[188:191], v[116:119], v[236:239], 0
    v_mfma_f32_16x16x32_bf16 v[188:191], v[120:123], v[240:243], v[188:191]
    v_mfma_f32_16x16x32_bf16 v[188:191], v[124:127], v[244:247], v[188:191]
    v_mfma_f32_16x16x32_bf16 v[192:195], v[128:131], v[236:239], 0
    v_mfma_f32_16x16x32_bf16 v[192:195], v[132:135], v[240:243], v[192:195]
    v_mfma_f32_16x16x32_bf16 v[192:195], v[136:139], v[244:247], v[192:195]
    v_mfma_f32_16x16x32_bf16 v[196:199], v[140:143], v[236:239], 0
    v_mfma_f32_16x16x32_bf16 v[196:199], v[144:147], v[240:243], v[196:199]
    v_mfma_f32_16x16x32_bf16 v[196:199], v[148:151], v[244:247], v[196:199]
    v_mfma_f32_16x16x32_bf16 v[200:203], v[152:155], v[236:239], 0
    v_mfma_f32_16x16x32_bf16 v[200:203], v[156:159], v[240:243], v[200:203]
    v_mfma_f32_16x16x32_bf16 v[200:203], v[160:163], v[244:247], v[200:203]
    v_max3_f32 v228, v184, v185, v186
    v_min3_f32 v230, v184, v185, v186
    v_max3_f32 v228, v228, v187, v188
    v_min3_f32 v230, v230, v187, v188
    v_max3_f32 v228, v228, v189, v190
    v_min3_f32 v230, v230, v189, v190
    v_max3_f32 v228, v228, v191, v192
    v_min3_f32 v230, v230, v191, v192
    v_max3_f32 v228, v228, v193, v194
    v_min3_f32 v230, v230, v193, v194
    v_max3_f32 v228, v228, v195, v196
    v_min3_f32 v230, v230, v195, v196
    v_max3_f32 v228, v228, v197, v198
    v_min3_f32 v230, v230, v197, v198
    v_max3_f32 v228, v228, v199, v200
    v_min3_f32 v230, v230, v199, v200
    v_max3_f32 v228, v228, v201, v202
    v_min3_f32 v230, v230, v201, v202
    v_max_f32 v228, v228, v203
    v_min_f32 v230, v230, v203
    v_mov_b32 v232, 1069066811
    v_mul_f32 v228, v232, v228
    v_mul_f32 v230, v232, v230
    v_pk_fma_f32 v[164:165], v[184:185], v[232:233], v[228:229] op_sel_hi:[1,0,0] neg_lo:[0,0,1] neg_hi:[0,0,1]
    v_pk_fma_f32 v[104:105], v[184:185], v[232:233], v[230:231] op_sel_hi:[1,0,0] neg_lo:[1,0,0] neg_hi:[1,0,0]
    v_pk_fma_f32 v[166:167], v[186:187], v[232:233], v[228:229] op_sel_hi:[1,0,0] neg_lo:[0,0,1] neg_hi:[0,0,1]
    v_pk_fma_f32 v[106:107], v[186:187], v[232:233], v[230:231] op_sel_hi:[1,0,0] neg_lo:[1,0,0] neg_hi:[1,0,0]
    v_pk_fma_f32 v[168:169], v[188:189], v[232:233], v[228:229] op_sel_hi:[1,0,0] neg_lo:[0,0,1] neg_hi:[0,0,1]
    v_pk_fma_f32 v[108:109], v[188:189], v[232:233], v[230:231] op_sel_hi:[1,0,0] neg_lo:[1,0,0] neg_hi:[1,0,0]
    v_pk_fma_f32 v[170:171], v[190:191], v[232:233], v[228:229] op_sel_hi:[1,0,0] neg_lo:[0,0,1] neg_hi:[0,0,1]
    v_pk_fma_f32 v[110:111], v[190:191], v[232:233], v[230:231] op_sel_hi:[1,0,0] neg_lo:[1,0,0] neg_hi:[1,0,0]
    v_pk_fma_f32 v[172:173], v[192:193], v[232:233], v[228:229] op_sel_hi:[1,0,0] neg_lo:[0,0,1] neg_hi:[0,0,1]
    v_pk_fma_f32 v[112:113], v[192:193], v[232:233], v[230:231] op_sel_hi:[1,0,0] neg_lo:[1,0,0] neg_hi:[1,0,0]
    v_pk_fma_f32 v[174:175], v[194:195], v[232:233], v[228:229] op_sel_hi:[1,0,0] neg_lo:[0,0,1] neg_hi:[0,0,1]
    v_pk_fma_f32 v[114:115], v[194:195], v[232:233], v[230:231] op_sel_hi:[1,0,0] neg_lo:[1,0,0] neg_hi:[1,0,0]
    v_pk_fma_f32 v[176:177], v[196:197], v[232:233], v[228:229] op_sel_hi:[1,0,0] neg_lo:[0,0,1] neg_hi:[0,0,1]
    v_pk_fma_f32 v[116:117], v[196:197], v[232:233], v[230:231] op_sel_hi:[1,0,0] neg_lo:[1,0,0] neg_hi:[1,0,0]
    v_pk_fma_f32 v[178:179], v[198:199], v[232:233], v[228:229] op_sel_hi:[1,0,0] neg_lo:[0,0,1] neg_hi:[0,0,1]
    v_pk_fma_f32 v[118:119], v[198:199], v[232:233], v[230:231] op_sel_hi:[1,0,0] neg_lo:[1,0,0] neg_hi:[1,0,0]
    v_pk_fma_f32 v[180:181], v[200:201], v[232:233], v[228:229] op_sel_hi:[1,0,0] neg_lo:[0,0,1] neg_hi:[0,0,1]
    v_pk_fma_f32 v[120:121], v[200:201], v[232:233], v[230:231] op_sel_hi:[1,0,0] neg_lo:[1,0,0] neg_hi:[1,0,0]
    v_pk_fma_f32 v[182:183], v[202:203], v[232:233], v[228:229] op_sel_hi:[1,0,0] neg_lo:[0,0,1] neg_hi:[0,0,1]
    v_pk_fma_f32 v[122:123], v[202:203], v[232:233], v[230:231] op_sel_hi:[1,0,0] neg_lo:[1,0,0] neg_hi:[1,0,0]
    v_exp_f32 v164, v164
    v_exp_f32 v104, v104
    v_exp_f32 v165, v165
    v_exp_f32 v105, v105
    v_exp_f32 v166, v166
    v_exp_f32 v106, v106
    v_exp_f32 v167, v167
    v_exp_f32 v107, v107
    v_exp_f32 v168, v168
    v_exp_f32 v108, v108
    v_exp_f32 v169, v169
    v_exp_f32 v109, v109
    v_exp_f32 v170, v170
    v_exp_f32 v110, v110
    v_exp_f32 v171, v171
    v_exp_f32 v111, v111
    v_exp_f32 v172, v172
    v_exp_f32 v112, v112
    v_exp_f32 v173, v173
    v_exp_f32 v113, v113
    v_exp_f32 v174, v174
    v_exp_f32 v114, v114
    v_exp_f32 v175, v175
    v_exp_f32 v115, v115
    v_exp_f32 v176, v176
    v_exp_f32 v116, v116
    v_exp_f32 v177, v177
    v_exp_f32 v117, v117
    v_exp_f32 v178, v178
    v_exp_f32 v118, v118
    v_exp_f32 v179, v179
    v_exp_f32 v119, v119
    v_exp_f32 v180, v180
    v_exp_f32 v120, v120
    v_exp_f32 v181, v181
    v_exp_f32 v121, v121
    v_exp_f32 v182, v182
    v_exp_f32 v122, v122
    v_exp_f32 v183, v183
    v_exp_f32 v123, v123
    v_pk_add_f32 v[228:229], v[164:165], v[166:167]
    v_pk_add_f32 v[230:231], v[104:105], v[106:107]
    v_pk_add_f32 v[228:229], v[228:229], v[168:169]
    v_pk_add_f32 v[230:231], v[230:231], v[108:109]
    v_pk_add_f32 v[228:229], v[228:229], v[170:171]
    v_pk_add_f32 v[230:231], v[230:231], v[110:111]
    v_pk_add_f32 v[228:229], v[228:229], v[172:173]
    v_pk_add_f32 v[230:231], v[230:231], v[112:113]
    v_pk_add_f32 v[228:229], v[228:229], v[174:175]
    v_pk_add_f32 v[230:231], v[230:231], v[114:115]
    v_pk_add_f32 v[228:229], v[228:229], v[176:177]
    v_pk_add_f32 v[230:231], v[230:231], v[116:117]
    v_pk_add_f32 v[228:229], v[228:229], v[178:179]
    v_pk_add_f32 v[230:231], v[230:231], v[118:119]
    v_pk_add_f32 v[228:229], v[228:229], v[180:181]
    v_pk_add_f32 v[230:231], v[230:231], v[120:121]
    v_pk_add_f32 v[228:229], v[228:229], v[182:183]
    v_pk_add_f32 v[230:231], v[230:231], v[122:123]
    v_add_f32 v228, v228, v229
    v_add_f32 v230, v230, v231
    v_rcp_f32 v228, v228
    v_rcp_f32 v230, v230
    v_pk_mul_f32 v[164:165], v[164:165], v[228:229] op_sel_hi:[1,0]
    v_pk_mul_f32 v[104:105], v[104:105], v[230:231] op_sel_hi:[1,0]
    v_pk_mul_f32 v[166:167], v[166:167], v[228:229] op_sel_hi:[1,0]
    v_pk_mul_f32 v[106:107], v[106:107], v[230:231] op_sel_hi:[1,0]
    v_pk_mul_f32 v[168:169], v[168:169], v[228:229] op_sel_hi:[1,0]
    v_pk_mul_f32 v[108:109], v[108:109], v[230:231] op_sel_hi:[1,0]
    v_pk_mul_f32 v[170:171], v[170:171], v[228:229] op_sel_hi:[1,0]
    v_pk_mul_f32 v[110:111], v[110:111], v[230:231] op_sel_hi:[1,0]
    v_pk_mul_f32 v[172:173], v[172:173], v[228:229] op_sel_hi:[1,0]
    v_pk_mul_f32 v[112:113], v[112:113], v[230:231] op_sel_hi:[1,0]
    v_pk_mul_f32 v[174:175], v[174:175], v[228:229] op_sel_hi:[1,0]
    v_pk_mul_f32 v[114:115], v[114:115], v[230:231] op_sel_hi:[1,0]
    v_pk_mul_f32 v[176:177], v[176:177], v[228:229] op_sel_hi:[1,0]
    v_pk_mul_f32 v[116:117], v[116:117], v[230:231] op_sel_hi:[1,0]
    v_pk_mul_f32 v[178:179], v[178:179], v[228:229] op_sel_hi:[1,0]
    v_pk_mul_f32 v[118:119], v[118:119], v[230:231] op_sel_hi:[1,0]
    v_pk_mul_f32 v[180:181], v[180:181], v[228:229] op_sel_hi:[1,0]
    v_pk_mul_f32 v[120:121], v[120:121], v[230:231] op_sel_hi:[1,0]
    v_pk_mul_f32 v[182:183], v[182:183], v[228:229] op_sel_hi:[1,0]
    v_pk_mul_f32 v[122:123], v[122:123], v[230:231] op_sel_hi:[1,0]
    v_cvt_pk_bf16_f32 v208, v164, v165
    v_cvt_pk_bf16_f32 v218, v104, v105
    v_cvt_pk_bf16_f32 v209, v166, v167
    v_cvt_pk_bf16_f32 v219, v106, v107
    v_cvt_pk_bf16_f32 v210, v168, v169
    v_cvt_pk_bf16_f32 v220, v108, v109
    v_cvt_pk_bf16_f32 v211, v170, v171
    v_cvt_pk_bf16_f32 v221, v110, v111
    v_cvt_pk_bf16_f32 v212, v172, v173
    v_cvt_pk_bf16_f32 v222, v112, v113
    v_cvt_pk_bf16_f32 v213, v174, v175
    v_cvt_pk_bf16_f32 v223, v114, v115
    v_cvt_pk_bf16_f32 v214, v176, v177
    v_cvt_pk_bf16_f32 v224, v116, v117
    v_cvt_pk_bf16_f32 v215, v178, v179
    v_cvt_pk_bf16_f32 v225, v118, v119
    v_cvt_pk_bf16_f32 v216, v180, v181
    v_cvt_pk_bf16_f32 v226, v120, v121
    v_cvt_pk_bf16_f32 v217, v182, v183
    v_cvt_pk_bf16_f32 v227, v122, v123
    ds_read_b32 v19, v17 offset:132
    s_waitcnt lgkmcnt(0)
    v_readfirstlane_b32 s70, v19
    s_nop 0
    s_cmp_eq_u32 s70, 16843009
    s_cbranch_scc0 slow_62
back_63:
    ds_write_b128 v249, v[208:211] offset:0
    ds_write_b128 v249, v[212:215] offset:16
    ds_write_b128 v249, v[216:219] offset:32
    ds_write_b128 v249, v[220:223] offset:48
    ds_write_b128 v249, v[224:227] offset:64
    ds_read_b32 v19, v17 offset:20
    v_mov_b32 v246, 0x00003f80
    v_mov_b32 v247, 0
    s_waitcnt lgkmcnt(0)
    v_readfirstlane_b32 s70, v19
    s_nop 0
    s_cmp_eq_u32 s70, 16843009
    s_cbranch_scc0 slow_64
back_65:
    ds_read_b64_tr_b16 v[104:105], v9 offset:40960
    ds_read_b64_tr_b16 v[106:107], v9 offset:42240
    ds_read_b64_tr_b16 v[108:109], v9 offset:40968
    ds_read_b64_tr_b16 v[110:111], v9 offset:42248
    ds_read_b64_tr_b16 v[112:113], v9 offset:40976
    ds_read_b64_tr_b16 v[114:115], v9 offset:42256
    ds_read_b64_tr_b16 v[116:117], v9 offset:40984
    ds_read_b64_tr_b16 v[118:119], v9 offset:42264
    ds_read_b64_tr_b16 v[120:121], v9 offset:40992
    ds_read_b64_tr_b16 v[122:123], v9 offset:42272
    ds_read_b64_tr_b16 v[124:125], v9 offset:46080
    ds_read_b64_tr_b16 v[126:127], v9 offset:47360
    ds_read_b64_tr_b16 v[128:129], v9 offset:46088
    ds_read_b64_tr_b16 v[130:131], v9 offset:47368
    ds_read_b64_tr_b16 v[132:133], v9 offset:46096
    ds_read_b64_tr_b16 v[134:135], v9 offset:47376
    ds_read_b64_tr_b16 v[136:137], v9 offset:46104
    ds_read_b64_tr_b16 v[138:139], v9 offset:47384
    ds_read_b64_tr_b16 v[140:141], v9 offset:46112
    ds_read_b64_tr_b16 v[142:143], v9 offset:47392
    s_waitcnt lgkmcnt(10)
    ds_read_b64_tr_b16 v[144:145], v9 offset:51200
    ds_read_b64_tr_b16 v[146:147], v9 offset:52480
    ds_read_b64_tr_b16 v[148:149], v9 offset:51208
    v_mfma_f32_16x16x32_bf16 v[184:187], v[104:107], v[24:27], 0
    ds_read_b64_tr_b16 v[150:151], v9 offset:52488
    ds_read_b64_tr_b16 v[152:153], v9 offset:51216
    ds_read_b64_tr_b16 v[154:155], v9 offset:52496
    v_mfma_f32_16x16x32_bf16 v[188:191], v[108:111], v[24:27], 0
    ds_read_b64_tr_b16 v[156:157], v9 offset:51224
    ds_read_b64_tr_b16 v[158:159], v9 offset:52504
    ds_read_b64_tr_b16 v[160:161], v9 offset:51232
    v_mfma_f32_16x16x32_bf16 v[192:195], v[112:115], v[24:27], 0
    ds_read_b64_tr_b16 v[162:163], v9 offset:52512
    ds_read_b32 v19, v17 offset:24
    v_mfma_f32_16x16x32_bf16 v[196:199], v[116:119], v[24:27], 0
    v_mfma_f32_16x16x32_bf16 v[200:203], v[120:123], v[24:27], 0
    s_waitcnt lgkmcnt(11)
    ds_read_b64_tr_b16 v[104:105], v9 offset:56320
    ds_read_b64_tr_b16 v[106:107], v9 offset:57600
    v_mfma_f32_16x16x32_bf16 v[184:187], v[124:127], v[28:31], v[184:187]
    ds_read_b64_tr_b16 v[108:109], v9 offset:56328
    ds_read_b64_tr_b16 v[110:111], v9 offset:57608
    v_mfma_f32_16x16x32_bf16 v[188:191], v[128:131], v[28:31], v[188:191]
    ds_read_b64_tr_b16 v[112:113], v9 offset:56336
    ds_read_b64_tr_b16 v[114:115], v9 offset:57616
    v_mfma_f32_16x16x32_bf16 v[192:195], v[132:135], v[28:31], v[192:195]
    ds_read_b64_tr_b16 v[116:117], v9 offset:56344
    ds_read_b64_tr_b16 v[118:119], v9 offset:57624
    v_mfma_f32_16x16x32_bf16 v[196:199], v[136:139], v[28:31], v[196:199]
    ds_read_b64_tr_b16 v[120:121], v9 offset:56352
    ds_read_b64_tr_b16 v[122:123], v9 offset:57632
    v_mfma_f32_16x16x32_bf16 v[200:203], v[140:143], v[28:31], v[200:203]
    s_waitcnt lgkmcnt(10)
    v_readfirstlane_b32 s70, v19
    s_nop 0
    s_cmp_eq_u32 s70, 16843009
    s_cbranch_scc0 slow_66
back_67:
    s_waitcnt lgkmcnt(10)
    ds_read_b64_tr_b16 v[124:125], v10 offset:0
    ds_read_b64_tr_b16 v[126:127], v10 offset:1280
    v_mfma_f32_16x16x32_bf16 v[184:187], v[144:147], v[32:35], v[184:187]
    ds_read_b64_tr_b16 v[128:129], v10 offset:8
    ds_read_b64_tr_b16 v[130:131], v10 offset:1288
    v_mfma_f32_16x16x32_bf16 v[188:191], v[148:151], v[32:35], v[188:191]
    ds_read_b64_tr_b16 v[132:133], v10 offset:16
    ds_read_b64_tr_b16 v[134:135], v10 offset:1296
    v_mfma_f32_16x16x32_bf16 v[192:195], v[152:155], v[32:35], v[192:195]
    ds_read_b64_tr_b16 v[136:137], v10 offset:24
    ds_read_b64_tr_b16 v[138:139], v10 offset:1304
    v_mfma_f32_16x16x32_bf16 v[196:199], v[156:159], v[32:35], v[196:199]
    ds_read_b64_tr_b16 v[140:141], v10 offset:32
    ds_read_b64_tr_b16 v[142:143], v10 offset:1312
    v_mfma_f32_16x16x32_bf16 v[200:203], v[160:163], v[32:35], v[200:203]
    s_waitcnt lgkmcnt(10)
    ds_read_b64_tr_b16 v[144:145], v10 offset:5120
    ds_read_b64_tr_b16 v[146:147], v10 offset:6400
    v_mfma_f32_16x16x32_bf16 v[184:187], v[104:107], v[36:39], v[184:187]
    ds_read_b64_tr_b16 v[148:149], v10 offset:5128
    ds_read_b64_tr_b16 v[150:151], v10 offset:6408
    v_mfma_f32_16x16x32_bf16 v[188:191], v[108:111], v[36:39], v[188:191]
    ds_read_b64_tr_b16 v[152:153], v10 offset:5136
    ds_read_b64_tr_b16 v[154:155], v10 offset:6416
    v_mfma_f32_16x16x32_bf16 v[192:195], v[112:115], v[36:39], v[192:195]
    ds_read_b64_tr_b16 v[156:157], v10 offset:5144
    ds_read_b64_tr_b16 v[158:159], v10 offset:6424
    v_mfma_f32_16x16x32_bf16 v[196:199], v[116:119], v[36:39], v[196:199]
    ds_read_b64_tr_b16 v[160:161], v10 offset:5152
    ds_read_b64_tr_b16 v[162:163], v10 offset:6432
    v_mfma_f32_16x16x32_bf16 v[200:203], v[120:123], v[36:39], v[200:203]
    ds_write_b8 v16, v18 offset:180
    s_waitcnt lgkmcnt(10)
    ds_read_b64_tr_b16 v[104:105], v10 offset:10240
    ds_read_b64_tr_b16 v[106:107], v10 offset:11520
    ds_read_b64_tr_b16 v[108:109], v10 offset:10248
    v_mfma_f32_16x16x32_bf16 v[184:187], v[124:127], v[40:43], v[184:187]
    ds_read_b64_tr_b16 v[110:111], v10 offset:11528
    ds_read_b64_tr_b16 v[112:113], v10 offset:10256
    ds_read_b64_tr_b16 v[114:115], v10 offset:11536
    v_mfma_f32_16x16x32_bf16 v[188:191], v[128:131], v[40:43], v[188:191]
    ds_read_b64_tr_b16 v[116:117], v10 offset:10264
    ds_read_b64_tr_b16 v[118:119], v10 offset:11544
    ds_read_b64_tr_b16 v[120:121], v10 offset:10272
    v_mfma_f32_16x16x32_bf16 v[192:195], v[132:135], v[40:43], v[192:195]
    ds_read_b64_tr_b16 v[122:123], v10 offset:11552
    ds_read_b32 v19, v17 offset:28
    v_mfma_f32_16x16x32_bf16 v[196:199], v[136:139], v[40:43], v[196:199]
    v_mfma_f32_16x16x32_bf16 v[200:203], v[140:143], v[40:43], v[200:203]
    s_waitcnt lgkmcnt(11)
    ds_read_b64_tr_b16 v[124:125], v10 offset:15360
    ds_read_b64_tr_b16 v[126:127], v10 offset:16640
    v_mfma_f32_16x16x32_bf16 v[184:187], v[144:147], v[44:47], v[184:187]
    ds_read_b64_tr_b16 v[128:129], v10 offset:15368
    ds_read_b64_tr_b16 v[130:131], v10 offset:16648
    v_mfma_f32_16x16x32_bf16 v[188:191], v[148:151], v[44:47], v[188:191]
    ds_read_b64_tr_b16 v[132:133], v10 offset:15376
    ds_read_b64_tr_b16 v[134:135], v10 offset:16656
    v_mfma_f32_16x16x32_bf16 v[192:195], v[152:155], v[44:47], v[192:195]
    ds_read_b64_tr_b16 v[136:137], v10 offset:15384
    ds_read_b64_tr_b16 v[138:139], v10 offset:16664
    v_mfma_f32_16x16x32_bf16 v[196:199], v[156:159], v[44:47], v[196:199]
    ds_read_b64_tr_b16 v[140:141], v10 offset:15392
    ds_read_b64_tr_b16 v[142:143], v10 offset:16672
    v_mfma_f32_16x16x32_bf16 v[200:203], v[160:163], v[44:47], v[200:203]
    s_waitcnt lgkmcnt(10)
    v_readfirstlane_b32 s70, v19
    s_nop 0
    s_cmp_eq_u32 s70, 16843009
    s_cbranch_scc0 slow_68
back_69:
    s_waitcnt lgkmcnt(10)
    ds_read_b64_tr_b16 v[144:145], v8 offset:0
    ds_read_b64_tr_b16 v[146:147], v8 offset:1280
    v_mfma_f32_16x16x32_bf16 v[184:187], v[104:107], v[48:51], v[184:187]
    ds_read_b64_tr_b16 v[148:149], v8 offset:8
    ds_read_b64_tr_b16 v[150:151], v8 offset:1288
    v_mfma_f32_16x16x32_bf16 v[188:191], v[108:111], v[48:51], v[188:191]
    ds_read_b64_tr_b16 v[152:153], v8 offset:16
    ds_read_b64_tr_b16 v[154:155], v8 offset:1296
    v_mfma_f32_16x16x32_bf16 v[192:195], v[112:115], v[48:51], v[192:195]
    ds_read_b64_tr_b16 v[156:157], v8 offset:24
    ds_read_b64_tr_b16 v[158:159], v8 offset:1304
    v_mfma_f32_16x16x32_bf16 v[196:199], v[116:119], v[48:51], v[196:199]
    ds_read_b64_tr_b16 v[160:161], v8 offset:32
    ds_read_b64_tr_b16 v[162:163], v8 offset:1312
    v_mfma_f32_16x16x32_bf16 v[200:203], v[120:123], v[48:51], v[200:203]
    s_waitcnt lgkmcnt(10)
    ds_read_b64_tr_b16 v[104:105], v8 offset:5120
    ds_read_b64_tr_b16 v[106:107], v8 offset:6400
    v_mfma_f32_16x16x32_bf16 v[184:187], v[124:127], v[52:55], v[184:187]
    ds_read_b64_tr_b16 v[108:109], v8 offset:5128
    ds_read_b64_tr_b16 v[110:111], v8 offset:6408
    v_mfma_f32_16x16x32_bf16 v[188:191], v[128:131], v[52:55], v[188:191]
    ds_read_b64_tr_b16 v[112:113], v8 offset:5136
    ds_read_b64_tr_b16 v[114:115], v8 offset:6416
    v_mfma_f32_16x16x32_bf16 v[192:195], v[132:135], v[52:55], v[192:195]
    ds_read_b64_tr_b16 v[116:117], v8 offset:5144
    ds_read_b64_tr_b16 v[118:119], v8 offset:6424
    v_mfma_f32_16x16x32_bf16 v[196:199], v[136:139], v[52:55], v[196:199]
    ds_read_b64_tr_b16 v[120:121], v8 offset:5152
    ds_read_b64_tr_b16 v[122:123], v8 offset:6432
    v_mfma_f32_16x16x32_bf16 v[200:203], v[140:143], v[52:55], v[200:203]
    ds_write_b8 v16, v18 offset:184
    s_waitcnt lgkmcnt(10)
    ds_read_b64_tr_b16 v[124:125], v8 offset:10240
    ds_read_b64_tr_b16 v[126:127], v8 offset:11520
    ds_read_b64_tr_b16 v[128:129], v8 offset:10248
    v_mfma_f32_16x16x32_bf16 v[184:187], v[144:147], v[56:59], v[184:187]
    ds_read_b64_tr_b16 v[130:131], v8 offset:11528
    ds_read_b64_tr_b16 v[132:133], v8 offset:10256
    ds_read_b64_tr_b16 v[134:135], v8 offset:11536
    v_mfma_f32_16x16x32_bf16 v[188:191], v[148:151], v[56:59], v[188:191]
    ds_read_b64_tr_b16 v[136:137], v8 offset:10264
    ds_read_b64_tr_b16 v[138:139], v8 offset:11544
    ds_read_b64_tr_b16 v[140:141], v8 offset:10272
    v_mfma_f32_16x16x32_bf16 v[192:195], v[152:155], v[56:59], v[192:195]
    ds_read_b64_tr_b16 v[142:143], v8 offset:11552
    ds_read_b32 v19, v17 offset:32
    v_mfma_f32_16x16x32_bf16 v[196:199], v[156:159], v[56:59], v[196:199]
    v_mfma_f32_16x16x32_bf16 v[200:203], v[160:163], v[56:59], v[200:203]
    s_waitcnt lgkmcnt(11)
    ds_read_b64_tr_b16 v[144:145], v8 offset:15360
    ds_read_b64_tr_b16 v[146:147], v8 offset:16640
    v_mfma_f32_16x16x32_bf16 v[184:187], v[104:107], v[60:63], v[184:187]
    ds_read_b64_tr_b16 v[148:149], v8 offset:15368
    ds_read_b64_tr_b16 v[150:151], v8 offset:16648
    v_mfma_f32_16x16x32_bf16 v[188:191], v[108:111], v[60:63], v[188:191]
    ds_read_b64_tr_b16 v[152:153], v8 offset:15376
    ds_read_b64_tr_b16 v[154:155], v8 offset:16656
    v_mfma_f32_16x16x32_bf16 v[192:195], v[112:115], v[60:63], v[192:195]
    ds_read_b64_tr_b16 v[156:157], v8 offset:15384
    ds_read_b64_tr_b16 v[158:159], v8 offset:16664
    v_mfma_f32_16x16x32_bf16 v[196:199], v[116:119], v[60:63], v[196:199]
    ds_read_b64_tr_b16 v[160:161], v8 offset:15392
    ds_read_b64_tr_b16 v[162:163], v8 offset:16672
    v_mfma_f32_16x16x32_bf16 v[200:203], v[120:123], v[60:63], v[200:203]
    s_waitcnt lgkmcnt(10)
    v_readfirstlane_b32 s70, v19
    s_nop 0
    s_cmp_eq_u32 s70, 16843009
    s_cbranch_scc0 slow_70
back_71:
    s_waitcnt lgkmcnt(10)
    ds_read_b64_tr_b16 v[104:105], v8 offset:20480
    ds_read_b64_tr_b16 v[106:107], v8 offset:21760
    v_mfma_f32_16x16x32_bf16 v[184:187], v[124:127], v[64:67], v[184:187]
    ds_read_b64_tr_b16 v[108:109], v8 offset:20488
    ds_read_b64_tr_b16 v[110:111], v8 offset:21768
    v_mfma_f32_16x16x32_bf16 v[188:191], v[128:131], v[64:67], v[188:191]
    ds_read_b64_tr_b16 v[112:113], v8 offset:20496
    ds_read_b64_tr_b16 v[114:115], v8 offset:21776
    v_mfma_f32_16x16x32_bf16 v[192:195], v[132:135], v[64:67], v[192:195]
    ds_read_b64_tr_b16 v[116:117], v8 offset:20504
    ds_read_b64_tr_b16 v[118:119], v8 offset:21784
    v_mfma_f32_16x16x32_bf16 v[196:199], v[136:139], v[64:67], v[196:199]
    ds_read_b64_tr_b16 v[120:121], v8 offset:20512
    ds_read_b64_tr_b16 v[122:123], v8 offset:21792
    v_mfma_f32_16x16x32_bf16 v[200:203], v[140:143], v[64:67], v[200:203]
    s_waitcnt lgkmcnt(10)
    ds_read_b64_tr_b16 v[124:125], v8 offset:25600
    ds_read_b64_tr_b16 v[126:127], v8 offset:26880
    v_mfma_f32_16x16x32_bf16 v[184:187], v[144:147], v[68:71], v[184:187]
    ds_read_b64_tr_b16 v[128:129], v8 offset:25608
    ds_read_b64_tr_b16 v[130:131], v8 offset:26888
    v_mfma_f32_16x16x32_bf16 v[188:191], v[148:151], v[68:71], v[188:191]
    ds_read_b64_tr_b16 v[132:133], v8 offset:25616
    ds_read_b64_tr_b16 v[134:135], v8 offset:26896
    v_mfma_f32_16x16x32_bf16 v[192:195], v[152:155], v[68:71], v[192:195]
    ds_read_b64_tr_b16 v[136:137], v8 offset:25624
    ds_read_b64_tr_b16 v[138:139], v8 offset:26904
    v_mfma_f32_16x16x32_bf16 v[196:199], v[156:159], v[68:71], v[196:199]
    ds_read_b64_tr_b16 v[140:141], v8 offset:25632
    ds_read_b64_tr_b16 v[142:143], v8 offset:26912
    v_mfma_f32_16x16x32_bf16 v[200:203], v[160:163], v[68:71], v[200:203]
    ds_write_b8 v16, v18 offset:188
    s_waitcnt lgkmcnt(10)
    ds_read_b64_tr_b16 v[144:145], v8 offset:30720
    ds_read_b64_tr_b16 v[146:147], v8 offset:32000
    ds_read_b64_tr_b16 v[148:149], v8 offset:30728
    v_mfma_f32_16x16x32_bf16 v[184:187], v[104:107], v[72:75], v[184:187]
    ds_read_b64_tr_b16 v[150:151], v8 offset:32008
    ds_read_b64_tr_b16 v[152:153], v8 offset:30736
    ds_read_b64_tr_b16 v[154:155], v8 offset:32016
    v_mfma_f32_16x16x32_bf16 v[188:191], v[108:111], v[72:75], v[188:191]
    ds_read_b64_tr_b16 v[156:157], v8 offset:30744
    ds_read_b64_tr_b16 v[158:159], v8 offset:32024
    ds_read_b64_tr_b16 v[160:161], v8 offset:30752
    v_mfma_f32_16x16x32_bf16 v[192:195], v[112:115], v[72:75], v[192:195]
    ds_read_b64_tr_b16 v[162:163], v8 offset:32032
    ds_read_b32 v19, v17 offset:36
    v_mfma_f32_16x16x32_bf16 v[196:199], v[116:119], v[72:75], v[196:199]
    v_mfma_f32_16x16x32_bf16 v[200:203], v[120:123], v[72:75], v[200:203]
    s_waitcnt lgkmcnt(11)
    ds_read_b64_tr_b16 v[104:105], v8 offset:35840
    ds_read_b64_tr_b16 v[106:107], v8 offset:37120
    v_mfma_f32_16x16x32_bf16 v[184:187], v[124:127], v[76:79], v[184:187]
    ds_read_b64_tr_b16 v[108:109], v8 offset:35848
    ds_read_b64_tr_b16 v[110:111], v8 offset:37128
    v_mfma_f32_16x16x32_bf16 v[188:191], v[128:131], v[76:79], v[188:191]
    ds_read_b64_tr_b16 v[112:113], v8 offset:35856
    ds_read_b64_tr_b16 v[114:115], v8 offset:37136
    v_mfma_f32_16x16x32_bf16 v[192:195], v[132:135], v[76:79], v[192:195]
    ds_read_b64_tr_b16 v[116:117], v8 offset:35864
    ds_read_b64_tr_b16 v[118:119], v8 offset:37144
    v_mfma_f32_16x16x32_bf16 v[196:199], v[136:139], v[76:79], v[196:199]
    ds_read_b64_tr_b16 v[120:121], v8 offset:35872
    ds_read_b64_tr_b16 v[122:123], v8 offset:37152
    v_mfma_f32_16x16x32_bf16 v[200:203], v[140:143], v[76:79], v[200:203]
    s_waitcnt lgkmcnt(10)
    v_readfirstlane_b32 s70, v19
    s_nop 0
    s_cmp_eq_u32 s70, 16843009
    s_cbranch_scc0 slow_72
back_73:
    s_waitcnt lgkmcnt(10)
    ds_read_b64_tr_b16 v[124:125], v8 offset:40960
    ds_read_b64_tr_b16 v[126:127], v8 offset:42240
    v_mfma_f32_16x16x32_bf16 v[184:187], v[144:147], v[80:83], v[184:187]
    ds_read_b64_tr_b16 v[128:129], v8 offset:40968
    ds_read_b64_tr_b16 v[130:131], v8 offset:42248
    v_mfma_f32_16x16x32_bf16 v[188:191], v[148:151], v[80:83], v[188:191]
    ds_read_b64_tr_b16 v[132:133], v8 offset:40976
    ds_read_b64_tr_b16 v[134:135], v8 offset:42256
    v_mfma_f32_16x16x32_bf16 v[192:195], v[152:155], v[80:83], v[192:195]
    ds_read_b64_tr_b16 v[136:137], v8 offset:40984
    ds_read_b64_tr_b16 v[138:139], v8 offset:42264
    v_mfma_f32_16x16x32_bf16 v[196:199], v[156:159], v[80:83], v[196:199]
    ds_read_b64_tr_b16 v[140:141], v8 offset:40992
    ds_read_b64_tr_b16 v[142:143], v8 offset:42272
    v_mfma_f32_16x16x32_bf16 v[200:203], v[160:163], v[80:83], v[200:203]
    s_waitcnt lgkmcnt(10)
    ds_read_b64_tr_b16 v[144:145], v8 offset:46080
    ds_read_b64_tr_b16 v[146:147], v8 offset:47360
    v_mfma_f32_16x16x32_bf16 v[184:187], v[104:107], v[84:87], v[184:187]
    ds_read_b64_tr_b16 v[148:149], v8 offset:46088
    ds_read_b64_tr_b16 v[150:151], v8 offset:47368
    v_mfma_f32_16x16x32_bf16 v[188:191], v[108:111], v[84:87], v[188:191]
    ds_read_b64_tr_b16 v[152:153], v8 offset:46096
    ds_read_b64_tr_b16 v[154:155], v8 offset:47376
    v_mfma_f32_16x16x32_bf16 v[192:195], v[112:115], v[84:87], v[192:195]
    ds_read_b64_tr_b16 v[156:157], v8 offset:46104
    ds_read_b64_tr_b16 v[158:159], v8 offset:47384
    v_mfma_f32_16x16x32_bf16 v[196:199], v[116:119], v[84:87], v[196:199]
    ds_read_b64_tr_b16 v[160:161], v8 offset:46112
    ds_read_b64_tr_b16 v[162:163], v8 offset:47392
    v_mfma_f32_16x16x32_bf16 v[200:203], v[120:123], v[84:87], v[200:203]
    ds_write_b8 v16, v18 offset:192
    s_waitcnt lgkmcnt(10)
    ds_read_b64_tr_b16 v[104:105], v8 offset:51200
    ds_read_b64_tr_b16 v[106:107], v8 offset:52480
    v_mfma_f32_16x16x32_bf16 v[184:187], v[124:127], v[88:91], v[184:187]
    ds_read_b64_tr_b16 v[108:109], v8 offset:51208
    ds_read_b64_tr_b16 v[110:111], v8 offset:52488
    v_mfma_f32_16x16x32_bf16 v[188:191], v[128:131], v[88:91], v[188:191]
    ds_read_b64_tr_b16 v[112:113], v8 offset:51216
    ds_read_b64_tr_b16 v[114:115], v8 offset:52496
    v_mfma_f32_16x16x32_bf16 v[192:195], v[132:135], v[88:91], v[192:195]
    ds_read_b64_tr_b16 v[116:117], v8 offset:51224
    ds_read_b64_tr_b16 v[118:119], v8 offset:52504
    v_mfma_f32_16x16x32_bf16 v[196:199], v[136:139], v[88:91], v[196:199]
    ds_read_b64_tr_b16 v[120:121], v8 offset:51232
    ds_read_b64_tr_b16 v[122:123], v8 offset:52512
    v_mfma_f32_16x16x32_bf16 v[200:203], v[140:143], v[88:91], v[200:203]
    s_waitcnt lgkmcnt(10)
    ds_read_b64_tr_b16 v[124:125], v8 offset:56320
    ds_read_b64_tr_b16 v[126:127], v8 offset:57600
    v_mfma_f32_16x16x32_bf16 v[184:187], v[144:147], v[92:95], v[184:187]
    ds_read_b64_tr_b16 v[128:129], v8 offset:56328
    ds_read_b64_tr_b16 v[130:131], v8 offset:57608
    v_mfma_f32_16x16x32_bf16 v[188:191], v[148:151], v[92:95], v[188:191]
    ds_read_b64_tr_b16 v[132:133], v8 offset:56336
    ds_read_b64_tr_b16 v[134:135], v8 offset:57616
    v_mfma_f32_16x16x32_bf16 v[192:195], v[152:155], v[92:95], v[192:195]
    ds_read_b64_tr_b16 v[136:137], v8 offset:56344
    ds_read_b64_tr_b16 v[138:139], v8 offset:57624
    v_mfma_f32_16x16x32_bf16 v[196:199], v[156:159], v[92:95], v[196:199]
    ds_read_b64_tr_b16 v[140:141], v8 offset:56352
    ds_read_b64_tr_b16 v[142:143], v8 offset:57632
    v_mfma_f32_16x16x32_bf16 v[200:203], v[160:163], v[92:95], v[200:203]
    s_waitcnt lgkmcnt(10)
    v_mfma_f32_16x16x32_bf16 v[184:187], v[104:107], v[96:99], v[184:187]
    v_mfma_f32_16x16x32_bf16 v[188:191], v[108:111], v[96:99], v[188:191]
    v_mfma_f32_16x16x32_bf16 v[192:195], v[112:115], v[96:99], v[192:195]
    v_mfma_f32_16x16x32_bf16 v[196:199], v[116:119], v[96:99], v[196:199]
    v_mfma_f32_16x16x32_bf16 v[200:203], v[120:123], v[96:99], v[200:203]
    s_waitcnt lgkmcnt(0)
    v_mfma_f32_16x16x32_bf16 v[184:187], v[124:127], v[100:103], v[184:187]
    v_mfma_f32_16x16x32_bf16 v[188:191], v[128:131], v[100:103], v[188:191]
    v_mfma_f32_16x16x32_bf16 v[192:195], v[132:135], v[100:103], v[192:195]
    v_mfma_f32_16x16x32_bf16 v[196:199], v[136:139], v[100:103], v[196:199]
    v_mfma_f32_16x16x32_bf16 v[200:203], v[140:143], v[100:103], v[200:203]
    s_nop 3
    v_pk_mul_f32 v[184:185], v[184:185], v[14:15] op_sel_hi:[1,0]
    v_pk_mul_f32 v[186:187], v[186:187], v[14:15] op_sel_hi:[1,0]
    v_pk_mul_f32 v[188:189], v[188:189], v[14:15] op_sel_hi:[1,0]
    v_pk_mul_f32 v[190:191], v[190:191], v[14:15] op_sel_hi:[1,0]
    v_pk_mul_f32 v[192:193], v[192:193], v[14:15] op_sel_hi:[1,0]
    v_pk_mul_f32 v[194:195], v[194:195], v[14:15] op_sel_hi:[1,0]
    v_pk_mul_f32 v[196:197], v[196:197], v[14:15] op_sel_hi:[1,0]
    v_pk_mul_f32 v[198:199], v[198:199], v[14:15] op_sel_hi:[1,0]
    v_pk_mul_f32 v[200:201], v[200:201], v[14:15] op_sel_hi:[1,0]
    v_pk_mul_f32 v[202:203], v[202:203], v[14:15] op_sel_hi:[1,0]
    v_cvt_pk_bf16_f32 v236, v184, v185
    v_cvt_pk_bf16_f32 v237, v186, v187
    v_cvt_pk_bf16_f32 v238, v188, v189
    v_cvt_pk_bf16_f32 v239, v190, v191
    v_cvt_pk_bf16_f32 v240, v192, v193
    v_cvt_pk_bf16_f32 v241, v194, v195
    v_cvt_pk_bf16_f32 v242, v196, v197
    v_cvt_pk_bf16_f32 v243, v198, v199
    v_cvt_pk_bf16_f32 v244, v200, v201
    v_cvt_pk_bf16_f32 v245, v202, v203
    ds_write_b128 v250, v[236:239] offset:0
    ds_write_b128 v250, v[240:243] offset:16
    ds_write_b128 v250, v[244:247] offset:32
    ds_write_b8 v16, v18 offset:140
    ds_read_b32 v19, v17 offset:140
    s_waitcnt lgkmcnt(0)
    v_readfirstlane_b32 s70, v19
    s_nop 0
    s_cmp_eq_u32 s70, 16843009
    s_cbranch_scc0 slow_74
back_75:
    ds_read_b64_tr_b16 v[128:129], v252 offset:0
    ds_read_b64_tr_b16 v[130:131], v252 offset:192
    ds_read_b64_tr_b16 v[132:133], v252 offset:32
    ds_read_b64_tr_b16 v[134:135], v252 offset:224
    ds_read_b64_tr_b16 v[104:105], v251 offset:0
    ds_read_b64_tr_b16 v[106:107], v251 offset:320
    ds_read_b64_tr_b16 v[108:109], v251 offset:32
    ds_read_b64_tr_b16 v[110:111], v251 offset:352
    ds_read_b64_tr_b16 v[112:113], v251 offset:64
    ds_read_b64_tr_b16 v[114:115], v251 offset:384
    ds_read_b64_tr_b16 v[136:137], v252 offset:1536
    ds_read_b64_tr_b16 v[138:139], v252 offset:1728
    ds_read_b64_tr_b16 v[140:141], v252 offset:1568
    ds_read_b64_tr_b16 v[142:143], v252 offset:1760
    ds_read_b64_tr_b16 v[116:117], v251 offset:2560
    ds_read_b64_tr_b16 v[118:119], v251 offset:2880
    ds_read_b64_tr_b16 v[120:121], v251 offset:2592
    ds_read_b64_tr_b16 v[122:123], v251 offset:2912
    ds_read_b64_tr_b16 v[124:125], v251 offset:2624
    ds_read_b64_tr_b16 v[126:127], v251 offset:2944
    s_waitcnt lgkmcnt(10)
    v_mfma_f32_16x16x32_bf16 v[164:167], v[104:107], v[128:131], 0
    v_mfma_f32_16x16x32_bf16 v[168:171], v[104:107], v[132:135], 0
    v_mfma_f32_16x16x32_bf16 v[172:175], v[108:111], v[128:131], 0
    v_mfma_f32_16x16x32_bf16 v[176:179], v[108:111], v[132:135], 0
    v_mfma_f32_16x16x32_bf16 v[180:183], v[112:115], v[128:131], 0
    v_mfma_f32_16x16x32_bf16 v[184:187], v[112:115], v[132:135], 0
    s_waitcnt lgkmcnt(0)
    v_mfma_f32_16x16x32_bf16 v[164:167], v[116:119], v[136:139], v[164:167]
    v_mfma_f32_16x16x32_bf16 v[168:171], v[116:119], v[140:143], v[168:171]
    v_mfma_f32_16x16x32_bf16 v[172:175], v[120:123], v[136:139], v[172:175]
    v_mfma_f32_16x16x32_bf16 v[176:179], v[120:123], v[140:143], v[176:179]
    v_mfma_f32_16x16x32_bf16 v[180:183], v[124:127], v[136:139], v[180:183]
    v_mfma_f32_16x16x32_bf16 v[184:187], v[124:127], v[140:143], v[184:187]
    v_mov_b32 v211, v248
    v_mov_b32 v215, v248
    v_mov_b32 v219, v248
    v_cvt_pk_bf16_f32 v236, v164, v165
    v_cvt_pk_bf16_f32 v237, v166, v167
    v_cvt_pk_bf16_f32 v240, v172, v173
    v_cvt_pk_bf16_f32 v241, v174, v175
    v_cvt_pk_bf16_f32 v238, v168, v169
    v_cvt_pk_bf16_f32 v239, v170, v171
    v_cvt_pk_bf16_f32 v242, v176, v177
    v_cvt_pk_bf16_f32 v243, v178, v179
    v_cvt_pk_bf16_f32 v244, v180, v181
    v_cvt_pk_bf16_f32 v245, v182, v183
    v_cvt_pk_bf16_f32 v246, v184, v185
    v_cvt_pk_bf16_f32 v247, v186, v187
    ds_write_b64 v21, v[236:237] offset:0
    ds_write_b64 v21, v[240:241] offset:32
    s_mov_b64 exec, s[50:51]
    ds_write_b64 v21, v[238:239] offset:1280
    ds_write_b64 v21, v[242:243] offset:1312
    s_mov_b64 exec, s[52:53]
    ds_write_b64 v21, v[244:245] offset:64
    s_mov_b64 exec, s[54:55]
    ds_write_b64 v21, v[246:247] offset:1344
    s_mov_b64 exec, -1
    ds_read_b32 v208, v253 offset:0
    ds_read_b32 v209, v253 offset:4
    ds_read_b32 v210, v253 offset:8
    ds_read_b32 v212, v253 offset:768
    ds_read_b32 v213, v253 offset:772
    ds_read_b32 v214, v253 offset:776
    ds_read_b32 v216, v253 offset:1536
    ds_read_b32 v217, v253 offset:1540
    ds_read_b32 v218, v253 offset:1544
    ds_read_b32 v19, v17 offset:40
    s_waitcnt lgkmcnt(7)
    buffer_store_dwordx4 v[208:211], v254, s[56:59], s68 offen offset:0 sc1
    s_waitcnt lgkmcnt(4)
    buffer_store_dwordx4 v[212:215], v254, s[56:59], s68 offen offset:1024 sc1
    s_waitcnt lgkmcnt(1)
    buffer_store_dwordx4 v[216:219], v255, s[56:59], s68 offen offset:2048 sc1
    ds_write_b8 v16, v18 offset:144
    s_waitcnt lgkmcnt(0)
    v_readfirstlane_b32 s70, v19
    s_nop 0
    s_cmp_eq_u32 s70, 16843009
    s_cbranch_scc0 slow_76
back_77:
    ds_read_b64_tr_b16 v[104:105], v9 offset:0
    ds_read_b64_tr_b16 v[106:107], v9 offset:1280
    ds_read_b64_tr_b16 v[108:109], v9 offset:8
    ds_read_b64_tr_b16 v[110:111], v9 offset:1288
    ds_read_b64_tr_b16 v[112:113], v9 offset:16
    ds_read_b64_tr_b16 v[114:115], v9 offset:1296
    ds_read_b64_tr_b16 v[116:117], v9 offset:24
    ds_read_b64_tr_b16 v[118:119], v9 offset:1304
    ds_read_b64_tr_b16 v[120:121], v9 offset:32
    ds_read_b64_tr_b16 v[122:123], v9 offset:1312
    ds_read_b64_tr_b16 v[124:125], v9 offset:5120
    ds_read_b64_tr_b16 v[126:127], v9 offset:6400
    ds_read_b64_tr_b16 v[128:129], v9 offset:5128
    ds_read_b64_tr_b16 v[130:131], v9 offset:6408
    ds_read_b64_tr_b16 v[132:133], v9 offset:5136
    ds_read_b64_tr_b16 v[134:135], v9 offset:6416
    ds_read_b64_tr_b16 v[136:137], v9 offset:5144
    ds_read_b64_tr_b16 v[138:139], v9 offset:6424
    ds_read_b64_tr_b16 v[140:141], v9 offset:5152
    ds_read_b64_tr_b16 v[142:143], v9 offset:6432
    s_waitcnt lgkmcnt(10)
    ds_read_b64_tr_b16 v[144:145], v9 offset:10240
    ds_read_b64_tr_b16 v[146:147], v9 offset:11520
    ds_read_b64_tr_b16 v[148:149], v9 offset:10248
    v_mfma_f32_16x16x32_bf16 v[164:167], v[104:107], v[24:27], 0
    ds_read_b64_tr_b16 v[150:151], v9 offset:11528
    ds_read_b64_tr_b16 v[152:153], v9 offset:10256
    ds_read_b64_tr_b16 v[154:155], v9 offset:11536
    v_mfma_f32_16x16x32_bf16 v[168:171], v[108:111], v[24:27], 0
    ds_read_b64_tr_b16 v[156:157], v9 offset:10264
    ds_read_b64_tr_b16 v[158:159], v9 offset:11544
    ds_read_b64_tr_b16 v[160:161], v9 offset:10272
    v_mfma_f32_16x16x32_bf16 v[172:175], v[112:115], v[24:27], 0
    ds_read_b64_tr_b16 v[162:163], v9 offset:11552
    ds_read_b32 v19, v17 offset:44
    v_mfma_f32_16x16x32_bf16 v[176:179], v[116:119], v[24:27], 0
    v_mfma_f32_16x16x32_bf16 v[180:183], v[120:123], v[24:27], 0
    s_waitcnt lgkmcnt(11)
    ds_read_b64_tr_b16 v[104:105], v9 offset:15360
    ds_read_b64_tr_b16 v[106:107], v9 offset:16640
    v_mfma_f32_16x16x32_bf16 v[164:167], v[124:127], v[28:31], v[164:167]
    ds_read_b64_tr_b16 v[108:109], v9 offset:15368
    ds_read_b64_tr_b16 v[110:111], v9 offset:16648
    v_mfma_f32_16x16x32_bf16 v[168:171], v[128:131], v[28:31], v[168:171]
    ds_read_b64_tr_b16 v[112:113], v9 offset:15376
    ds_read_b64_tr_b16 v[114:115], v9 offset:16656
    v_mfma_f32_16x16x32_bf16 v[172:175], v[132:135], v[28:31], v[172:175]
    ds_read_b64_tr_b16 v[116:117], v9 offset:15384
    ds_read_b64_tr_b16 v[118:119], v9 offset:16664
    v_mfma_f32_16x16x32_bf16 v[176:179], v[136:139], v[28:31], v[176:179]
    ds_read_b64_tr_b16 v[120:121], v9 offset:15392
    ds_read_b64_tr_b16 v[122:123], v9 offset:16672
    v_mfma_f32_16x16x32_bf16 v[180:183], v[140:143], v[28:31], v[180:183]
    s_waitcnt lgkmcnt(10)
    v_readfirstlane_b32 s70, v19
    s_nop 0
    s_cmp_eq_u32 s70, 16843009
    s_cbranch_scc0 slow_78
back_79:
    s_waitcnt lgkmcnt(10)
    ds_read_b64_tr_b16 v[124:125], v9 offset:40960
    ds_read_b64_tr_b16 v[126:127], v9 offset:42240
    v_mfma_f32_16x16x32_bf16 v[164:167], v[144:147], v[32:35], v[164:167]
    ds_read_b64_tr_b16 v[128:129], v9 offset:40968
    ds_read_b64_tr_b16 v[130:131], v9 offset:42248
    v_mfma_f32_16x16x32_bf16 v[168:171], v[148:151], v[32:35], v[168:171]
    ds_read_b64_tr_b16 v[132:133], v9 offset:40976
    ds_read_b64_tr_b16 v[134:135], v9 offset:42256
    v_mfma_f32_16x16x32_bf16 v[172:175], v[152:155], v[32:35], v[172:175]
    ds_read_b64_tr_b16 v[136:137], v9 offset:40984
    ds_read_b64_tr_b16 v[138:139], v9 offset:42264
    v_mfma_f32_16x16x32_bf16 v[176:179], v[156:159], v[32:35], v[176:179]
    ds_read_b64_tr_b16 v[140:141], v9 offset:40992
    ds_read_b64_tr_b16 v[142:143], v9 offset:42272
    v_mfma_f32_16x16x32_bf16 v[180:183], v[160:163], v[32:35], v[180:183]
    s_waitcnt lgkmcnt(10)
    ds_read_b64_tr_b16 v[144:145], v9 offset:46080
    ds_read_b64_tr_b16 v[146:147], v9 offset:47360
    v_mfma_f32_16x16x32_bf16 v[164:167], v[104:107], v[36:39], v[164:167]
    ds_read_b64_tr_b16 v[148:149], v9 offset:46088
    ds_read_b64_tr_b16 v[150:151], v9 offset:47368
    v_mfma_f32_16x16x32_bf16 v[168:171], v[108:111], v[36:39], v[168:171]
    ds_read_b64_tr_b16 v[152:153], v9 offset:46096
    ds_read_b64_tr_b16 v[154:155], v9 offset:47376
    v_mfma_f32_16x16x32_bf16 v[172:175], v[112:115], v[36:39], v[172:175]
    ds_read_b64_tr_b16 v[156:157], v9 offset:46104
    ds_read_b64_tr_b16 v[158:159], v9 offset:47384
    v_mfma_f32_16x16x32_bf16 v[176:179], v[116:119], v[36:39], v[176:179]
    ds_read_b64_tr_b16 v[160:161], v9 offset:46112
    ds_read_b64_tr_b16 v[162:163], v9 offset:47392
    v_mfma_f32_16x16x32_bf16 v[180:183], v[120:123], v[36:39], v[180:183]
    s_waitcnt lgkmcnt(10)
    ds_read_b64_tr_b16 v[104:105], v9 offset:51200
    ds_read_b64_tr_b16 v[106:107], v9 offset:52480
    ds_read_b64_tr_b16 v[108:109], v9 offset:51208
    v_mfma_f32_16x16x32_bf16 v[164:167], v[124:127], v[40:43], v[164:167]
    ds_read_b64_tr_b16 v[110:111], v9 offset:52488
    ds_read_b64_tr_b16 v[112:113], v9 offset:51216
    ds_read_b64_tr_b16 v[114:115], v9 offset:52496
    v_mfma_f32_16x16x32_bf16 v[168:171], v[128:131], v[40:43], v[168:171]
    ds_read_b64_tr_b16 v[116:117], v9 offset:51224
    ds_read_b64_tr_b16 v[118:119], v9 offset:52504
    ds_read_b64_tr_b16 v[120:121], v9 offset:51232
    v_mfma_f32_16x16x32_bf16 v[172:175], v[132:135], v[40:43], v[172:175]
    ds_read_b64_tr_b16 v[122:123], v9 offset:52512
    ds_read_b32 v19, v17 offset:48
    v_mfma_f32_16x16x32_bf16 v[176:179], v[136:139], v[40:43], v[176:179]
    v_mfma_f32_16x16x32_bf16 v[180:183], v[140:143], v[40:43], v[180:183]
    s_waitcnt lgkmcnt(11)
    ds_read_b64_tr_b16 v[124:125], v9 offset:56320
    ds_read_b64_tr_b16 v[126:127], v9 offset:57600
    v_mfma_f32_16x16x32_bf16 v[164:167], v[144:147], v[44:47], v[164:167]
    ds_read_b64_tr_b16 v[128:129], v9 offset:56328
    ds_read_b64_tr_b16 v[130:131], v9 offset:57608
    v_mfma_f32_16x16x32_bf16 v[168:171], v[148:151], v[44:47], v[168:171]
    ds_read_b64_tr_b16 v[132:133], v9 offset:56336
    ds_read_b64_tr_b16 v[134:135], v9 offset:57616
    v_mfma_f32_16x16x32_bf16 v[172:175], v[152:155], v[44:47], v[172:175]
    ds_read_b64_tr_b16 v[136:137], v9 offset:56344
    ds_read_b64_tr_b16 v[138:139], v9 offset:57624
    v_mfma_f32_16x16x32_bf16 v[176:179], v[156:159], v[44:47], v[176:179]
    ds_read_b64_tr_b16 v[140:141], v9 offset:56352
    ds_read_b64_tr_b16 v[142:143], v9 offset:57632
    v_mfma_f32_16x16x32_bf16 v[180:183], v[160:163], v[44:47], v[180:183]
    s_waitcnt vmcnt(0)
    ds_write_b8 v16, v18 offset:136
    s_waitcnt lgkmcnt(10)
    v_readfirstlane_b32 s70, v19
    s_nop 0
    s_cmp_eq_u32 s70, 16843009
    s_cbranch_scc0 slow_80
back_81:
    s_waitcnt lgkmcnt(10)
    ds_read_b64_tr_b16 v[144:145], v10 offset:0
    ds_read_b64_tr_b16 v[146:147], v10 offset:1280
    v_mfma_f32_16x16x32_bf16 v[164:167], v[104:107], v[48:51], v[164:167]
    ds_read_b64_tr_b16 v[148:149], v10 offset:8
    ds_read_b64_tr_b16 v[150:151], v10 offset:1288
    v_mfma_f32_16x16x32_bf16 v[168:171], v[108:111], v[48:51], v[168:171]
    ds_read_b64_tr_b16 v[152:153], v10 offset:16
    ds_read_b64_tr_b16 v[154:155], v10 offset:1296
    v_mfma_f32_16x16x32_bf16 v[172:175], v[112:115], v[48:51], v[172:175]
    ds_read_b64_tr_b16 v[156:157], v10 offset:24
    ds_read_b64_tr_b16 v[158:159], v10 offset:1304
    v_mfma_f32_16x16x32_bf16 v[176:179], v[116:119], v[48:51], v[176:179]
    ds_read_b64_tr_b16 v[160:161], v10 offset:32
    ds_read_b64_tr_b16 v[162:163], v10 offset:1312
    v_mfma_f32_16x16x32_bf16 v[180:183], v[120:123], v[48:51], v[180:183]
    s_waitcnt lgkmcnt(10)
    ds_read_b64_tr_b16 v[104:105], v10 offset:5120
    ds_read_b64_tr_b16 v[106:107], v10 offset:6400
    v_mfma_f32_16x16x32_bf16 v[164:167], v[124:127], v[52:55], v[164:167]
    ds_read_b64_tr_b16 v[108:109], v10 offset:5128
    ds_read_b64_tr_b16 v[110:111], v10 offset:6408
    v_mfma_f32_16x16x32_bf16 v[168:171], v[128:131], v[52:55], v[168:171]
    ds_read_b64_tr_b16 v[112:113], v10 offset:5136
    ds_read_b64_tr_b16 v[114:115], v10 offset:6416
    v_mfma_f32_16x16x32_bf16 v[172:175], v[132:135], v[52:55], v[172:175]
    ds_read_b64_tr_b16 v[116:117], v10 offset:5144
    ds_read_b64_tr_b16 v[118:119], v10 offset:6424
    v_mfma_f32_16x16x32_bf16 v[176:179], v[136:139], v[52:55], v[176:179]
    ds_read_b64_tr_b16 v[120:121], v10 offset:5152
    ds_read_b64_tr_b16 v[122:123], v10 offset:6432
    v_mfma_f32_16x16x32_bf16 v[180:183], v[140:143], v[52:55], v[180:183]
    s_waitcnt lgkmcnt(10)
    ds_read_b64_tr_b16 v[124:125], v10 offset:10240
    ds_read_b64_tr_b16 v[126:127], v10 offset:11520
    ds_read_b64_tr_b16 v[128:129], v10 offset:10248
    v_mfma_f32_16x16x32_bf16 v[164:167], v[144:147], v[56:59], v[164:167]
    ds_read_b64_tr_b16 v[130:131], v10 offset:11528
    ds_read_b64_tr_b16 v[132:133], v10 offset:10256
    ds_read_b64_tr_b16 v[134:135], v10 offset:11536
    v_mfma_f32_16x16x32_bf16 v[168:171], v[148:151], v[56:59], v[168:171]
    ds_read_b64_tr_b16 v[136:137], v10 offset:10264
    ds_read_b64_tr_b16 v[138:139], v10 offset:11544
    ds_read_b64_tr_b16 v[140:141], v10 offset:10272
    v_mfma_f32_16x16x32_bf16 v[172:175], v[152:155], v[56:59], v[172:175]
    ds_read_b64_tr_b16 v[142:143], v10 offset:11552
    ds_read_b32 v19, v17 offset:52
    v_mfma_f32_16x16x32_bf16 v[176:179], v[156:159], v[56:59], v[176:179]
    v_mfma_f32_16x16x32_bf16 v[180:183], v[160:163], v[56:59], v[180:183]
    s_waitcnt lgkmcnt(11)
    ds_read_b64_tr_b16 v[144:145], v10 offset:15360
    ds_read_b64_tr_b16 v[146:147], v10 offset:16640
    v_mfma_f32_16x16x32_bf16 v[164:167], v[104:107], v[60:63], v[164:167]
    ds_read_b64_tr_b16 v[148:149], v10 offset:15368
    ds_read_b64_tr_b16 v[150:151], v10 offset:16648
    v_mfma_f32_16x16x32_bf16 v[168:171], v[108:111], v[60:63], v[168:171]
    ds_read_b64_tr_b16 v[152:153], v10 offset:15376
    ds_read_b64_tr_b16 v[154:155], v10 offset:16656
    v_mfma_f32_16x16x32_bf16 v[172:175], v[112:115], v[60:63], v[172:175]
    ds_read_b64_tr_b16 v[156:157], v10 offset:15384
    ds_read_b64_tr_b16 v[158:159], v10 offset:16664
    v_mfma_f32_16x16x32_bf16 v[176:179], v[116:119], v[60:63], v[176:179]
    ds_read_b64_tr_b16 v[160:161], v10 offset:15392
    ds_read_b64_tr_b16 v[162:163], v10 offset:16672
    v_mfma_f32_16x16x32_bf16 v[180:183], v[120:123], v[60:63], v[180:183]
    s_waitcnt lgkmcnt(10)
    v_readfirstlane_b32 s70, v19
    s_nop 0
    s_cmp_eq_u32 s70, 16843009
    s_cbranch_scc0 slow_82
back_83:
    s_waitcnt lgkmcnt(10)
    ds_read_b64_tr_b16 v[104:105], v8 offset:0
    ds_read_b64_tr_b16 v[106:107], v8 offset:1280
    v_mfma_f32_16x16x32_bf16 v[164:167], v[124:127], v[64:67], v[164:167]
    ds_read_b64_tr_b16 v[108:109], v8 offset:8
    ds_read_b64_tr_b16 v[110:111], v8 offset:1288
    v_mfma_f32_16x16x32_bf16 v[168:171], v[128:131], v[64:67], v[168:171]
    ds_read_b64_tr_b16 v[112:113], v8 offset:16
    ds_read_b64_tr_b16 v[114:115], v8 offset:1296
    v_mfma_f32_16x16x32_bf16 v[172:175], v[132:135], v[64:67], v[172:175]
    ds_read_b64_tr_b16 v[116:117], v8 offset:24
    ds_read_b64_tr_b16 v[118:119], v8 offset:1304
    v_mfma_f32_16x16x32_bf16 v[176:179], v[136:139], v[64:67], v[176:179]
    ds_read_b64_tr_b16 v[120:121], v8 offset:32
    ds_read_b64_tr_b16 v[122:123], v8 offset:1312
    v_mfma_f32_16x16x32_bf16 v[180:183], v[140:143], v[64:67], v[180:183]
    s_waitcnt lgkmcnt(10)
    ds_read_b64_tr_b16 v[124:125], v8 offset:5120
    ds_read_b64_tr_b16 v[126:127], v8 offset:6400
    v_mfma_f32_16x16x32_bf16 v[164:167], v[144:147], v[68:71], v[164:167]
    ds_read_b64_tr_b16 v[128:129], v8 offset:5128
    ds_read_b64_tr_b16 v[130:131], v8 offset:6408
    v_mfma_f32_16x16x32_bf16 v[168:171], v[148:151], v[68:71], v[168:171]
    ds_read_b64_tr_b16 v[132:133], v8 offset:5136
    ds_read_b64_tr_b16 v[134:135], v8 offset:6416
    v_mfma_f32_16x16x32_bf16 v[172:175], v[152:155], v[68:71], v[172:175]
    ds_read_b64_tr_b16 v[136:137], v8 offset:5144
    ds_read_b64_tr_b16 v[138:139], v8 offset:6424
    v_mfma_f32_16x16x32_bf16 v[176:179], v[156:159], v[68:71], v[176:179]
    ds_read_b64_tr_b16 v[140:141], v8 offset:5152
    ds_read_b64_tr_b16 v[142:143], v8 offset:6432
    v_mfma_f32_16x16x32_bf16 v[180:183], v[160:163], v[68:71], v[180:183]
    s_waitcnt lgkmcnt(10)
    ds_read_b64_tr_b16 v[144:145], v8 offset:10240
    ds_read_b64_tr_b16 v[146:147], v8 offset:11520
    ds_read_b64_tr_b16 v[148:149], v8 offset:10248
    v_mfma_f32_16x16x32_bf16 v[164:167], v[104:107], v[72:75], v[164:167]
    ds_read_b64_tr_b16 v[150:151], v8 offset:11528
    ds_read_b64_tr_b16 v[152:153], v8 offset:10256
    ds_read_b64_tr_b16 v[154:155], v8 offset:11536
    v_mfma_f32_16x16x32_bf16 v[168:171], v[108:111], v[72:75], v[168:171]
    ds_read_b64_tr_b16 v[156:157], v8 offset:10264
    ds_read_b64_tr_b16 v[158:159], v8 offset:11544
    ds_read_b64_tr_b16 v[160:161], v8 offset:10272
    v_mfma_f32_16x16x32_bf16 v[172:175], v[112:115], v[72:75], v[172:175]
    ds_read_b64_tr_b16 v[162:163], v8 offset:11552
    ds_read_b32 v19, v17 offset:56
    v_mfma_f32_16x16x32_bf16 v[176:179], v[116:119], v[72:75], v[176:179]
    v_mfma_f32_16x16x32_bf16 v[180:183], v[120:123], v[72:75], v[180:183]
    s_waitcnt lgkmcnt(11)
    ds_read_b64_tr_b16 v[104:105], v8 offset:15360
    ds_read_b64_tr_b16 v[106:107], v8 offset:16640
    v_mfma_f32_16x16x32_bf16 v[164:167], v[124:127], v[76:79], v[164:167]
    ds_read_b64_tr_b16 v[108:109], v8 offset:15368
    ds_read_b64_tr_b16 v[110:111], v8 offset:16648
    v_mfma_f32_16x16x32_bf16 v[168:171], v[128:131], v[76:79], v[168:171]
    ds_read_b64_tr_b16 v[112:113], v8 offset:15376
    ds_read_b64_tr_b16 v[114:115], v8 offset:16656
    v_mfma_f32_16x16x32_bf16 v[172:175], v[132:135], v[76:79], v[172:175]
    ds_read_b64_tr_b16 v[116:117], v8 offset:15384
    ds_read_b64_tr_b16 v[118:119], v8 offset:16664
    v_mfma_f32_16x16x32_bf16 v[176:179], v[136:139], v[76:79], v[176:179]
    ds_read_b64_tr_b16 v[120:121], v8 offset:15392
    ds_read_b64_tr_b16 v[122:123], v8 offset:16672
    v_mfma_f32_16x16x32_bf16 v[180:183], v[140:143], v[76:79], v[180:183]
    s_waitcnt lgkmcnt(10)
    v_readfirstlane_b32 s70, v19
    s_nop 0
    s_cmp_eq_u32 s70, 16843009
    s_cbranch_scc0 slow_84
back_85:
    s_waitcnt lgkmcnt(10)
    ds_read_b64_tr_b16 v[124:125], v8 offset:20480
    ds_read_b64_tr_b16 v[126:127], v8 offset:21760
    v_mfma_f32_16x16x32_bf16 v[164:167], v[144:147], v[80:83], v[164:167]
    ds_read_b64_tr_b16 v[128:129], v8 offset:20488
    ds_read_b64_tr_b16 v[130:131], v8 offset:21768
    v_mfma_f32_16x16x32_bf16 v[168:171], v[148:151], v[80:83], v[168:171]
    ds_read_b64_tr_b16 v[132:133], v8 offset:20496
    ds_read_b64_tr_b16 v[134:135], v8 offset:21776
    v_mfma_f32_16x16x32_bf16 v[172:175], v[152:155], v[80:83], v[172:175]
    ds_read_b64_tr_b16 v[136:137], v8 offset:20504
    ds_read_b64_tr_b16 v[138:139], v8 offset:21784
    v_mfma_f32_16x16x32_bf16 v[176:179], v[156:159], v[80:83], v[176:179]
    ds_read_b64_tr_b16 v[140:141], v8 offset:20512
    ds_read_b64_tr_b16 v[142:143], v8 offset:21792
    v_mfma_f32_16x16x32_bf16 v[180:183], v[160:163], v[80:83], v[180:183]
    s_waitcnt lgkmcnt(10)
    ds_read_b64_tr_b16 v[144:145], v8 offset:25600
    ds_read_b64_tr_b16 v[146:147], v8 offset:26880
    v_mfma_f32_16x16x32_bf16 v[164:167], v[104:107], v[84:87], v[164:167]
    ds_read_b64_tr_b16 v[148:149], v8 offset:25608
    ds_read_b64_tr_b16 v[150:151], v8 offset:26888
    v_mfma_f32_16x16x32_bf16 v[168:171], v[108:111], v[84:87], v[168:171]
    ds_read_b64_tr_b16 v[152:153], v8 offset:25616
    ds_read_b64_tr_b16 v[154:155], v8 offset:26896
    v_mfma_f32_16x16x32_bf16 v[172:175], v[112:115], v[84:87], v[172:175]
    ds_read_b64_tr_b16 v[156:157], v8 offset:25624
    ds_read_b64_tr_b16 v[158:159], v8 offset:26904
    v_mfma_f32_16x16x32_bf16 v[176:179], v[116:119], v[84:87], v[176:179]
    ds_read_b64_tr_b16 v[160:161], v8 offset:25632
    ds_read_b64_tr_b16 v[162:163], v8 offset:26912
    v_mfma_f32_16x16x32_bf16 v[180:183], v[120:123], v[84:87], v[180:183]
    s_waitcnt lgkmcnt(10)
    ds_read_b64_tr_b16 v[104:105], v8 offset:30720
    ds_read_b64_tr_b16 v[106:107], v8 offset:32000
    v_mfma_f32_16x16x32_bf16 v[164:167], v[124:127], v[88:91], v[164:167]
    ds_read_b64_tr_b16 v[108:109], v8 offset:30728
    ds_read_b64_tr_b16 v[110:111], v8 offset:32008
    v_mfma_f32_16x16x32_bf16 v[168:171], v[128:131], v[88:91], v[168:171]
    ds_read_b64_tr_b16 v[112:113], v8 offset:30736
    ds_read_b64_tr_b16 v[114:115], v8 offset:32016
    v_mfma_f32_16x16x32_bf16 v[172:175], v[132:135], v[88:91], v[172:175]
    ds_read_b64_tr_b16 v[116:117], v8 offset:30744
    ds_read_b64_tr_b16 v[118:119], v8 offset:32024
    v_mfma_f32_16x16x32_bf16 v[176:179], v[136:139], v[88:91], v[176:179]
    ds_read_b64_tr_b16 v[120:121], v8 offset:30752
    ds_read_b64_tr_b16 v[122:123], v8 offset:32032
    v_mfma_f32_16x16x32_bf16 v[180:183], v[140:143], v[88:91], v[180:183]
    s_waitcnt lgkmcnt(10)
    ds_read_b64_tr_b16 v[124:125], v8 offset:35840
    ds_read_b64_tr_b16 v[126:127], v8 offset:37120
    v_mfma_f32_16x16x32_bf16 v[164:167], v[144:147], v[92:95], v[164:167]
    ds_read_b64_tr_b16 v[128:129], v8 offset:35848
    ds_read_b64_tr_b16 v[130:131], v8 offset:37128
    v_mfma_f32_16x16x32_bf16 v[168:171], v[148:151], v[92:95], v[168:171]
    ds_read_b64_tr_b16 v[132:133], v8 offset:35856
    ds_read_b64_tr_b16 v[134:135], v8 offset:37136
    v_mfma_f32_16x16x32_bf16 v[172:175], v[152:155], v[92:95], v[172:175]
    ds_read_b64_tr_b16 v[136:137], v8 offset:35864
    ds_read_b64_tr_b16 v[138:139], v8 offset:37144
    v_mfma_f32_16x16x32_bf16 v[176:179], v[156:159], v[92:95], v[176:179]
    ds_read_b64_tr_b16 v[140:141], v8 offset:35872
    ds_read_b64_tr_b16 v[142:143], v8 offset:37152
    v_mfma_f32_16x16x32_bf16 v[180:183], v[160:163], v[92:95], v[180:183]
    s_waitcnt lgkmcnt(10)
    v_mfma_f32_16x16x32_bf16 v[164:167], v[104:107], v[96:99], v[164:167]
    v_mfma_f32_16x16x32_bf16 v[168:171], v[108:111], v[96:99], v[168:171]
    v_mfma_f32_16x16x32_bf16 v[172:175], v[112:115], v[96:99], v[172:175]
    v_mfma_f32_16x16x32_bf16 v[176:179], v[116:119], v[96:99], v[176:179]
    v_mfma_f32_16x16x32_bf16 v[180:183], v[120:123], v[96:99], v[180:183]
    s_waitcnt lgkmcnt(0)
    v_mfma_f32_16x16x32_bf16 v[164:167], v[124:127], v[100:103], v[164:167]
    v_mfma_f32_16x16x32_bf16 v[168:171], v[128:131], v[100:103], v[168:171]
    v_mfma_f32_16x16x32_bf16 v[172:175], v[132:135], v[100:103], v[172:175]
    v_mfma_f32_16x16x32_bf16 v[176:179], v[136:139], v[100:103], v[176:179]
    v_mfma_f32_16x16x32_bf16 v[180:183], v[140:143], v[100:103], v[180:183]
    ds_write_b8 v16, v18 offset:148
    ds_read_b64_tr_b16 v[104:105], v11 offset:0
    ds_read_b64_tr_b16 v[106:107], v11 offset:160
    ds_read_b64_tr_b16 v[108:109], v11 offset:320
    ds_read_b64_tr_b16 v[110:111], v11 offset:480
    ds_read_b64_tr_b16 v[112:113], v11 offset:640
    v_mov_b32 v114, 0
    v_mov_b32 v115, 0
    ds_read_b64_tr_b16 v[116:117], v11 offset:8
    ds_read_b64_tr_b16 v[118:119], v11 offset:168
    ds_read_b64_tr_b16 v[120:121], v11 offset:328
    ds_read_b64_tr_b16 v[122:123], v11 offset:488
    ds_read_b64_tr_b16 v[124:125], v11 offset:648
    v_mov_b32 v126, 0
    v_mov_b32 v127, 0
    ds_read_b64_tr_b16 v[128:129], v11 offset:16
    ds_read_b64_tr_b16 v[130:131], v11 offset:176
    ds_read_b64_tr_b16 v[132:133], v11 offset:336
    ds_read_b64_tr_b16 v[134:135], v11 offset:496
    ds_read_b64_tr_b16 v[136:137], v11 offset:656
    v_mov_b32 v138, 0
    v_mov_b32 v139, 0
    ds_read_b64_tr_b16 v[140:141], v11 offset:24
    ds_read_b64_tr_b16 v[142:143], v11 offset:184
    ds_read_b64_tr_b16 v[144:145], v11 offset:344
    ds_read_b64_tr_b16 v[146:147], v11 offset:504
    ds_read_b64_tr_b16 v[148:149], v11 offset:664
    v_mov_b32 v150, 0
    v_mov_b32 v151, 0
    ds_read_b64_tr_b16 v[152:153], v11 offset:32
    ds_read_b64_tr_b16 v[154:155], v11 offset:192
    ds_read_b64_tr_b16 v[156:157], v11 offset:352
    ds_read_b64_tr_b16 v[158:159], v11 offset:512
    ds_read_b64_tr_b16 v[160:161], v11 offset:672
    v_mov_b32 v162, 0
    v_mov_b32 v163, 0
    v_pk_mul_f32 v[164:165], v[164:165], v[14:15] op_sel_hi:[1,0]
    v_pk_mul_f32 v[166:167], v[166:167], v[14:15] op_sel_hi:[1,0]
    v_pk_mul_f32 v[168:169], v[168:169], v[14:15] op_sel_hi:[1,0]
    v_pk_mul_f32 v[170:171], v[170:171], v[14:15] op_sel_hi:[1,0]
    v_pk_mul_f32 v[172:173], v[172:173], v[14:15] op_sel_hi:[1,0]
    v_pk_mul_f32 v[174:175], v[174:175], v[14:15] op_sel_hi:[1,0]
    v_pk_mul_f32 v[176:177], v[176:177], v[14:15] op_sel_hi:[1,0]
    v_pk_mul_f32 v[178:179], v[178:179], v[14:15] op_sel_hi:[1,0]
    v_pk_mul_f32 v[180:181], v[180:181], v[14:15] op_sel_hi:[1,0]
    v_pk_mul_f32 v[182:183], v[182:183], v[14:15] op_sel_hi:[1,0]
    v_cvt_pk_bf16_f32 v236, v164, v165
    v_cvt_pk_bf16_f32 v237, v166, v167
    v_cvt_pk_bf16_f32 v238, v168, v169
    v_cvt_pk_bf16_f32 v239, v170, v171
    v_cvt_pk_bf16_f32 v240, v172, v173
    v_cvt_pk_bf16_f32 v241, v174, v175
    v_cvt_pk_bf16_f32 v242, v176, v177
    v_cvt_pk_bf16_f32 v243, v178, v179
    v_cvt_pk_bf16_f32 v244, v180, v181
    v_cvt_pk_bf16_f32 v245, v182, v183
    v_mov_b32 v246, 0
    v_mov_b32 v247, 0
    s_waitcnt lgkmcnt(0)
    v_mfma_f32_16x16x32_bf16 v[184:187], v[104:107], v[236:239], 0
    v_mfma_f32_16x16x32_bf16 v[184:187], v[108:111], v[240:243], v[184:187]
    v_mfma_f32_16x16x32_bf16 v[184:187], v[112:115], v[244:247], v[184:187]
    v_mfma_f32_16x16x32_bf16 v[188:191], v[116:119], v[236:239], 0
    v_mfma_f32_16x16x32_bf16 v[188:191], v[120:123], v[240:243], v[188:191]
    v_mfma_f32_16x16x32_bf16 v[188:191], v[124:127], v[244:247], v[188:191]
    v_mfma_f32_16x16x32_bf16 v[192:195], v[128:131], v[236:239], 0
    v_mfma_f32_16x16x32_bf16 v[192:195], v[132:135], v[240:243], v[192:195]
    v_mfma_f32_16x16x32_bf16 v[192:195], v[136:139], v[244:247], v[192:195]
    v_mfma_f32_16x16x32_bf16 v[196:199], v[140:143], v[236:239], 0
    v_mfma_f32_16x16x32_bf16 v[196:199], v[144:147], v[240:243], v[196:199]
    v_mfma_f32_16x16x32_bf16 v[196:199], v[148:151], v[244:247], v[196:199]
    v_mfma_f32_16x16x32_bf16 v[200:203], v[152:155], v[236:239], 0
    v_mfma_f32_16x16x32_bf16 v[200:203], v[156:159], v[240:243], v[200:203]
    v_mfma_f32_16x16x32_bf16 v[200:203], v[160:163], v[244:247], v[200:203]
    v_max3_f32 v228, v184, v185, v186
    v_min3_f32 v230, v184, v185, v186
    v_max3_f32 v228, v228, v187, v188
    v_min3_f32 v230, v230, v187, v188
    v_max3_f32 v228, v228, v189, v190
    v_min3_f32 v230, v230, v189, v190
    v_max3_f32 v228, v228, v191, v192
    v_min3_f32 v230, v230, v191, v192
    v_max3_f32 v228, v228, v193, v194
    v_min3_f32 v230, v230, v193, v194
    v_max3_f32 v228, v228, v195, v196
    v_min3_f32 v230, v230, v195, v196
    v_max3_f32 v228, v228, v197, v198
    v_min3_f32 v230, v230, v197, v198
    v_max3_f32 v228, v228, v199, v200
    v_min3_f32 v230, v230, v199, v200
    v_max3_f32 v228, v228, v201, v202
    v_min3_f32 v230, v230, v201, v202
    v_max_f32 v228, v228, v203
    v_min_f32 v230, v230, v203
    v_mov_b32 v232, 1069066811
    v_mul_f32 v228, v232, v228
    v_mul_f32 v230, v232, v230
    v_pk_fma_f32 v[164:165], v[184:185], v[232:233], v[228:229] op_sel_hi:[1,0,0] neg_lo:[0,0,1] neg_hi:[0,0,1]
    v_pk_fma_f32 v[104:105], v[184:185], v[232:233], v[230:231] op_sel_hi:[1,0,0] neg_lo:[1,0,0] neg_hi:[1,0,0]
    v_pk_fma_f32 v[166:167], v[186:187], v[232:233], v[228:229] op_sel_hi:[1,0,0] neg_lo:[0,0,1] neg_hi:[0,0,1]
    v_pk_fma_f32 v[106:107], v[186:187], v[232:233], v[230:231] op_sel_hi:[1,0,0] neg_lo:[1,0,0] neg_hi:[1,0,0]
    v_pk_fma_f32 v[168:169], v[188:189], v[232:233], v[228:229] op_sel_hi:[1,0,0] neg_lo:[0,0,1] neg_hi:[0,0,1]
    v_pk_fma_f32 v[108:109], v[188:189], v[232:233], v[230:231] op_sel_hi:[1,0,0] neg_lo:[1,0,0] neg_hi:[1,0,0]
    v_pk_fma_f32 v[170:171], v[190:191], v[232:233], v[228:229] op_sel_hi:[1,0,0] neg_lo:[0,0,1] neg_hi:[0,0,1]
    v_pk_fma_f32 v[110:111], v[190:191], v[232:233], v[230:231] op_sel_hi:[1,0,0] neg_lo:[1,0,0] neg_hi:[1,0,0]
    v_pk_fma_f32 v[172:173], v[192:193], v[232:233], v[228:229] op_sel_hi:[1,0,0] neg_lo:[0,0,1] neg_hi:[0,0,1]
    v_pk_fma_f32 v[112:113], v[192:193], v[232:233], v[230:231] op_sel_hi:[1,0,0] neg_lo:[1,0,0] neg_hi:[1,0,0]
    v_pk_fma_f32 v[174:175], v[194:195], v[232:233], v[228:229] op_sel_hi:[1,0,0] neg_lo:[0,0,1] neg_hi:[0,0,1]
    v_pk_fma_f32 v[114:115], v[194:195], v[232:233], v[230:231] op_sel_hi:[1,0,0] neg_lo:[1,0,0] neg_hi:[1,0,0]
    v_pk_fma_f32 v[176:177], v[196:197], v[232:233], v[228:229] op_sel_hi:[1,0,0] neg_lo:[0,0,1] neg_hi:[0,0,1]
    v_pk_fma_f32 v[116:117], v[196:197], v[232:233], v[230:231] op_sel_hi:[1,0,0] neg_lo:[1,0,0] neg_hi:[1,0,0]
    v_pk_fma_f32 v[178:179], v[198:199], v[232:233], v[228:229] op_sel_hi:[1,0,0] neg_lo:[0,0,1] neg_hi:[0,0,1]
    v_pk_fma_f32 v[118:119], v[198:199], v[232:233], v[230:231] op_sel_hi:[1,0,0] neg_lo:[1,0,0] neg_hi:[1,0,0]
    v_pk_fma_f32 v[180:181], v[200:201], v[232:233], v[228:229] op_sel_hi:[1,0,0] neg_lo:[0,0,1] neg_hi:[0,0,1]
    v_pk_fma_f32 v[120:121], v[200:201], v[232:233], v[230:231] op_sel_hi:[1,0,0] neg_lo:[1,0,0] neg_hi:[1,0,0]
    v_pk_fma_f32 v[182:183], v[202:203], v[232:233], v[228:229] op_sel_hi:[1,0,0] neg_lo:[0,0,1] neg_hi:[0,0,1]
    v_pk_fma_f32 v[122:123], v[202:203], v[232:233], v[230:231] op_sel_hi:[1,0,0] neg_lo:[1,0,0] neg_hi:[1,0,0]
    v_exp_f32 v164, v164
    v_exp_f32 v104, v104
    v_exp_f32 v165, v165
    v_exp_f32 v105, v105
    v_exp_f32 v166, v166
    v_exp_f32 v106, v106
    v_exp_f32 v167, v167
    v_exp_f32 v107, v107
    v_exp_f32 v168, v168
    v_exp_f32 v108, v108
    v_exp_f32 v169, v169
    v_exp_f32 v109, v109
    v_exp_f32 v170, v170
    v_exp_f32 v110, v110
    v_exp_f32 v171, v171
    v_exp_f32 v111, v111
    v_exp_f32 v172, v172
    v_exp_f32 v112, v112
    v_exp_f32 v173, v173
    v_exp_f32 v113, v113
    v_exp_f32 v174, v174
    v_exp_f32 v114, v114
    v_exp_f32 v175, v175
    v_exp_f32 v115, v115
    v_exp_f32 v176, v176
    v_exp_f32 v116, v116
    v_exp_f32 v177, v177
    v_exp_f32 v117, v117
    v_exp_f32 v178, v178
    v_exp_f32 v118, v118
    v_exp_f32 v179, v179
    v_exp_f32 v119, v119
    v_exp_f32 v180, v180
    v_exp_f32 v120, v120
    v_exp_f32 v181, v181
    v_exp_f32 v121, v121
    v_exp_f32 v182, v182
    v_exp_f32 v122, v122
    v_exp_f32 v183, v183
    v_exp_f32 v123, v123
    v_pk_add_f32 v[228:229], v[164:165], v[166:167]
    v_pk_add_f32 v[230:231], v[104:105], v[106:107]
    v_pk_add_f32 v[228:229], v[228:229], v[168:169]
    v_pk_add_f32 v[230:231], v[230:231], v[108:109]
    v_pk_add_f32 v[228:229], v[228:229], v[170:171]
    v_pk_add_f32 v[230:231], v[230:231], v[110:111]
    v_pk_add_f32 v[228:229], v[228:229], v[172:173]
    v_pk_add_f32 v[230:231], v[230:231], v[112:113]
    v_pk_add_f32 v[228:229], v[228:229], v[174:175]
    v_pk_add_f32 v[230:231], v[230:231], v[114:115]
    v_pk_add_f32 v[228:229], v[228:229], v[176:177]
    v_pk_add_f32 v[230:231], v[230:231], v[116:117]
    v_pk_add_f32 v[228:229], v[228:229], v[178:179]
    v_pk_add_f32 v[230:231], v[230:231], v[118:119]
    v_pk_add_f32 v[228:229], v[228:229], v[180:181]
    v_pk_add_f32 v[230:231], v[230:231], v[120:121]
    v_pk_add_f32 v[228:229], v[228:229], v[182:183]
    v_pk_add_f32 v[230:231], v[230:231], v[122:123]
    v_add_f32 v228, v228, v229
    v_add_f32 v230, v230, v231
    v_rcp_f32 v228, v228
    v_rcp_f32 v230, v230
    v_pk_mul_f32 v[164:165], v[164:165], v[228:229] op_sel_hi:[1,0]
    v_pk_mul_f32 v[104:105], v[104:105], v[230:231] op_sel_hi:[1,0]
    v_pk_mul_f32 v[166:167], v[166:167], v[228:229] op_sel_hi:[1,0]
    v_pk_mul_f32 v[106:107], v[106:107], v[230:231] op_sel_hi:[1,0]
    v_pk_mul_f32 v[168:169], v[168:169], v[228:229] op_sel_hi:[1,0]
    v_pk_mul_f32 v[108:109], v[108:109], v[230:231] op_sel_hi:[1,0]
    v_pk_mul_f32 v[170:171], v[170:171], v[228:229] op_sel_hi:[1,0]
    v_pk_mul_f32 v[110:111], v[110:111], v[230:231] op_sel_hi:[1,0]
    v_pk_mul_f32 v[172:173], v[172:173], v[228:229] op_sel_hi:[1,0]
    v_pk_mul_f32 v[112:113], v[112:113], v[230:231] op_sel_hi:[1,0]
    v_pk_mul_f32 v[174:175], v[174:175], v[228:229] op_sel_hi:[1,0]
    v_pk_mul_f32 v[114:115], v[114:115], v[230:231] op_sel_hi:[1,0]
    v_pk_mul_f32 v[176:177], v[176:177], v[228:229] op_sel_hi:[1,0]
    v_pk_mul_f32 v[116:117], v[116:117], v[230:231] op_sel_hi:[1,0]
    v_pk_mul_f32 v[178:179], v[178:179], v[228:229] op_sel_hi:[1,0]
    v_pk_mul_f32 v[118:119], v[118:119], v[230:231] op_sel_hi:[1,0]
    v_pk_mul_f32 v[180:181], v[180:181], v[228:229] op_sel_hi:[1,0]
    v_pk_mul_f32 v[120:121], v[120:121], v[230:231] op_sel_hi:[1,0]
    v_pk_mul_f32 v[182:183], v[182:183], v[228:229] op_sel_hi:[1,0]
    v_pk_mul_f32 v[122:123], v[122:123], v[230:231] op_sel_hi:[1,0]
    v_cvt_pk_bf16_f32 v208, v164, v165
    v_cvt_pk_bf16_f32 v218, v104, v105
    v_cvt_pk_bf16_f32 v209, v166, v167
    v_cvt_pk_bf16_f32 v219, v106, v107
    v_cvt_pk_bf16_f32 v210, v168, v169
    v_cvt_pk_bf16_f32 v220, v108, v109
    v_cvt_pk_bf16_f32 v211, v170, v171
    v_cvt_pk_bf16_f32 v221, v110, v111
    v_cvt_pk_bf16_f32 v212, v172, v173
    v_cvt_pk_bf16_f32 v222, v112, v113
    v_cvt_pk_bf16_f32 v213, v174, v175
    v_cvt_pk_bf16_f32 v223, v114, v115
    v_cvt_pk_bf16_f32 v214, v176, v177
    v_cvt_pk_bf16_f32 v224, v116, v117
    v_cvt_pk_bf16_f32 v215, v178, v179
    v_cvt_pk_bf16_f32 v225, v118, v119
    v_cvt_pk_bf16_f32 v216, v180, v181
    v_cvt_pk_bf16_f32 v226, v120, v121
    v_cvt_pk_bf16_f32 v217, v182, v183
    v_cvt_pk_bf16_f32 v227, v122, v123
    ds_read_b32 v19, v17 offset:144
    s_waitcnt lgkmcnt(0)
    v_readfirstlane_b32 s70, v19
    s_nop 0
    s_cmp_eq_u32 s70, 16843009
    s_cbranch_scc0 slow_86
back_87:
    ds_write_b128 v249, v[208:211] offset:0
    ds_write_b128 v249, v[212:215] offset:16
    ds_write_b128 v249, v[216:219] offset:32
    ds_write_b128 v249, v[220:223] offset:48
    ds_write_b128 v249, v[224:227] offset:64
    ds_write_b8 v16, v18 offset:152
    s_mul_i32 s36, s35, 5120
    s_add_u32 s36, s36, 81920
    v_mul_u32_u24 v5, 80, v2
    v_lshl_add_u32 v5, v3, 4, v5
    v_add_u32 v5, s36, v5
    v_cmp_eq_u32 vcc, 0, v3
    s_nop 1
    v_cndmask_b32 v12, 0, -1, vcc
    s_mul_i32 s37, s35, 1680
    s_add_u32 s37, s37, 147712
    v_mul_u32_u24 v160, 80, v2
    v_lshl_add_u32 v161, v3, 4, v160
    v_add_u32 v161, s37, v161
    v_add_u32 v160, s37, v160
    v_and_b32 v162, 3, v2
    v_mul_u32_u24 v162, 80, v162
    v_lshl_add_u32 v163, v3, 4, v162
    v_add_u32 v163, s37, v163
    v_add_u32 v162, s37, v162
    v_lshlrev_b32 v164, 4, v3
    v_add_u32 v164, s37, v164
    v_mov_b32 v165, s37
    s_mul_i32 s37, s35, 40
    s_add_u32 s37, s37, 40960
    v_mul_u32_u24 v20, 160, v2
    v_add_u32 v20, s37, v20
    v_lshl_add_u32 v21, v3, 3, v20
    s_lshl_b32 s36, s30, 6
    s_lshl_b32 s37, s35, 4
    s_add_u32 s36, s36, s37
    s_mul_i32 s36, s36, 1280
    s_mul_i32 s37, s31, 160
    s_add_u32 s36, s36, s37
    s_mov_b32 s40, s8
    s_mov_b32 s41, s9
    s_mov_b32 s42, 2621440
    s_mov_b32 s43, 0x20000
    s_add_u32 s64, s4, 11534336
    s_addc_u32 s65, s5, 0
    s_mov_b32 s66, 2621440
    s_mov_b32 s67, 0x20000
    s_add_u32 s72, s4, 14680064
    s_addc_u32 s73, s5, 0
    s_mov_b32 s74, 131072
    s_mov_b32 s75, 0x20000
    v_mul_u32_u24 v4, 1280, v2
    v_mul_u32_u24 v13, 40, v3
    v_add_u32 v4, v4, v13
    buffer_load_dwordx4 v[168:171], v4, s[40:43], s36 offen
    buffer_load_dwordx4 v[172:175], v4, s[40:43], s36 offen offset:16
    buffer_load_dwordx2 v[176:177], v4, s[40:43], s36 offen offset:32
    s_lshl_b32 s38, s30, 2
    s_add_u32 s38, s38, s35
    s_mul_i32 s39, s38, 20480
    s_mul_i32 s48, s31, 2560
    s_add_u32 s48, s48, s39
    s_mov_b32 s51, s48
    s_lshl_b32 s49, s38, 10
    s_add_u32 s49, s49, 0x1000
    s_lshl_b32 s50, s31, 7
    s_add_u32 s50, s50, s49
    s_mul_i32 s37, s35, 2560
    s_add_u32 s37, s37, 40960
    v_mul_u32_u24 v6, 160, v2
    v_lshl_add_u32 v7, v3, 4, v6
    v_add_u32 v7, s37, v7
    s_add_u32 s37, s37, 106752
    v_add3_u32 v6, v6, v13, s37
    v_cmp_gt_u32 vcc, 32, v0
    s_nop 1
    v_cndmask_b32 v255, v15, v254, vcc
    v_and_b32 v253, 7, v0
    v_lshlrev_b32 v253, 7, v253
    ds_read_b32 v19, v17 offset:152
    s_waitcnt lgkmcnt(0)
    v_readfirstlane_b32 s70, v19
    s_nop 0
    s_cmp_eq_u32 s70, 16843009
    s_cbranch_scc0 slow_88
back_89:
    ds_read_b128 v[24:27], v5 offset:0
    ds_read_b128 v[28:31], v5 offset:64
    ds_read_b128 v[32:35], v5 offset:1280
    ds_read_b128 v[36:39], v5 offset:1344
    ds_read_b128 v[40:43], v5 offset:2560
    ds_read_b128 v[44:47], v5 offset:2624
    ds_read_b128 v[48:51], v5 offset:3840
    ds_read_b128 v[52:55], v5 offset:3904
    s_waitcnt lgkmcnt(0)
    v_and_b32 v28, v12, v28
    v_and_b32 v29, v12, v29
    v_and_b32 v30, v12, v30
    v_and_b32 v31, v12, v31
    v_and_b32 v36, v12, v36
    v_and_b32 v37, v12, v37
    v_and_b32 v38, v12, v38
    v_and_b32 v39, v12, v39
    v_and_b32 v44, v12, v44
    v_and_b32 v45, v12, v45
    v_and_b32 v46, v12, v46
    v_and_b32 v47, v12, v47
    v_and_b32 v52, v12, v52
    v_and_b32 v53, v12, v53
    v_and_b32 v54, v12, v54
    v_and_b32 v55, v12, v55
wkv_90:
    ds_read_b32 v19, v17 offset:64
    s_waitcnt lgkmcnt(0)
    v_readfirstlane_b32 s70, v19
    s_nop 0
    s_cmp_lg_u32 s70, 0
    s_cbranch_scc1 gokv_91
    s_sleep 1
    s_branch wkv_90
gokv_91:
    ds_read_b128 v[56:59], v164 offset:1600
    ds_read_b128 v[60:63], v165 offset:1664
    ds_read_b128 v[64:67], v161
    ds_read_b128 v[68:71], v160 offset:64
    ds_read_b128 v[72:75], v163 offset:1280
    ds_read_b128 v[76:79], v162 offset:1344
    s_waitcnt lgkmcnt(4)
    v_mfma_f32_16x16x32_bf16 v[80:83], v[56:59], v[24:27], 0
    v_mfma_f32_16x16x32_bf16 v[84:87], v[56:59], v[32:35], 0
    v_mfma_f32_16x16x32_bf16 v[88:91], v[56:59], v[40:43], 0
    v_mfma_f32_16x16x32_bf16 v[92:95], v[56:59], v[48:51], 0
    v_mfma_f32_16x16x32_bf16 v[80:83], v[60:63], v[28:31], v[80:83]
    v_mfma_f32_16x16x32_bf16 v[84:87], v[60:63], v[36:39], v[84:87]
    v_mfma_f32_16x16x32_bf16 v[88:91], v[60:63], v[44:47], v[88:91]
    v_mfma_f32_16x16x32_bf16 v[92:95], v[60:63], v[52:55], v[92:95]
    s_waitcnt lgkmcnt(2)
    v_mfma_f32_16x16x32_bf16 v[96:99], v[64:67], v[24:27], 0
    v_mfma_f32_16x16x32_bf16 v[100:103], v[64:67], v[32:35], 0
    v_mfma_f32_16x16x32_bf16 v[104:107], v[64:67], v[40:43], 0
    v_mfma_f32_16x16x32_bf16 v[108:111], v[64:67], v[48:51], 0
    v_mfma_f32_16x16x32_bf16 v[96:99], v[68:71], v[28:31], v[96:99]
    v_mfma_f32_16x16x32_bf16 v[100:103], v[68:71], v[36:39], v[100:103]
    v_mfma_f32_16x16x32_bf16 v[104:107], v[68:71], v[44:47], v[104:107]
    v_mfma_f32_16x16x32_bf16 v[108:111], v[68:71], v[52:55], v[108:111]
    v_add_f32 v80, 897988541, v80
    v_add_f32 v84, 897988541, v84
    v_add_f32 v88, 897988541, v88
    v_add_f32 v92, 897988541, v92
    v_rcp_f32 v80, v80
    v_rcp_f32 v84, v84
    v_rcp_f32 v88, v88
    v_rcp_f32 v92, v92
    s_waitcnt lgkmcnt(0)
    v_mfma_f32_16x16x32_bf16 v[112:115], v[72:75], v[24:27], 0
    v_mfma_f32_16x16x32_bf16 v[116:119], v[72:75], v[32:35], 0
    v_mfma_f32_16x16x32_bf16 v[120:123], v[72:75], v[40:43], 0
    v_mfma_f32_16x16x32_bf16 v[124:127], v[72:75], v[48:51], 0
    v_mfma_f32_16x16x32_bf16 v[112:115], v[76:79], v[28:31], v[112:115]
    v_mfma_f32_16x16x32_bf16 v[116:119], v[76:79], v[36:39], v[116:119]
    v_mfma_f32_16x16x32_bf16 v[120:123], v[76:79], v[44:47], v[120:123]
    v_mfma_f32_16x16x32_bf16 v[124:127], v[76:79], v[52:55], v[124:127]
    v_pk_mul_f32 v[96:97], v[96:97], v[80:81] op_sel_hi:[1,0]
    v_pk_mul_f32 v[98:99], v[98:99], v[80:81] op_sel_hi:[1,0]
    v_cvt_pk_bf16_f32 v136, v96, v97
    v_cvt_pk_bf16_f32 v137, v98, v99
    ds_write_b64 v21, v[136:137] offset:0
    v_pk_mul_f32 v[100:101], v[100:101], v[84:85] op_sel_hi:[1,0]
    v_pk_mul_f32 v[102:103], v[102:103], v[84:85] op_sel_hi:[1,0]
    v_cvt_pk_bf16_f32 v138, v100, v101
    v_cvt_pk_bf16_f32 v139, v102, v103
    ds_write_b64 v21, v[138:139] offset:2560
    v_pk_mul_f32 v[104:105], v[104:105], v[88:89] op_sel_hi:[1,0]
    v_pk_mul_f32 v[106:107], v[106:107], v[88:89] op_sel_hi:[1,0]
    v_cvt_pk_bf16_f32 v140, v104, v105
    v_cvt_pk_bf16_f32 v141, v106, v107
    ds_write_b64 v21, v[140:141] offset:5120
    v_pk_mul_f32 v[108:109], v[108:109], v[92:93] op_sel_hi:[1,0]
    v_pk_mul_f32 v[110:111], v[110:111], v[92:93] op_sel_hi:[1,0]
    v_cvt_pk_bf16_f32 v142, v108, v109
    v_cvt_pk_bf16_f32 v143, v110, v111
    ds_write_b64 v21, v[142:143] offset:7680
    v_pk_mul_f32 v[112:113], v[112:113], v[80:81] op_sel_hi:[1,0]
    v_pk_mul_f32 v[114:115], v[114:115], v[80:81] op_sel_hi:[1,0]
    v_cvt_pk_bf16_f32 v144, v112, v113
    v_cvt_pk_bf16_f32 v145, v114, v115
    ds_write_b64 v20, v[144:145] offset:32
    v_pk_mul_f32 v[116:117], v[116:117], v[84:85] op_sel_hi:[1,0]
    v_pk_mul_f32 v[118:119], v[118:119], v[84:85] op_sel_hi:[1,0]
    v_cvt_pk_bf16_f32 v146, v116, v117
    v_cvt_pk_bf16_f32 v147, v118, v119
    ds_write_b64 v20, v[146:147] offset:2592
    v_pk_mul_f32 v[120:121], v[120:121], v[88:89] op_sel_hi:[1,0]
    v_pk_mul_f32 v[122:123], v[122:123], v[88:89] op_sel_hi:[1,0]
    v_cvt_pk_bf16_f32 v148, v120, v121
    v_cvt_pk_bf16_f32 v149, v122, v123
    ds_write_b64 v20, v[148:149] offset:5152
    v_pk_mul_f32 v[124:125], v[124:125], v[92:93] op_sel_hi:[1,0]
    v_pk_mul_f32 v[126:127], v[126:127], v[92:93] op_sel_hi:[1,0]
    v_cvt_pk_bf16_f32 v150, v124, v125
    v_cvt_pk_bf16_f32 v151, v126, v127
    ds_write_b64 v20, v[150:151] offset:7712
    ds_write_b8 v16, v18 offset:156
    ds_read_b32 v19, v17 offset:156
    s_waitcnt lgkmcnt(0)
    v_readfirstlane_b32 s70, v19
    s_nop 0
    s_cmp_eq_u32 s70, 16843009
    s_cbranch_scc0 slow_92
back_93:
    ds_read_b128 v[24:27], v7 offset:0
    ds_read_b128 v[28:31], v7 offset:64
    ds_read_b128 v[32:35], v7 offset:128
    s_waitcnt lgkmcnt(2)
    buffer_store_dwordx4 v[24:27], v254, s[60:63], s51 offen offset:0 sc1
    s_waitcnt lgkmcnt(1)
    buffer_store_dwordx4 v[28:31], v254, s[60:63], s51 offen offset:1024 sc1
    s_waitcnt lgkmcnt(0)
    buffer_store_dwordx4 v[32:35], v255, s[60:63], s51 offen offset:2048 sc1
wwo_94:
    ds_read_b32 v19, v17 offset:68
    s_waitcnt lgkmcnt(0)
    v_readfirstlane_b32 s70, v19
    s_nop 0
    s_cmp_eq_u32 s70, 0x10100
    s_cbranch_scc1 wogo_95
    s_sleep 1
    s_branch wwo_94
wogo_95:
    ds_read_b64_tr_b16 v[104:105], v8 offset:0
    ds_read_b64_tr_b16 v[106:107], v8 offset:1280
    ds_read_b64_tr_b16 v[108:109], v8 offset:8
    ds_read_b64_tr_b16 v[110:111], v8 offset:1288
    ds_read_b64_tr_b16 v[112:113], v8 offset:16
    ds_read_b64_tr_b16 v[114:115], v8 offset:1296
    ds_read_b64_tr_b16 v[116:117], v8 offset:24
    ds_read_b64_tr_b16 v[118:119], v8 offset:1304
    ds_read_b64_tr_b16 v[120:121], v8 offset:32
    ds_read_b64_tr_b16 v[122:123], v8 offset:1312
    ds_read_b64_tr_b16 v[124:125], v8 offset:5120
    ds_read_b64_tr_b16 v[126:127], v8 offset:6400
    ds_read_b64_tr_b16 v[128:129], v8 offset:5128
    ds_read_b64_tr_b16 v[130:131], v8 offset:6408
    ds_read_b64_tr_b16 v[132:133], v8 offset:5136
    ds_read_b64_tr_b16 v[134:135], v8 offset:6416
    ds_read_b64_tr_b16 v[136:137], v8 offset:5144
    ds_read_b64_tr_b16 v[138:139], v8 offset:6424
    ds_read_b64_tr_b16 v[140:141], v8 offset:5152
    ds_read_b64_tr_b16 v[142:143], v8 offset:6432
    v_mov_b32 v20, 0
    s_waitcnt vmcnt(0)
    s_mov_b64 exec, 1
    buffer_store_dword v248, v20, s[44:47], s50 offen sc1
    s_mov_b64 exec, -1
    s_waitcnt vmcnt(0)
    s_mov_b32 s71, 50000
pl_96:
    buffer_load_dword v240, v253, s[44:47], s49 offen sc1
    s_waitcnt vmcnt(0)
    v_xor_b32 v21, s33, v240
    v_cmp_ne_u32 vcc, 0, v21
    s_nop 0
    s_and_b64 vcc, vcc, exec
    s_cbranch_scc0 pk_97
    s_mov_b64 exec, vcc
    s_sub_u32 s71, s71, 1
    s_cmp_lg_u32 s71, 0
    s_cbranch_scc1 pl_96
pk_97:
    s_mov_b64 exec, -1
    buffer_load_dwordx4 v[24:27], v254, s[60:63], s39 offen offset:0 sc1
    buffer_load_dwordx4 v[28:31], v254, s[60:63], s39 offen offset:1024 sc1
    buffer_load_dwordx4 v[32:35], v254, s[60:63], s39 offen offset:2048 sc1
    buffer_load_dwordx4 v[36:39], v254, s[60:63], s39 offen offset:3072 sc1
    s_add_u32 s39, s39, 4096
    buffer_load_dwordx4 v[40:43], v254, s[60:63], s39 offen offset:0 sc1
    buffer_load_dwordx4 v[44:47], v254, s[60:63], s39 offen offset:1024 sc1
    buffer_load_dwordx4 v[48:51], v254, s[60:63], s39 offen offset:2048 sc1
    buffer_load_dwordx4 v[52:55], v254, s[60:63], s39 offen offset:3072 sc1
    s_add_u32 s39, s39, 4096
    buffer_load_dwordx4 v[56:59], v254, s[60:63], s39 offen offset:0 sc1
    buffer_load_dwordx4 v[60:63], v254, s[60:63], s39 offen offset:1024 sc1
    buffer_load_dwordx4 v[64:67], v254, s[60:63], s39 offen offset:2048 sc1
    buffer_load_dwordx4 v[68:71], v254, s[60:63], s39 offen offset:3072 sc1
    s_add_u32 s39, s39, 4096
    buffer_load_dwordx4 v[72:75], v254, s[60:63], s39 offen offset:0 sc1
    buffer_load_dwordx4 v[76:79], v254, s[60:63], s39 offen offset:1024 sc1
    buffer_load_dwordx4 v[80:83], v254, s[60:63], s39 offen offset:2048 sc1
    buffer_load_dwordx4 v[84:87], v254, s[60:63], s39 offen offset:3072 sc1
    s_add_u32 s39, s39, 4096
    buffer_load_dwordx4 v[88:91], v254, s[60:63], s39 offen offset:0 sc1
    buffer_load_dwordx4 v[92:95], v254, s[60:63], s39 offen offset:1024 sc1
    buffer_load_dwordx4 v[96:99], v254, s[60:63], s39 offen offset:2048 sc1
    buffer_load_dwordx4 v[100:103], v254, s[60:63], s39 offen offset:3072 sc1
    s_waitcnt vmcnt(19) lgkmcnt(10)
    ds_write_b8 v16, v18 offset:216
    ds_read_b64_tr_b16 v[144:145], v8 offset:10240
    ds_read_b64_tr_b16 v[146:147], v8 offset:11520
    v_mfma_f32_16x16x32_bf16 v[184:187], v[104:107], v[24:27], 0
    ds_read_b64_tr_b16 v[148:149], v8 offset:10248
    ds_read_b64_tr_b16 v[150:151], v8 offset:11528
    v_mfma_f32_16x16x32_bf16 v[188:191], v[108:111], v[24:27], 0
    ds_read_b64_tr_b16 v[152:153], v8 offset:10256
    ds_read_b64_tr_b16 v[154:155], v8 offset:11536
    v_mfma_f32_16x16x32_bf16 v[192:195], v[112:115], v[24:27], 0
    ds_read_b64_tr_b16 v[156:157], v8 offset:10264
    ds_read_b64_tr_b16 v[158:159], v8 offset:11544
    v_mfma_f32_16x16x32_bf16 v[196:199], v[116:119], v[24:27], 0
    ds_read_b64_tr_b16 v[160:161], v8 offset:10272
    ds_read_b64_tr_b16 v[162:163], v8 offset:11552
    v_mfma_f32_16x16x32_bf16 v[200:203], v[120:123], v[24:27], 0
    s_waitcnt vmcnt(18) lgkmcnt(10)
    ds_read_b64_tr_b16 v[104:105], v8 offset:15360
    ds_read_b64_tr_b16 v[106:107], v8 offset:16640
    v_mfma_f32_16x16x32_bf16 v[184:187], v[124:127], v[28:31], v[184:187]
    ds_read_b64_tr_b16 v[108:109], v8 offset:15368
    ds_read_b64_tr_b16 v[110:111], v8 offset:16648
    v_mfma_f32_16x16x32_bf16 v[188:191], v[128:131], v[28:31], v[188:191]
    ds_read_b64_tr_b16 v[112:113], v8 offset:15376
    ds_read_b64_tr_b16 v[114:115], v8 offset:16656
    v_mfma_f32_16x16x32_bf16 v[192:195], v[132:135], v[28:31], v[192:195]
    ds_read_b64_tr_b16 v[116:117], v8 offset:15384
    ds_read_b64_tr_b16 v[118:119], v8 offset:16664
    v_mfma_f32_16x16x32_bf16 v[196:199], v[136:139], v[28:31], v[196:199]
    ds_read_b64_tr_b16 v[120:121], v8 offset:15392
    ds_read_b64_tr_b16 v[122:123], v8 offset:16672
    v_mfma_f32_16x16x32_bf16 v[200:203], v[140:143], v[28:31], v[200:203]
    s_waitcnt vmcnt(17) lgkmcnt(10)
    ds_read_b64_tr_b16 v[124:125], v8 offset:20480
    ds_read_b64_tr_b16 v[126:127], v8 offset:21760
    v_mfma_f32_16x16x32_bf16 v[184:187], v[144:147], v[32:35], v[184:187]
    ds_read_b64_tr_b16 v[128:129], v8 offset:20488
    ds_read_b64_tr_b16 v[130:131], v8 offset:21768
    v_mfma_f32_16x16x32_bf16 v[188:191], v[148:151], v[32:35], v[188:191]
    ds_read_b64_tr_b16 v[132:133], v8 offset:20496
    ds_read_b64_tr_b16 v[134:135], v8 offset:21776
    v_mfma_f32_16x16x32_bf16 v[192:195], v[152:155], v[32:35], v[192:195]
    ds_read_b64_tr_b16 v[136:137], v8 offset:20504
    ds_read_b64_tr_b16 v[138:139], v8 offset:21784
    v_mfma_f32_16x16x32_bf16 v[196:199], v[156:159], v[32:35], v[196:199]
    ds_read_b64_tr_b16 v[140:141], v8 offset:20512
    ds_read_b64_tr_b16 v[142:143], v8 offset:21792
    v_mfma_f32_16x16x32_bf16 v[200:203], v[160:163], v[32:35], v[200:203]
    s_waitcnt vmcnt(16) lgkmcnt(10)
    ds_read_b64_tr_b16 v[144:145], v8 offset:25600
    ds_read_b64_tr_b16 v[146:147], v8 offset:26880
    v_mfma_f32_16x16x32_bf16 v[184:187], v[104:107], v[36:39], v[184:187]
    ds_read_b64_tr_b16 v[148:149], v8 offset:25608
    ds_read_b64_tr_b16 v[150:151], v8 offset:26888
    v_mfma_f32_16x16x32_bf16 v[188:191], v[108:111], v[36:39], v[188:191]
    ds_read_b64_tr_b16 v[152:153], v8 offset:25616
    ds_read_b64_tr_b16 v[154:155], v8 offset:26896
    v_mfma_f32_16x16x32_bf16 v[192:195], v[112:115], v[36:39], v[192:195]
    ds_read_b64_tr_b16 v[156:157], v8 offset:25624
    ds_read_b64_tr_b16 v[158:159], v8 offset:26904
    v_mfma_f32_16x16x32_bf16 v[196:199], v[116:119], v[36:39], v[196:199]
    ds_read_b64_tr_b16 v[160:161], v8 offset:25632
    ds_read_b64_tr_b16 v[162:163], v8 offset:26912
    v_mfma_f32_16x16x32_bf16 v[200:203], v[120:123], v[36:39], v[200:203]
    s_waitcnt vmcnt(15) lgkmcnt(10)
    ds_read_b64_tr_b16 v[104:105], v8 offset:30720
    ds_read_b64_tr_b16 v[106:107], v8 offset:32000
    v_mfma_f32_16x16x32_bf16 v[184:187], v[124:127], v[40:43], v[184:187]
    ds_read_b64_tr_b16 v[108:109], v8 offset:30728
    ds_read_b64_tr_b16 v[110:111], v8 offset:32008
    v_mfma_f32_16x16x32_bf16 v[188:191], v[128:131], v[40:43], v[188:191]
    ds_read_b64_tr_b16 v[112:113], v8 offset:30736
    ds_read_b64_tr_b16 v[114:115], v8 offset:32016
    v_mfma_f32_16x16x32_bf16 v[192:195], v[132:135], v[40:43], v[192:195]
    ds_read_b64_tr_b16 v[116:117], v8 offset:30744
    ds_read_b64_tr_b16 v[118:119], v8 offset:32024
    v_mfma_f32_16x16x32_bf16 v[196:199], v[136:139], v[40:43], v[196:199]
    ds_read_b64_tr_b16 v[120:121], v8 offset:30752
    ds_read_b64_tr_b16 v[122:123], v8 offset:32032
    v_mfma_f32_16x16x32_bf16 v[200:203], v[140:143], v[40:43], v[200:203]
    s_waitcnt vmcnt(14) lgkmcnt(10)
    ds_read_b64_tr_b16 v[124:125], v8 offset:35840
    ds_read_b64_tr_b16 v[126:127], v8 offset:37120
    v_mfma_f32_16x16x32_bf16 v[184:187], v[144:147], v[44:47], v[184:187]
    ds_read_b64_tr_b16 v[128:129], v8 offset:35848
    ds_read_b64_tr_b16 v[130:131], v8 offset:37128
    v_mfma_f32_16x16x32_bf16 v[188:191], v[148:151], v[44:47], v[188:191]
    ds_read_b64_tr_b16 v[132:133], v8 offset:35856
    ds_read_b64_tr_b16 v[134:135], v8 offset:37136
    v_mfma_f32_16x16x32_bf16 v[192:195], v[152:155], v[44:47], v[192:195]
    ds_read_b64_tr_b16 v[136:137], v8 offset:35864
    ds_read_b64_tr_b16 v[138:139], v8 offset:37144
    v_mfma_f32_16x16x32_bf16 v[196:199], v[156:159], v[44:47], v[196:199]
    ds_read_b64_tr_b16 v[140:141], v8 offset:35872
    ds_read_b64_tr_b16 v[142:143], v8 offset:37152
    v_mfma_f32_16x16x32_bf16 v[200:203], v[160:163], v[44:47], v[200:203]
    s_waitcnt vmcnt(13) lgkmcnt(10)
    ds_read_b64_tr_b16 v[144:145], v9 offset:0
    ds_read_b64_tr_b16 v[146:147], v9 offset:1280
    v_mfma_f32_16x16x32_bf16 v[184:187], v[104:107], v[48:51], v[184:187]
    ds_read_b64_tr_b16 v[148:149], v9 offset:8
    ds_read_b64_tr_b16 v[150:151], v9 offset:1288
    v_mfma_f32_16x16x32_bf16 v[188:191], v[108:111], v[48:51], v[188:191]
    ds_read_b64_tr_b16 v[152:153], v9 offset:16
    ds_read_b64_tr_b16 v[154:155], v9 offset:1296
    v_mfma_f32_16x16x32_bf16 v[192:195], v[112:115], v[48:51], v[192:195]
    ds_read_b64_tr_b16 v[156:157], v9 offset:24
    ds_read_b64_tr_b16 v[158:159], v9 offset:1304
    v_mfma_f32_16x16x32_bf16 v[196:199], v[116:119], v[48:51], v[196:199]
    ds_read_b64_tr_b16 v[160:161], v9 offset:32
    ds_read_b64_tr_b16 v[162:163], v9 offset:1312
    v_mfma_f32_16x16x32_bf16 v[200:203], v[120:123], v[48:51], v[200:203]
    s_waitcnt vmcnt(12) lgkmcnt(10)
    ds_read_b64_tr_b16 v[104:105], v9 offset:5120
    ds_read_b64_tr_b16 v[106:107], v9 offset:6400
    v_mfma_f32_16x16x32_bf16 v[184:187], v[124:127], v[52:55], v[184:187]
    ds_read_b64_tr_b16 v[108:109], v9 offset:5128
    ds_read_b64_tr_b16 v[110:111], v9 offset:6408
    v_mfma_f32_16x16x32_bf16 v[188:191], v[128:131], v[52:55], v[188:191]
    ds_read_b64_tr_b16 v[112:113], v9 offset:5136
    ds_read_b64_tr_b16 v[114:115], v9 offset:6416
    v_mfma_f32_16x16x32_bf16 v[192:195], v[132:135], v[52:55], v[192:195]
    ds_read_b64_tr_b16 v[116:117], v9 offset:5144
    ds_read_b64_tr_b16 v[118:119], v9 offset:6424
    v_mfma_f32_16x16x32_bf16 v[196:199], v[136:139], v[52:55], v[196:199]
    ds_read_b64_tr_b16 v[120:121], v9 offset:5152
    ds_read_b64_tr_b16 v[122:123], v9 offset:6432
    v_mfma_f32_16x16x32_bf16 v[200:203], v[140:143], v[52:55], v[200:203]
    s_waitcnt vmcnt(11) lgkmcnt(10)
    ds_read_b64_tr_b16 v[124:125], v9 offset:10240
    ds_read_b64_tr_b16 v[126:127], v9 offset:11520
    v_mfma_f32_16x16x32_bf16 v[184:187], v[144:147], v[56:59], v[184:187]
    ds_read_b64_tr_b16 v[128:129], v9 offset:10248
    ds_read_b64_tr_b16 v[130:131], v9 offset:11528
    v_mfma_f32_16x16x32_bf16 v[188:191], v[148:151], v[56:59], v[188:191]
    ds_read_b64_tr_b16 v[132:133], v9 offset:10256
    ds_read_b64_tr_b16 v[134:135], v9 offset:11536
    v_mfma_f32_16x16x32_bf16 v[192:195], v[152:155], v[56:59], v[192:195]
    ds_read_b64_tr_b16 v[136:137], v9 offset:10264
    ds_read_b64_tr_b16 v[138:139], v9 offset:11544
    v_mfma_f32_16x16x32_bf16 v[196:199], v[156:159], v[56:59], v[196:199]
    ds_read_b64_tr_b16 v[140:141], v9 offset:10272
    ds_read_b64_tr_b16 v[142:143], v9 offset:11552
    v_mfma_f32_16x16x32_bf16 v[200:203], v[160:163], v[56:59], v[200:203]
    s_waitcnt vmcnt(10) lgkmcnt(10)
    ds_read_b64_tr_b16 v[144:145], v9 offset:15360
    ds_read_b64_tr_b16 v[146:147], v9 offset:16640
    v_mfma_f32_16x16x32_bf16 v[184:187], v[104:107], v[60:63], v[184:187]
    ds_read_b64_tr_b16 v[148:149], v9 offset:15368
    ds_read_b64_tr_b16 v[150:151], v9 offset:16648
    v_mfma_f32_16x16x32_bf16 v[188:191], v[108:111], v[60:63], v[188:191]
    ds_read_b64_tr_b16 v[152:153], v9 offset:15376
    ds_read_b64_tr_b16 v[154:155], v9 offset:16656
    v_mfma_f32_16x16x32_bf16 v[192:195], v[112:115], v[60:63], v[192:195]
    ds_read_b64_tr_b16 v[156:157], v9 offset:15384
    ds_read_b64_tr_b16 v[158:159], v9 offset:16664
    v_mfma_f32_16x16x32_bf16 v[196:199], v[116:119], v[60:63], v[196:199]
    ds_read_b64_tr_b16 v[160:161], v9 offset:15392
    ds_read_b64_tr_b16 v[162:163], v9 offset:16672
    v_mfma_f32_16x16x32_bf16 v[200:203], v[120:123], v[60:63], v[200:203]
    s_waitcnt vmcnt(9) lgkmcnt(10)
    ds_read_b64_tr_b16 v[104:105], v9 offset:40960
    ds_read_b64_tr_b16 v[106:107], v9 offset:42240
    v_mfma_f32_16x16x32_bf16 v[184:187], v[124:127], v[64:67], v[184:187]
    ds_read_b64_tr_b16 v[108:109], v9 offset:40968
    ds_read_b64_tr_b16 v[110:111], v9 offset:42248
    v_mfma_f32_16x16x32_bf16 v[188:191], v[128:131], v[64:67], v[188:191]
    ds_read_b64_tr_b16 v[112:113], v9 offset:40976
    ds_read_b64_tr_b16 v[114:115], v9 offset:42256
    v_mfma_f32_16x16x32_bf16 v[192:195], v[132:135], v[64:67], v[192:195]
    ds_read_b64_tr_b16 v[116:117], v9 offset:40984
    ds_read_b64_tr_b16 v[118:119], v9 offset:42264
    v_mfma_f32_16x16x32_bf16 v[196:199], v[136:139], v[64:67], v[196:199]
    ds_read_b64_tr_b16 v[120:121], v9 offset:40992
    ds_read_b64_tr_b16 v[122:123], v9 offset:42272
    v_mfma_f32_16x16x32_bf16 v[200:203], v[140:143], v[64:67], v[200:203]
    s_waitcnt vmcnt(8) lgkmcnt(10)
    ds_read_b64_tr_b16 v[124:125], v9 offset:46080
    ds_read_b64_tr_b16 v[126:127], v9 offset:47360
    v_mfma_f32_16x16x32_bf16 v[184:187], v[144:147], v[68:71], v[184:187]
    ds_read_b64_tr_b16 v[128:129], v9 offset:46088
    ds_read_b64_tr_b16 v[130:131], v9 offset:47368
    v_mfma_f32_16x16x32_bf16 v[188:191], v[148:151], v[68:71], v[188:191]
    ds_read_b64_tr_b16 v[132:133], v9 offset:46096
    ds_read_b64_tr_b16 v[134:135], v9 offset:47376
    v_mfma_f32_16x16x32_bf16 v[192:195], v[152:155], v[68:71], v[192:195]
    ds_read_b64_tr_b16 v[136:137], v9 offset:46104
    ds_read_b64_tr_b16 v[138:139], v9 offset:47384
    v_mfma_f32_16x16x32_bf16 v[196:199], v[156:159], v[68:71], v[196:199]
    ds_read_b64_tr_b16 v[140:141], v9 offset:46112
    ds_read_b64_tr_b16 v[142:143], v9 offset:47392
    v_mfma_f32_16x16x32_bf16 v[200:203], v[160:163], v[68:71], v[200:203]
    s_waitcnt vmcnt(7) lgkmcnt(10)
    ds_read_b64_tr_b16 v[144:145], v9 offset:51200
    ds_read_b64_tr_b16 v[146:147], v9 offset:52480
    v_mfma_f32_16x16x32_bf16 v[184:187], v[104:107], v[72:75], v[184:187]
    ds_read_b64_tr_b16 v[148:149], v9 offset:51208
    ds_read_b64_tr_b16 v[150:151], v9 offset:52488
    v_mfma_f32_16x16x32_bf16 v[188:191], v[108:111], v[72:75], v[188:191]
    ds_read_b64_tr_b16 v[152:153], v9 offset:51216
    ds_read_b64_tr_b16 v[154:155], v9 offset:52496
    v_mfma_f32_16x16x32_bf16 v[192:195], v[112:115], v[72:75], v[192:195]
    ds_read_b64_tr_b16 v[156:157], v9 offset:51224
    ds_read_b64_tr_b16 v[158:159], v9 offset:52504
    v_mfma_f32_16x16x32_bf16 v[196:199], v[116:119], v[72:75], v[196:199]
    ds_read_b64_tr_b16 v[160:161], v9 offset:51232
    ds_read_b64_tr_b16 v[162:163], v9 offset:52512
    v_mfma_f32_16x16x32_bf16 v[200:203], v[120:123], v[72:75], v[200:203]
    s_waitcnt vmcnt(6) lgkmcnt(10)
    ds_read_b64_tr_b16 v[104:105], v9 offset:56320
    ds_read_b64_tr_b16 v[106:107], v9 offset:57600
    v_mfma_f32_16x16x32_bf16 v[184:187], v[124:127], v[76:79], v[184:187]
    ds_read_b64_tr_b16 v[108:109], v9 offset:56328
    ds_read_b64_tr_b16 v[110:111], v9 offset:57608
    v_mfma_f32_16x16x32_bf16 v[188:191], v[128:131], v[76:79], v[188:191]
    ds_read_b64_tr_b16 v[112:113], v9 offset:56336
    ds_read_b64_tr_b16 v[114:115], v9 offset:57616
    v_mfma_f32_16x16x32_bf16 v[192:195], v[132:135], v[76:79], v[192:195]
    ds_read_b64_tr_b16 v[116:117], v9 offset:56344
    ds_read_b64_tr_b16 v[118:119], v9 offset:57624
    v_mfma_f32_16x16x32_bf16 v[196:199], v[136:139], v[76:79], v[196:199]
    ds_read_b64_tr_b16 v[120:121], v9 offset:56352
    ds_read_b64_tr_b16 v[122:123], v9 offset:57632
    v_mfma_f32_16x16x32_bf16 v[200:203], v[140:143], v[76:79], v[200:203]
    s_waitcnt vmcnt(5) lgkmcnt(10)
    ds_read_b64_tr_b16 v[124:125], v10 offset:0
    ds_read_b64_tr_b16 v[126:127], v10 offset:1280
    v_mfma_f32_16x16x32_bf16 v[184:187], v[144:147], v[80:83], v[184:187]
    ds_read_b64_tr_b16 v[128:129], v10 offset:8
    ds_read_b64_tr_b16 v[130:131], v10 offset:1288
    v_mfma_f32_16x16x32_bf16 v[188:191], v[148:151], v[80:83], v[188:191]
    ds_read_b64_tr_b16 v[132:133], v10 offset:16
    ds_read_b64_tr_b16 v[134:135], v10 offset:1296
    v_mfma_f32_16x16x32_bf16 v[192:195], v[152:155], v[80:83], v[192:195]
    ds_read_b64_tr_b16 v[136:137], v10 offset:24
    ds_read_b64_tr_b16 v[138:139], v10 offset:1304
    v_mfma_f32_16x16x32_bf16 v[196:199], v[156:159], v[80:83], v[196:199]
    ds_read_b64_tr_b16 v[140:141], v10 offset:32
    ds_read_b64_tr_b16 v[142:143], v10 offset:1312
    v_mfma_f32_16x16x32_bf16 v[200:203], v[160:163], v[80:83], v[200:203]
    s_waitcnt vmcnt(4) lgkmcnt(10)
    ds_read_b64_tr_b16 v[144:145], v10 offset:5120
    ds_read_b64_tr_b16 v[146:147], v10 offset:6400
    v_mfma_f32_16x16x32_bf16 v[184:187], v[104:107], v[84:87], v[184:187]
    ds_read_b64_tr_b16 v[148:149], v10 offset:5128
    ds_read_b64_tr_b16 v[150:151], v10 offset:6408
    v_mfma_f32_16x16x32_bf16 v[188:191], v[108:111], v[84:87], v[188:191]
    ds_read_b64_tr_b16 v[152:153], v10 offset:5136
    ds_read_b64_tr_b16 v[154:155], v10 offset:6416
    v_mfma_f32_16x16x32_bf16 v[192:195], v[112:115], v[84:87], v[192:195]
    ds_read_b64_tr_b16 v[156:157], v10 offset:5144
    ds_read_b64_tr_b16 v[158:159], v10 offset:6424
    v_mfma_f32_16x16x32_bf16 v[196:199], v[116:119], v[84:87], v[196:199]
    ds_read_b64_tr_b16 v[160:161], v10 offset:5152
    ds_read_b64_tr_b16 v[162:163], v10 offset:6432
    v_mfma_f32_16x16x32_bf16 v[200:203], v[120:123], v[84:87], v[200:203]
    s_waitcnt vmcnt(3) lgkmcnt(10)
    ds_read_b64_tr_b16 v[104:105], v10 offset:10240
    ds_read_b64_tr_b16 v[106:107], v10 offset:11520
    v_mfma_f32_16x16x32_bf16 v[184:187], v[124:127], v[88:91], v[184:187]
    ds_read_b64_tr_b16 v[108:109], v10 offset:10248
    ds_read_b64_tr_b16 v[110:111], v10 offset:11528
    v_mfma_f32_16x16x32_bf16 v[188:191], v[128:131], v[88:91], v[188:191]
    ds_read_b64_tr_b16 v[112:113], v10 offset:10256
    ds_read_b64_tr_b16 v[114:115], v10 offset:11536
    v_mfma_f32_16x16x32_bf16 v[192:195], v[132:135], v[88:91], v[192:195]
    ds_read_b64_tr_b16 v[116:117], v10 offset:10264
    ds_read_b64_tr_b16 v[118:119], v10 offset:11544
    v_mfma_f32_16x16x32_bf16 v[196:199], v[136:139], v[88:91], v[196:199]
    ds_read_b64_tr_b16 v[120:121], v10 offset:10272
    ds_read_b64_tr_b16 v[122:123], v10 offset:11552
    v_mfma_f32_16x16x32_bf16 v[200:203], v[140:143], v[88:91], v[200:203]
    s_waitcnt vmcnt(2) lgkmcnt(10)
    ds_read_b64_tr_b16 v[124:125], v10 offset:15360
    ds_read_b64_tr_b16 v[126:127], v10 offset:16640
    v_mfma_f32_16x16x32_bf16 v[184:187], v[144:147], v[92:95], v[184:187]
    ds_read_b64_tr_b16 v[128:129], v10 offset:15368
    ds_read_b64_tr_b16 v[130:131], v10 offset:16648
    v_mfma_f32_16x16x32_bf16 v[188:191], v[148:151], v[92:95], v[188:191]
    ds_read_b64_tr_b16 v[132:133], v10 offset:15376
    ds_read_b64_tr_b16 v[134:135], v10 offset:16656
    v_mfma_f32_16x16x32_bf16 v[192:195], v[152:155], v[92:95], v[192:195]
    ds_read_b64_tr_b16 v[136:137], v10 offset:15384
    ds_read_b64_tr_b16 v[138:139], v10 offset:16664
    v_mfma_f32_16x16x32_bf16 v[196:199], v[156:159], v[92:95], v[196:199]
    ds_read_b64_tr_b16 v[140:141], v10 offset:15392
    ds_read_b64_tr_b16 v[142:143], v10 offset:16672
    v_mfma_f32_16x16x32_bf16 v[200:203], v[160:163], v[92:95], v[200:203]
    s_waitcnt vmcnt(1) lgkmcnt(10)
    v_mfma_f32_16x16x32_bf16 v[184:187], v[104:107], v[96:99], v[184:187]
    v_mfma_f32_16x16x32_bf16 v[188:191], v[108:111], v[96:99], v[188:191]
    v_mfma_f32_16x16x32_bf16 v[192:195], v[112:115], v[96:99], v[192:195]
    v_mfma_f32_16x16x32_bf16 v[196:199], v[116:119], v[96:99], v[196:199]
    v_mfma_f32_16x16x32_bf16 v[200:203], v[120:123], v[96:99], v[200:203]
    s_waitcnt vmcnt(0) lgkmcnt(0)
    v_mfma_f32_16x16x32_bf16 v[184:187], v[124:127], v[100:103], v[184:187]
    v_mfma_f32_16x16x32_bf16 v[188:191], v[128:131], v[100:103], v[188:191]
    v_mfma_f32_16x16x32_bf16 v[192:195], v[132:135], v[100:103], v[192:195]
    v_mfma_f32_16x16x32_bf16 v[196:199], v[136:139], v[100:103], v[196:199]
    v_mfma_f32_16x16x32_bf16 v[200:203], v[140:143], v[100:103], v[200:203]
    v_lshlrev_b32 v228, 16, v168
    v_and_b32 v229, 0xffff0000, v168
    s_nop 1
    v_pk_add_f32 v[228:229], v[228:229], v[184:185]
    v_cvt_pk_bf16_f32 v208, v228, v229
    v_lshlrev_b32 v230, 16, v169
    v_and_b32 v231, 0xffff0000, v169
    v_pk_add_f32 v[230:231], v[230:231], v[186:187]
    v_cvt_pk_bf16_f32 v209, v230, v231
    v_lshlrev_b32 v232, 16, v170
    v_and_b32 v233, 0xffff0000, v170
    v_pk_add_f32 v[232:233], v[232:233], v[188:189]
    v_cvt_pk_bf16_f32 v210, v232, v233
    v_lshlrev_b32 v234, 16, v171
    v_and_b32 v235, 0xffff0000, v171
    v_pk_add_f32 v[234:235], v[234:235], v[190:191]
    v_cvt_pk_bf16_f32 v211, v234, v235
    v_lshlrev_b32 v228, 16, v172
    v_and_b32 v229, 0xffff0000, v172
    v_pk_add_f32 v[228:229], v[228:229], v[192:193]
    v_cvt_pk_bf16_f32 v212, v228, v229
    v_lshlrev_b32 v230, 16, v173
    v_and_b32 v231, 0xffff0000, v173
    v_pk_add_f32 v[230:231], v[230:231], v[194:195]
    v_cvt_pk_bf16_f32 v213, v230, v231
    v_lshlrev_b32 v232, 16, v174
    v_and_b32 v233, 0xffff0000, v174
    v_pk_add_f32 v[232:233], v[232:233], v[196:197]
    v_cvt_pk_bf16_f32 v214, v232, v233
    v_lshlrev_b32 v234, 16, v175
    v_and_b32 v235, 0xffff0000, v175
    v_pk_add_f32 v[234:235], v[234:235], v[198:199]
    v_cvt_pk_bf16_f32 v215, v234, v235
    v_lshlrev_b32 v228, 16, v176
    v_and_b32 v229, 0xffff0000, v176
    v_pk_add_f32 v[228:229], v[228:229], v[200:201]
    v_cvt_pk_bf16_f32 v216, v228, v229
    v_lshlrev_b32 v230, 16, v177
    v_and_b32 v231, 0xffff0000, v177
    v_pk_add_f32 v[230:231], v[230:231], v[202:203]
    v_cvt_pk_bf16_f32 v217, v230, v231
    ds_write_b64 v6, v[208:209] offset:0
    ds_write_b64 v6, v[210:211] offset:8
    ds_write_b64 v6, v[212:213] offset:16
    ds_write_b64 v6, v[214:215] offset:24
    ds_write_b64 v6, v[216:217] offset:32
    v_add_u32 v7, 106752, v7
    ds_read_b128 v[24:27], v7 offset:0
    ds_read_b128 v[28:31], v7 offset:64
    ds_read_b128 v[32:35], v7 offset:128
    v_mov_b32 v12, 0
    v_mov_b32 v13, 0
    v_mov_b32 v21, 0x3f803f80
    v_dot2c_f32_bf16 v12, v208, v21
    v_dot2c_f32_bf16 v13, v208, v208
    v_dot2c_f32_bf16 v12, v209, v21
    v_dot2c_f32_bf16 v13, v209, v209
    v_dot2c_f32_bf16 v12, v210, v21
    v_dot2c_f32_bf16 v13, v210, v210
    v_dot2c_f32_bf16 v12, v211, v21
    v_dot2c_f32_bf16 v13, v211, v211
    v_dot2c_f32_bf16 v12, v212, v21
    v_dot2c_f32_bf16 v13, v212, v212
    v_dot2c_f32_bf16 v12, v213, v21
    v_dot2c_f32_bf16 v13, v213, v213
    v_dot2c_f32_bf16 v12, v214, v21
    v_dot2c_f32_bf16 v13, v214, v214
    v_dot2c_f32_bf16 v12, v215, v21
    v_dot2c_f32_bf16 v13, v215, v215
    v_dot2c_f32_bf16 v12, v216, v21
    v_dot2c_f32_bf16 v13, v216, v216
    v_dot2c_f32_bf16 v12, v217, v21
    v_dot2c_f32_bf16 v13, v217, v217
    s_waitcnt lgkmcnt(2)
    buffer_store_dwordx4 v[24:27], v254, s[64:67], s48 offen offset:0 sc1
    s_waitcnt lgkmcnt(1)
    buffer_store_dwordx4 v[28:31], v254, s[64:67], s48 offen offset:1024 sc1
    s_waitcnt lgkmcnt(0)
    buffer_store_dwordx4 v[32:35], v255, s[64:67], s48 offen offset:2048 sc1
    v_permlane32_swap_b32 v12, v13
    v_add_f32 v12, v12, v13
    v_mov_b32 v13, v12
    s_nop 1
    v_permlane16_swap_b32 v12, v13
    v_add_f32 v12, v12, v13
    s_lshl_b32 s37, s31, 14
    s_lshl_b32 s38, s38, 7
    s_add_u32 s37, s37, s38
    v_lshrrev_b32 v13, 1, v3
    v_lshlrev_b32 v13, 2, v13
    v_lshl_add_u32 v13, v2, 3, v13
    buffer_store_dword v12, v13, s[72:75], s37 offen sc1
    s_lshl_b32 s37, s30, 3
    s_add_u32 s37, s37, s31
    s_lshl_b32 s37, s37, 7
    s_add_u32 s37, s37, 196608
    v_mov_b32 v22, 147568
    v_mov_b32 v23, 1
    s_mov_b64 exec, 1
    s_waitcnt vmcnt(0)
    ds_add_rtn_u32 v23, v22, v23
    s_mov_b64 exec, -1
    v_mov_b32 v244, s33
    v_mov_b32 v245, s33
    v_mov_b32 v246, s33
    v_mov_b32 v247, s33
    v_lshlrev_b32 v22, 7, v0
    s_waitcnt lgkmcnt(0)
    v_readfirstlane_b32 s70, v23
    s_nop 0
    s_cmp_lg_u32 s70, 3
    s_cbranch_scc1 notlast_98
    s_mov_b64 exec, 1
    buffer_store_dwordx4 v[244:247], v22, s[44:47], s37 offen sc1
    s_mov_b64 exec, -1
notlast_98:
    s_mov_b64 exec, 1
    s_xor_b32 s37, s35, 3
    s_xor_b32 s38, s2, 255
    s_or_b32 s37, s37, s38
    s_cbranch_scc1 nobump_99
    buffer_store_dword v248, v20, s[44:47], 0 offen sc1
nobump_99:
    s_mov_b64 exec, -1
    ds_write_b8 v16, v18 offset:208
    s_mul_i32 s23, s20, 30
    s_add_u32 s23, s23, s21
    s_sub_u32 s24, s21, 30
    s_lshl_b32 s24, s24, 3
    s_add_u32 s24, s24, s20
    s_add_u32 s25, s24, 240
    s_cmp_ge_u32 s21, 30
    s_cselect_b32 s23, s25, s23
    s_cmp_ge_u32 s23, 243
    s_cselect_b32 s75, 1, 0
    s_cmp_ge_u32 s23, 252
    s_cselect_b32 s75, 2, s75
    s_sub_u32 s24, s23, 126
    s_cmp_ge_u32 s23, 126
    s_cselect_b32 s24, s24, s23
    s_mul_i32 s22, s24, 147
    s_lshr_b32 s22, s22, 11
    s_mul_i32 s25, s24, 79
    s_lshr_b32 s25, s25, 10
    s_cmp_ge_u32 s23, 126
    s_cselect_b32 s22, s25, s22
    s_cselect_b32 s25, 13, 14
    s_cselect_b32 s31, 14, 0
    s_mul_i32 s25, s25, s22
    s_sub_u32 s24, s24, s25
    s_add_u32 s31, s31, s24
    s_sub_u32 s24, s23, 243
    s_mul_i32 s24, s24, 3
    s_cmp_eq_u32 s75, 1
    s_cselect_b32 s31, s24, s31
    s_cselect_b32 s22, 9, s22
    s_cmp_eq_u32 s75, 2
    s_cbranch_scc1 c4_100
    s_cmp_eq_u32 s75, 1
    s_cbranch_scc1 csmall_102
    s_mul_i32 s30, s22, 224
    s_lshl_b32 s34, s31, 7
    s_lshr_b32 s36, s35, 1
    s_and_b32 s37, s35, 1
    v_and_b32 v2, 15, v0
    v_lshrrev_b32 v3, 4, v0
    s_mul_i32 s38, s36, 14336
    v_lshlrev_b32 v16, 4, v0
    v_add_u32 v16, s38, v16
    v_add_u32 v17, 1024, v16
    v_bfe_u32 v8, v0, 2, 3
    v_bfe_u32 v9, v0, 3, 2
    v_lshrrev_b32 v10, 5, v0
    s_lshl_b32 s39, s37, 1
    v_xor_b32 v9, s39, v9
    v_and_b32 v11, 3, v0
    v_lshlrev_b32 v11, 3, v11
    v_lshl_add_u32 v11, v8, 7, v11
    v_lshl_add_u32 v11, v10, 10, v11
    v_add_u32 v11, 98304, v11
    v_lshl_add_u32 v18, v9, 5, v11
    v_xor_b32 v19, 32, v18
    v_add_u32 v20, 65536, v16
    v_add_u32 v21, 65536, v17
    v_and_b32 v8, 1, v3
    v_lshlrev_b32 v8, 5, v8
    v_lshrrev_b32 v9, 1, v3
    v_lshl_add_u32 v8, v9, 4, v8
    s_lshl_b32 s39, s37, 6
    s_add_u32 s39, s39, s34
    v_add_u32 v8, s39, v8
    s_mul_i32 s38, s36, 112
    v_add_u32 v9, s38, v2
    v_add_u32 v10, s30, v9
    v_mul_u32_u24 v10, 3456, v10
    v_add_u32 v10, v10, v8
    v_and_b32 v10, 1, v3
    v_lshlrev_b32 v10, 1, v10
    v_lshrrev_b32 v8, 1, v3
    v_add_u32 v10, v10, v8
    v_lshlrev_b32 v10, 8, v10
    v_lshl_add_u32 v10, v2, 4, v10
    s_lshl_b32 s39, s31, 1
    s_add_u32 s39, s39, s37
    s_lshl_b32 s39, s39, 10
    v_add_u32 v10, s39, v10
    s_add_u32 s39, s30, s38
    s_mul_i32 s39, s39, 3456
    v_add_u32 v10, s39, v10
    s_add_u32 s52, s4, 16777216
    s_addc_u32 s53, s5, 0
    s_mov_b32 s54, 7077888
    s_mov_b32 s55, 0x20000
    v_lshlrev_b32 v8, 4, v3
    s_lshl_b32 s39, s37, 7
    v_add_u32 v8, s39, v8
    v_add_u32 v8, 151808, v8
    v_lshlrev_b32 v11, 4, v9
    v_add_u32 v11, 147712, v11
    s_lshr_b32 s38, s30, 6
    s_add_u32 s39, s30, 223
    s_lshr_b32 s39, s39, 6
    v_lshrrev_b32 v12, 3, v0
    v_add_u32 v12, s38, v12
    v_min_u32 v12, s39, v12
    v_and_b32 v13, 7, v0
    v_lshl_add_u32 v12, v12, 3, v13
    v_lshlrev_b32 v12, 7, v12
    v_add_u32 v12, 196608, v12
    v_bfe_u32 v13, v0, 2, 1
    v_mul_u32_u24 v13, 108, v13
    v_and_b32 v14, 3, v0
    v_add_u32 v13, v13, v14
    s_lshl_b32 s39, s31, 2
    v_add_u32 v13, s39, v13
    v_lshlrev_b32 v13, 7, v13
    v_add_u32 v13, 229376, v13
    v_cmp_gt_u32 vcc, 40, v0
    s_nop 1
    v_cndmask_b32 v12, v13, v12, vcc
    s_cmp_lg_u32 s35, 0
    s_cbranch_scc1 pd_104
    s_waitcnt vmcnt(0)
    s_mov_b32 s71, 50000
pl_105:
    buffer_load_dwordx4 v[248:251], v12, s[44:47], 0 offen sc1
    s_waitcnt vmcnt(0)
    v_xor_b32 v13, s33, v248
    v_xor_b32 v14, s33, v249
    v_or_b32 v13, v13, v14
    v_xor_b32 v14, s33, v250
    v_or_b32 v13, v13, v14
    v_xor_b32 v14, s33, v251
    v_or_b32 v13, v13, v14
    v_cmp_ne_u32 vcc, 0, v13
    s_nop 0
    s_and_b64 vcc, vcc, exec
    s_cbranch_scc0 pk_106
    s_mov_b64 exec, vcc
    s_sub_u32 s71, s71, 1
    s_cmp_lg_u32 s71, 0
    s_cbranch_scc1 pl_105
pk_106:
    s_mov_b64 exec, -1
pd_104:
    s_barrier
    s_add_u32 s56, s4, 14680064
    s_addc_u32 s57, s5, 0
    s_mov_b32 s58, 131072
    s_mov_b32 s59, 0x20000
    s_add_u32 s60, s4, 15204352
    s_addc_u32 s61, s5, 0
    s_mov_b32 s62, 110592
    s_mov_b32 s63, 0x20000
    s_lshl_b32 s72, s35, 6
    s_add_u32 s72, s72, s30
    v_add_u32 v12, s72, v0
    v_lshlrev_b32 v12, 3, v12
    s_mov_b32 s73, 0
    buffer_load_dwordx2 v[224:225], v12, s[56:59], s73 offen sc1
    s_mov_b32 s73, 16384
    buffer_load_dwordx2 v[226:227], v12, s[56:59], s73 offen sc1
    s_mov_b32 s73, 32768
    buffer_load_dwordx2 v[228:229], v12, s[56:59], s73 offen sc1
    s_mov_b32 s73, 49152
    buffer_load_dwordx2 v[230:231], v12, s[56:59], s73 offen sc1
    s_mov_b32 s73, 65536
    buffer_load_dwordx2 v[232:233], v12, s[56:59], s73 offen sc1
    s_mov_b32 s73, 81920
    buffer_load_dwordx2 v[234:235], v12, s[56:59], s73 offen sc1
    s_mov_b32 s73, 98304
    buffer_load_dwordx2 v[236:237], v12, s[56:59], s73 offen sc1
    s_mov_b32 s73, 114688
    buffer_load_dwordx2 v[238:239], v12, s[56:59], s73 offen sc1
    v_and_b32 v13, 31, v0
    s_and_b32 s72, s35, 1
    s_lshl_b32 s72, s72, 5
    s_lshr_b32 s73, s35, 1
    s_mul_i32 s73, s73, 1728
    s_add_u32 s72, s72, s73
    s_lshl_b32 s73, s31, 6
    s_add_u32 s72, s72, s73
    v_add_u32 v13, s72, v13
    v_lshlrev_b32 v13, 2, v13
    v_lshrrev_b32 v14, 5, v0
    v_mul_u32_u24 v14, 55296, v14
    v_add_u32 v13, v13, v14
    s_mov_b32 s73, 0
    buffer_load_dword v240, v13, s[60:63], s73 offen offset:0 sc1
    s_mov_b32 s73, 13824
    buffer_load_dword v241, v13, s[60:63], s73 offen offset:0 sc1
    s_mov_b32 s73, 27648
    buffer_load_dword v242, v13, s[60:63], s73 offen offset:0 sc1
    s_mov_b32 s73, 41472
    buffer_load_dword v243, v13, s[60:63], s73 offen offset:0 sc1
    s_barrier
    ds_read_b64_tr_b16 v[52:53], v18 offset:0
    ds_read_b64_tr_b16 v[54:55], v18 offset:2048
    ds_read_b64_tr_b16 v[56:57], v19 offset:0
    ds_read_b64_tr_b16 v[58:59], v19 offset:2048
    ds_read_b64_tr_b16 v[60:61], v18 offset:8192
    ds_read_b64_tr_b16 v[62:63], v18 offset:10240
    ds_read_b64_tr_b16 v[64:65], v19 offset:8192
    ds_read_b64_tr_b16 v[66:67], v19 offset:10240
    ds_read_b128 v[24:27], v16 offset:0
    ds_read_b128 v[28:31], v16 offset:2048
    ds_read_b128 v[32:35], v16 offset:4096
    ds_read_b128 v[36:39], v16 offset:6144
    ds_read_b128 v[40:43], v16 offset:8192
    ds_read_b128 v[44:47], v16 offset:10240
    ds_read_b128 v[48:51], v16 offset:12288
    s_waitcnt lgkmcnt(0)
    ds_read_b64_tr_b16 v[96:97], v18 offset:4096
    v_mfma_f32_16x16x32_bf16 v[112:115], v[52:55], v[24:27], 0
    ds_read_b64_tr_b16 v[98:99], v18 offset:6144
    v_mfma_f32_16x16x32_bf16 v[116:119], v[56:59], v[24:27], 0
    ds_read_b64_tr_b16 v[100:101], v19 offset:4096
    v_mfma_f32_16x16x32_bf16 v[120:123], v[60:63], v[24:27], 0
    ds_read_b64_tr_b16 v[102:103], v19 offset:6144
    v_mfma_f32_16x16x32_bf16 v[124:127], v[64:67], v[24:27], 0
    ds_read_b64_tr_b16 v[104:105], v18 offset:12288
    v_mfma_f32_16x16x32_bf16 v[128:131], v[52:55], v[28:31], 0
    ds_read_b64_tr_b16 v[106:107], v18 offset:14336
    v_mfma_f32_16x16x32_bf16 v[132:135], v[56:59], v[28:31], 0
    ds_read_b64_tr_b16 v[108:109], v19 offset:12288
    v_mfma_f32_16x16x32_bf16 v[136:139], v[60:63], v[28:31], 0
    ds_read_b64_tr_b16 v[110:111], v19 offset:14336
    v_mfma_f32_16x16x32_bf16 v[140:143], v[64:67], v[28:31], 0
    ds_read_b128 v[68:71], v17 offset:0
    v_mfma_f32_16x16x32_bf16 v[144:147], v[52:55], v[32:35], 0
    ds_read_b128 v[72:75], v17 offset:2048
    v_mfma_f32_16x16x32_bf16 v[148:151], v[56:59], v[32:35], 0
    ds_read_b128 v[76:79], v17 offset:4096
    v_mfma_f32_16x16x32_bf16 v[152:155], v[60:63], v[32:35], 0
    ds_read_b128 v[80:83], v17 offset:6144
    v_mfma_f32_16x16x32_bf16 v[156:159], v[64:67], v[32:35], 0
    ds_read_b128 v[84:87], v17 offset:8192
    v_mfma_f32_16x16x32_bf16 v[160:163], v[52:55], v[36:39], 0
    ds_read_b128 v[88:91], v17 offset:10240
    v_mfma_f32_16x16x32_bf16 v[164:167], v[56:59], v[36:39], 0
    ds_read_b128 v[92:95], v17 offset:12288
    v_mfma_f32_16x16x32_bf16 v[168:171], v[60:63], v[36:39], 0
    v_mfma_f32_16x16x32_bf16 v[172:175], v[64:67], v[36:39], 0
    v_mfma_f32_16x16x32_bf16 v[176:179], v[52:55], v[40:43], 0
    v_mfma_f32_16x16x32_bf16 v[180:183], v[56:59], v[40:43], 0
    v_mfma_f32_16x16x32_bf16 v[184:187], v[60:63], v[40:43], 0
    v_mfma_f32_16x16x32_bf16 v[188:191], v[64:67], v[40:43], 0
    v_mfma_f32_16x16x32_bf16 v[192:195], v[52:55], v[44:47], 0
    s_waitcnt lgkmcnt(0)
    s_barrier
    v_mfma_f32_16x16x32_bf16 v[196:199], v[56:59], v[44:47], 0
    v_mfma_f32_16x16x32_bf16 v[200:203], v[60:63], v[44:47], 0
    v_mfma_f32_16x16x32_bf16 v[204:207], v[64:67], v[44:47], 0
    v_mfma_f32_16x16x32_bf16 v[208:211], v[52:55], v[48:51], 0
    v_mfma_f32_16x16x32_bf16 v[212:215], v[56:59], v[48:51], 0
    v_mfma_f32_16x16x32_bf16 v[216:219], v[60:63], v[48:51], 0
    v_mfma_f32_16x16x32_bf16 v[220:223], v[64:67], v[48:51], 0
    ds_read_b64_tr_b16 v[52:53], v18 offset:16384
    v_mfma_f32_16x16x32_bf16 v[112:115], v[96:99], v[68:71], v[112:115]
    ds_read_b64_tr_b16 v[54:55], v18 offset:18432
    v_mfma_f32_16x16x32_bf16 v[116:119], v[100:103], v[68:71], v[116:119]
    ds_read_b64_tr_b16 v[56:57], v19 offset:16384
    v_mfma_f32_16x16x32_bf16 v[120:123], v[104:107], v[68:71], v[120:123]
    ds_read_b64_tr_b16 v[58:59], v19 offset:18432
    v_mfma_f32_16x16x32_bf16 v[124:127], v[108:111], v[68:71], v[124:127]
    ds_read_b64_tr_b16 v[60:61], v18 offset:24576
    v_mfma_f32_16x16x32_bf16 v[128:131], v[96:99], v[72:75], v[128:131]
    ds_read_b64_tr_b16 v[62:63], v18 offset:26624
    v_mfma_f32_16x16x32_bf16 v[132:135], v[100:103], v[72:75], v[132:135]
    ds_read_b64_tr_b16 v[64:65], v19 offset:24576
    v_mfma_f32_16x16x32_bf16 v[136:139], v[104:107], v[72:75], v[136:139]
    ds_read_b64_tr_b16 v[66:67], v19 offset:26624
    v_mfma_f32_16x16x32_bf16 v[140:143], v[108:111], v[72:75], v[140:143]
    ds_read_b128 v[24:27], v16 offset:32768
    v_mfma_f32_16x16x32_bf16 v[144:147], v[96:99], v[76:79], v[144:147]
    ds_read_b128 v[28:31], v16 offset:34816
    v_mfma_f32_16x16x32_bf16 v[148:151], v[100:103], v[76:79], v[148:151]
    ds_read_b128 v[32:35], v16 offset:36864
    v_mfma_f32_16x16x32_bf16 v[152:155], v[104:107], v[76:79], v[152:155]
    ds_read_b128 v[36:39], v16 offset:38912
    v_mfma_f32_16x16x32_bf16 v[156:159], v[108:111], v[76:79], v[156:159]
    ds_read_b128 v[40:43], v16 offset:40960
    v_mfma_f32_16x16x32_bf16 v[160:163], v[96:99], v[80:83], v[160:163]
    ds_read_b128 v[44:47], v16 offset:43008
    v_mfma_f32_16x16x32_bf16 v[164:167], v[100:103], v[80:83], v[164:167]
    ds_read_b128 v[48:51], v16 offset:45056
    v_mfma_f32_16x16x32_bf16 v[168:171], v[104:107], v[80:83], v[168:171]
    v_mfma_f32_16x16x32_bf16 v[172:175], v[108:111], v[80:83], v[172:175]
    v_mfma_f32_16x16x32_bf16 v[176:179], v[96:99], v[84:87], v[176:179]
    v_mfma_f32_16x16x32_bf16 v[180:183], v[100:103], v[84:87], v[180:183]
    v_mfma_f32_16x16x32_bf16 v[184:187], v[104:107], v[84:87], v[184:187]
    v_mfma_f32_16x16x32_bf16 v[188:191], v[108:111], v[84:87], v[188:191]
    v_mfma_f32_16x16x32_bf16 v[192:195], v[96:99], v[88:91], v[192:195]
    v_mfma_f32_16x16x32_bf16 v[196:199], v[100:103], v[88:91], v[196:199]
    v_mfma_f32_16x16x32_bf16 v[200:203], v[104:107], v[88:91], v[200:203]
    v_mfma_f32_16x16x32_bf16 v[204:207], v[108:111], v[88:91], v[204:207]
    v_mfma_f32_16x16x32_bf16 v[208:211], v[96:99], v[92:95], v[208:211]
    v_mfma_f32_16x16x32_bf16 v[212:215], v[100:103], v[92:95], v[212:215]
    v_mfma_f32_16x16x32_bf16 v[216:219], v[104:107], v[92:95], v[216:219]
    v_mfma_f32_16x16x32_bf16 v[220:223], v[108:111], v[92:95], v[220:223]
    s_waitcnt lgkmcnt(0)
    ds_read_b64_tr_b16 v[96:97], v18 offset:20480
    v_mfma_f32_16x16x32_bf16 v[112:115], v[52:55], v[24:27], v[112:115]
    ds_read_b64_tr_b16 v[98:99], v18 offset:22528
    v_mfma_f32_16x16x32_bf16 v[116:119], v[56:59], v[24:27], v[116:119]
    ds_read_b64_tr_b16 v[100:101], v19 offset:20480
    v_mfma_f32_16x16x32_bf16 v[120:123], v[60:63], v[24:27], v[120:123]
    ds_read_b64_tr_b16 v[102:103], v19 offset:22528
    v_mfma_f32_16x16x32_bf16 v[124:127], v[64:67], v[24:27], v[124:127]
    ds_read_b64_tr_b16 v[104:105], v18 offset:28672
    v_mfma_f32_16x16x32_bf16 v[128:131], v[52:55], v[28:31], v[128:131]
    ds_read_b64_tr_b16 v[106:107], v18 offset:30720
    v_mfma_f32_16x16x32_bf16 v[132:135], v[56:59], v[28:31], v[132:135]
    ds_read_b64_tr_b16 v[108:109], v19 offset:28672
    v_mfma_f32_16x16x32_bf16 v[136:139], v[60:63], v[28:31], v[136:139]
    ds_read_b64_tr_b16 v[110:111], v19 offset:30720
    v_mfma_f32_16x16x32_bf16 v[140:143], v[64:67], v[28:31], v[140:143]
    ds_read_b128 v[68:71], v17 offset:32768
    v_mfma_f32_16x16x32_bf16 v[144:147], v[52:55], v[32:35], v[144:147]
    ds_read_b128 v[72:75], v17 offset:34816
    v_mfma_f32_16x16x32_bf16 v[148:151], v[56:59], v[32:35], v[148:151]
    ds_read_b128 v[76:79], v17 offset:36864
    v_mfma_f32_16x16x32_bf16 v[152:155], v[60:63], v[32:35], v[152:155]
    ds_read_b128 v[80:83], v17 offset:38912
    v_mfma_f32_16x16x32_bf16 v[156:159], v[64:67], v[32:35], v[156:159]
    ds_read_b128 v[84:87], v17 offset:40960
    v_mfma_f32_16x16x32_bf16 v[160:163], v[52:55], v[36:39], v[160:163]
    ds_read_b128 v[88:91], v17 offset:43008
    v_mfma_f32_16x16x32_bf16 v[164:167], v[56:59], v[36:39], v[164:167]
    ds_read_b128 v[92:95], v17 offset:45056
    v_mfma_f32_16x16x32_bf16 v[168:171], v[60:63], v[36:39], v[168:171]
    v_mfma_f32_16x16x32_bf16 v[172:175], v[64:67], v[36:39], v[172:175]
    v_mfma_f32_16x16x32_bf16 v[176:179], v[52:55], v[40:43], v[176:179]
    v_mfma_f32_16x16x32_bf16 v[180:183], v[56:59], v[40:43], v[180:183]
    v_mfma_f32_16x16x32_bf16 v[184:187], v[60:63], v[40:43], v[184:187]
    v_mfma_f32_16x16x32_bf16 v[188:191], v[64:67], v[40:43], v[188:191]
    v_mfma_f32_16x16x32_bf16 v[192:195], v[52:55], v[44:47], v[192:195]
    s_waitcnt lgkmcnt(0)
    s_barrier
    v_mfma_f32_16x16x32_bf16 v[196:199], v[56:59], v[44:47], v[196:199]
    v_mfma_f32_16x16x32_bf16 v[200:203], v[60:63], v[44:47], v[200:203]
    v_mfma_f32_16x16x32_bf16 v[204:207], v[64:67], v[44:47], v[204:207]
    v_mfma_f32_16x16x32_bf16 v[208:211], v[52:55], v[48:51], v[208:211]
    v_mfma_f32_16x16x32_bf16 v[212:215], v[56:59], v[48:51], v[212:215]
    v_mfma_f32_16x16x32_bf16 v[216:219], v[60:63], v[48:51], v[216:219]
    v_mfma_f32_16x16x32_bf16 v[220:223], v[64:67], v[48:51], v[220:223]
    ds_read_b64_tr_b16 v[52:53], v18 offset:32768
    v_mfma_f32_16x16x32_bf16 v[112:115], v[96:99], v[68:71], v[112:115]
    s_waitcnt vmcnt(4)
    ds_read_b64_tr_b16 v[54:55], v18 offset:34816
    v_mfma_f32_16x16x32_bf16 v[116:119], v[100:103], v[68:71], v[116:119]
    v_add_f32 v224, v224, v226
    ds_read_b64_tr_b16 v[56:57], v19 offset:32768
    v_mfma_f32_16x16x32_bf16 v[120:123], v[104:107], v[68:71], v[120:123]
    v_add_f32 v225, v225, v227
    ds_read_b64_tr_b16 v[58:59], v19 offset:34816
    v_mfma_f32_16x16x32_bf16 v[124:127], v[108:111], v[68:71], v[124:127]
    v_add_f32 v224, v224, v228
    ds_read_b64_tr_b16 v[60:61], v18 offset:40960
    v_mfma_f32_16x16x32_bf16 v[128:131], v[96:99], v[72:75], v[128:131]
    v_add_f32 v225, v225, v229
    ds_read_b64_tr_b16 v[62:63], v18 offset:43008
    v_mfma_f32_16x16x32_bf16 v[132:135], v[100:103], v[72:75], v[132:135]
    v_add_f32 v224, v224, v230
    ds_read_b64_tr_b16 v[64:65], v19 offset:40960
    v_mfma_f32_16x16x32_bf16 v[136:139], v[104:107], v[72:75], v[136:139]
    v_add_f32 v225, v225, v231
    ds_read_b64_tr_b16 v[66:67], v19 offset:43008
    v_mfma_f32_16x16x32_bf16 v[140:143], v[108:111], v[72:75], v[140:143]
    v_add_f32 v224, v224, v232
    ds_read_b128 v[24:27], v20 offset:0
    v_mfma_f32_16x16x32_bf16 v[144:147], v[96:99], v[76:79], v[144:147]
    v_add_f32 v225, v225, v233
    ds_read_b128 v[28:31], v20 offset:2048
    v_mfma_f32_16x16x32_bf16 v[148:151], v[100:103], v[76:79], v[148:151]
    v_add_f32 v224, v224, v234
    ds_read_b128 v[32:35], v20 offset:4096
    v_mfma_f32_16x16x32_bf16 v[152:155], v[104:107], v[76:79], v[152:155]
    v_add_f32 v225, v225, v235
    ds_read_b128 v[36:39], v20 offset:6144
    v_mfma_f32_16x16x32_bf16 v[156:159], v[108:111], v[76:79], v[156:159]
    v_add_f32 v224, v224, v236
    ds_read_b128 v[40:43], v20 offset:8192
    v_mfma_f32_16x16x32_bf16 v[160:163], v[96:99], v[80:83], v[160:163]
    v_add_f32 v225, v225, v237
    ds_read_b128 v[44:47], v20 offset:10240
    v_mfma_f32_16x16x32_bf16 v[164:167], v[100:103], v[80:83], v[164:167]
    v_add_f32 v224, v224, v238
    ds_read_b128 v[48:51], v20 offset:12288
    v_mfma_f32_16x16x32_bf16 v[168:171], v[104:107], v[80:83], v[168:171]
    v_add_f32 v225, v225, v239
    v_mfma_f32_16x16x32_bf16 v[172:175], v[108:111], v[80:83], v[172:175]
    v_mul_f32 v224, 3133983949, v224
    v_mfma_f32_16x16x32_bf16 v[176:179], v[96:99], v[84:87], v[176:179]
    v_mul_f32 v225, 986500301, v225
    v_mfma_f32_16x16x32_bf16 v[180:183], v[100:103], v[84:87], v[180:183]
    v_fma_f32 v225, -v224, v224, v225
    v_mfma_f32_16x16x32_bf16 v[184:187], v[104:107], v[84:87], v[184:187]
    v_max_f32 v225, 0, v225
    v_mfma_f32_16x16x32_bf16 v[188:191], v[108:111], v[84:87], v[188:191]
    v_add_f32 v227, 925353388, v225
    v_mfma_f32_16x16x32_bf16 v[192:195], v[96:99], v[88:91], v[192:195]
    v_rsq_f32 v228, v227
    v_mfma_f32_16x16x32_bf16 v[196:199], v[100:103], v[88:91], v[196:199]
    v_mul_f32 v225, 3222493025, v228
    v_mfma_f32_16x16x32_bf16 v[200:203], v[104:107], v[88:91], v[200:203]
    v_mul_f32 v226, v228, v228
    v_mfma_f32_16x16x32_bf16 v[204:207], v[108:111], v[88:91], v[204:207]
    v_mul_f32 v226, v226, v228
    v_mfma_f32_16x16x32_bf16 v[208:211], v[96:99], v[92:95], v[208:211]
    v_mul_f32 v226, 3184710632, v226
    v_mfma_f32_16x16x32_bf16 v[212:215], v[100:103], v[92:95], v[212:215]
    s_lshl_b32 s72, s35, 10
    v_mfma_f32_16x16x32_bf16 v[216:219], v[104:107], v[92:95], v[216:219]
    v_lshlrev_b32 v12, 4, v0
    v_mfma_f32_16x16x32_bf16 v[220:223], v[108:111], v[92:95], v[220:223]
    v_add_u32 v12, s72, v12
    s_waitcnt lgkmcnt(0)
    ds_read_b64_tr_b16 v[96:97], v18 offset:36864
    v_mfma_f32_16x16x32_bf16 v[112:115], v[52:55], v[24:27], v[112:115]
    ds_read_b64_tr_b16 v[98:99], v18 offset:38912
    v_mfma_f32_16x16x32_bf16 v[116:119], v[56:59], v[24:27], v[116:119]
    ds_read_b64_tr_b16 v[100:101], v19 offset:36864
    v_mfma_f32_16x16x32_bf16 v[120:123], v[60:63], v[24:27], v[120:123]
    ds_read_b64_tr_b16 v[102:103], v19 offset:38912
    v_mfma_f32_16x16x32_bf16 v[124:127], v[64:67], v[24:27], v[124:127]
    ds_read_b64_tr_b16 v[104:105], v18 offset:45056
    v_mfma_f32_16x16x32_bf16 v[128:131], v[52:55], v[28:31], v[128:131]
    ds_read_b64_tr_b16 v[106:107], v18 offset:47104
    v_mfma_f32_16x16x32_bf16 v[132:135], v[56:59], v[28:31], v[132:135]
    ds_read_b64_tr_b16 v[108:109], v19 offset:45056
    v_mfma_f32_16x16x32_bf16 v[136:139], v[60:63], v[28:31], v[136:139]
    ds_read_b64_tr_b16 v[110:111], v19 offset:47104
    v_mfma_f32_16x16x32_bf16 v[140:143], v[64:67], v[28:31], v[140:143]
    ds_read_b128 v[68:71], v21 offset:0
    v_mfma_f32_16x16x32_bf16 v[144:147], v[52:55], v[32:35], v[144:147]
    ds_read_b128 v[72:75], v21 offset:2048
    v_mfma_f32_16x16x32_bf16 v[148:151], v[56:59], v[32:35], v[148:151]
    ds_read_b128 v[76:79], v21 offset:4096
    v_mfma_f32_16x16x32_bf16 v[152:155], v[60:63], v[32:35], v[152:155]
    ds_read_b128 v[80:83], v21 offset:6144
    v_mfma_f32_16x16x32_bf16 v[156:159], v[64:67], v[32:35], v[156:159]
    ds_read_b128 v[84:87], v21 offset:8192
    v_mfma_f32_16x16x32_bf16 v[160:163], v[52:55], v[36:39], v[160:163]
    ds_read_b128 v[88:91], v21 offset:10240
    v_mfma_f32_16x16x32_bf16 v[164:167], v[56:59], v[36:39], v[164:167]
    ds_read_b128 v[92:95], v21 offset:12288
    v_mfma_f32_16x16x32_bf16 v[168:171], v[60:63], v[36:39], v[168:171]
    v_mfma_f32_16x16x32_bf16 v[172:175], v[64:67], v[36:39], v[172:175]
    v_mfma_f32_16x16x32_bf16 v[176:179], v[52:55], v[40:43], v[176:179]
    v_mfma_f32_16x16x32_bf16 v[180:183], v[56:59], v[40:43], v[180:183]
    v_mfma_f32_16x16x32_bf16 v[184:187], v[60:63], v[40:43], v[184:187]
    v_mfma_f32_16x16x32_bf16 v[188:191], v[64:67], v[40:43], v[188:191]
    v_mfma_f32_16x16x32_bf16 v[192:195], v[52:55], v[44:47], v[192:195]
    s_waitcnt lgkmcnt(0)
    s_barrier
    v_mfma_f32_16x16x32_bf16 v[196:199], v[56:59], v[44:47], v[196:199]
    v_mfma_f32_16x16x32_bf16 v[200:203], v[60:63], v[44:47], v[200:203]
    v_mfma_f32_16x16x32_bf16 v[204:207], v[64:67], v[44:47], v[204:207]
    v_mfma_f32_16x16x32_bf16 v[208:211], v[52:55], v[48:51], v[208:211]
    v_mfma_f32_16x16x32_bf16 v[212:215], v[56:59], v[48:51], v[212:215]
    v_mfma_f32_16x16x32_bf16 v[216:219], v[60:63], v[48:51], v[216:219]
    v_mfma_f32_16x16x32_bf16 v[220:223], v[64:67], v[48:51], v[220:223]
    ds_read_b64_tr_b16 v[52:53], v18 offset:0
    v_mfma_f32_16x16x32_bf16 v[112:115], v[96:99], v[68:71], v[112:115]
    v_add_u32 v12, 147712, v12
    ds_read_b64_tr_b16 v[54:55], v18 offset:2048
    v_mfma_f32_16x16x32_bf16 v[116:119], v[100:103], v[68:71], v[116:119]
    ds_write_b128 v12, v[224:227]
    ds_read_b64_tr_b16 v[56:57], v19 offset:0
    v_mfma_f32_16x16x32_bf16 v[120:123], v[104:107], v[68:71], v[120:123]
    s_waitcnt vmcnt(0)
    ds_read_b64_tr_b16 v[58:59], v19 offset:2048
    v_mfma_f32_16x16x32_bf16 v[124:127], v[108:111], v[68:71], v[124:127]
    v_and_b32 v13, 31, v0
    ds_read_b64_tr_b16 v[60:61], v18 offset:8192
    v_mfma_f32_16x16x32_bf16 v[128:131], v[96:99], v[72:75], v[128:131]
    v_lshlrev_b32 v13, 2, v13
    ds_read_b64_tr_b16 v[62:63], v18 offset:10240
    v_mfma_f32_16x16x32_bf16 v[132:135], v[100:103], v[72:75], v[132:135]
    s_lshl_b32 s72, s35, 7
    ds_read_b64_tr_b16 v[64:65], v19 offset:8192
    v_mfma_f32_16x16x32_bf16 v[136:139], v[104:107], v[72:75], v[136:139]
    v_add_u32 v13, s72, v13
    ds_read_b64_tr_b16 v[66:67], v19 offset:10240
    v_mfma_f32_16x16x32_bf16 v[140:143], v[108:111], v[72:75], v[140:143]
    v_add_u32 v13, 151808, v13
    ds_read_b128 v[24:27], v16 offset:0
    v_mfma_f32_16x16x32_bf16 v[144:147], v[96:99], v[76:79], v[144:147]
    v_add_f32 v240, v240, v241
    ds_read_b128 v[28:31], v16 offset:2048
    v_mfma_f32_16x16x32_bf16 v[148:151], v[100:103], v[76:79], v[148:151]
    v_add_f32 v240, v240, v242
    ds_read_b128 v[32:35], v16 offset:4096
    v_mfma_f32_16x16x32_bf16 v[152:155], v[104:107], v[76:79], v[152:155]
    v_add_f32 v240, v240, v243
    ds_read_b128 v[36:39], v16 offset:6144
    v_mfma_f32_16x16x32_bf16 v[156:159], v[108:111], v[76:79], v[156:159]
    v_mov_b32 v241, v240
    ds_read_b128 v[40:43], v16 offset:8192
    v_mfma_f32_16x16x32_bf16 v[160:163], v[96:99], v[80:83], v[160:163]
    v_permlane32_swap_b32 v240, v241
    ds_read_b128 v[44:47], v16 offset:10240
    v_mfma_f32_16x16x32_bf16 v[164:167], v[100:103], v[80:83], v[164:167]
    v_add_f32 v240, v240, v241
    ds_read_b128 v[48:51], v16 offset:12288
    v_mfma_f32_16x16x32_bf16 v[168:171], v[104:107], v[80:83], v[168:171]
    ds_write_b32 v13, v240 offset:0
    v_mfma_f32_16x16x32_bf16 v[172:175], v[108:111], v[80:83], v[172:175]
    v_mfma_f32_16x16x32_bf16 v[176:179], v[96:99], v[84:87], v[176:179]
    v_mfma_f32_16x16x32_bf16 v[180:183], v[100:103], v[84:87], v[180:183]
    v_mfma_f32_16x16x32_bf16 v[184:187], v[104:107], v[84:87], v[184:187]
    v_mfma_f32_16x16x32_bf16 v[188:191], v[108:111], v[84:87], v[188:191]
    v_mfma_f32_16x16x32_bf16 v[192:195], v[96:99], v[88:91], v[192:195]
    v_mfma_f32_16x16x32_bf16 v[196:199], v[100:103], v[88:91], v[196:199]
    v_mfma_f32_16x16x32_bf16 v[200:203], v[104:107], v[88:91], v[200:203]
    v_mfma_f32_16x16x32_bf16 v[204:207], v[108:111], v[88:91], v[204:207]
    v_mfma_f32_16x16x32_bf16 v[208:211], v[96:99], v[92:95], v[208:211]
    v_mfma_f32_16x16x32_bf16 v[212:215], v[100:103], v[92:95], v[212:215]
    v_mfma_f32_16x16x32_bf16 v[216:219], v[104:107], v[92:95], v[216:219]
    v_mfma_f32_16x16x32_bf16 v[220:223], v[108:111], v[92:95], v[220:223]
    s_waitcnt lgkmcnt(0)
    ds_read_b64_tr_b16 v[96:97], v18 offset:4096
    v_mfma_f32_16x16x32_bf16 v[112:115], v[52:55], v[24:27], v[112:115]
    ds_read_b64_tr_b16 v[98:99], v18 offset:6144
    v_mfma_f32_16x16x32_bf16 v[116:119], v[56:59], v[24:27], v[116:119]
    ds_read_b64_tr_b16 v[100:101], v19 offset:4096
    v_mfma_f32_16x16x32_bf16 v[120:123], v[60:63], v[24:27], v[120:123]
    ds_read_b64_tr_b16 v[102:103], v19 offset:6144
    v_mfma_f32_16x16x32_bf16 v[124:127], v[64:67], v[24:27], v[124:127]
    ds_read_b64_tr_b16 v[104:105], v18 offset:12288
    v_mfma_f32_16x16x32_bf16 v[128:131], v[52:55], v[28:31], v[128:131]
    ds_read_b64_tr_b16 v[106:107], v18 offset:14336
    v_mfma_f32_16x16x32_bf16 v[132:135], v[56:59], v[28:31], v[132:135]
    ds_read_b64_tr_b16 v[108:109], v19 offset:12288
    v_mfma_f32_16x16x32_bf16 v[136:139], v[60:63], v[28:31], v[136:139]
    ds_read_b64_tr_b16 v[110:111], v19 offset:14336
    v_mfma_f32_16x16x32_bf16 v[140:143], v[64:67], v[28:31], v[140:143]
    ds_read_b128 v[68:71], v17 offset:0
    v_mfma_f32_16x16x32_bf16 v[144:147], v[52:55], v[32:35], v[144:147]
    ds_read_b128 v[72:75], v17 offset:2048
    v_mfma_f32_16x16x32_bf16 v[148:151], v[56:59], v[32:35], v[148:151]
    ds_read_b128 v[76:79], v17 offset:4096
    v_mfma_f32_16x16x32_bf16 v[152:155], v[60:63], v[32:35], v[152:155]
    ds_read_b128 v[80:83], v17 offset:6144
    v_mfma_f32_16x16x32_bf16 v[156:159], v[64:67], v[32:35], v[156:159]
    ds_read_b128 v[84:87], v17 offset:8192
    v_mfma_f32_16x16x32_bf16 v[160:163], v[52:55], v[36:39], v[160:163]
    ds_read_b128 v[88:91], v17 offset:10240
    v_mfma_f32_16x16x32_bf16 v[164:167], v[56:59], v[36:39], v[164:167]
    ds_read_b128 v[92:95], v17 offset:12288
    v_mfma_f32_16x16x32_bf16 v[168:171], v[60:63], v[36:39], v[168:171]
    v_mfma_f32_16x16x32_bf16 v[172:175], v[64:67], v[36:39], v[172:175]
    v_mfma_f32_16x16x32_bf16 v[176:179], v[52:55], v[40:43], v[176:179]
    v_mfma_f32_16x16x32_bf16 v[180:183], v[56:59], v[40:43], v[180:183]
    v_mfma_f32_16x16x32_bf16 v[184:187], v[60:63], v[40:43], v[184:187]
    v_mfma_f32_16x16x32_bf16 v[188:191], v[64:67], v[40:43], v[188:191]
    v_mfma_f32_16x16x32_bf16 v[192:195], v[52:55], v[44:47], v[192:195]
    s_waitcnt lgkmcnt(0)
    s_barrier
    v_mfma_f32_16x16x32_bf16 v[196:199], v[56:59], v[44:47], v[196:199]
    v_mfma_f32_16x16x32_bf16 v[200:203], v[60:63], v[44:47], v[200:203]
    v_mfma_f32_16x16x32_bf16 v[204:207], v[64:67], v[44:47], v[204:207]
    v_mfma_f32_16x16x32_bf16 v[208:211], v[52:55], v[48:51], v[208:211]
    v_mfma_f32_16x16x32_bf16 v[212:215], v[56:59], v[48:51], v[212:215]
    v_mfma_f32_16x16x32_bf16 v[216:219], v[60:63], v[48:51], v[216:219]
    v_mfma_f32_16x16x32_bf16 v[220:223], v[64:67], v[48:51], v[220:223]
    ds_read_b64_tr_b16 v[52:53], v18 offset:16384
    v_mfma_f32_16x16x32_bf16 v[112:115], v[96:99], v[68:71], v[112:115]
    ds_read_b64_tr_b16 v[54:55], v18 offset:18432
    v_mfma_f32_16x16x32_bf16 v[116:119], v[100:103], v[68:71], v[116:119]
    ds_read_b64_tr_b16 v[56:57], v19 offset:16384
    v_mfma_f32_16x16x32_bf16 v[120:123], v[104:107], v[68:71], v[120:123]
    ds_read_b64_tr_b16 v[58:59], v19 offset:18432
    v_mfma_f32_16x16x32_bf16 v[124:127], v[108:111], v[68:71], v[124:127]
    ds_read_b64_tr_b16 v[60:61], v18 offset:24576
    v_mfma_f32_16x16x32_bf16 v[128:131], v[96:99], v[72:75], v[128:131]
    ds_read_b64_tr_b16 v[62:63], v18 offset:26624
    v_mfma_f32_16x16x32_bf16 v[132:135], v[100:103], v[72:75], v[132:135]
    ds_read_b64_tr_b16 v[64:65], v19 offset:24576
    v_mfma_f32_16x16x32_bf16 v[136:139], v[104:107], v[72:75], v[136:139]
    ds_read_b64_tr_b16 v[66:67], v19 offset:26624
    v_mfma_f32_16x16x32_bf16 v[140:143], v[108:111], v[72:75], v[140:143]
    ds_read_b128 v[24:27], v16 offset:32768
    v_mfma_f32_16x16x32_bf16 v[144:147], v[96:99], v[76:79], v[144:147]
    ds_read_b128 v[28:31], v16 offset:34816
    v_mfma_f32_16x16x32_bf16 v[148:151], v[100:103], v[76:79], v[148:151]
    ds_read_b128 v[32:35], v16 offset:36864
    v_mfma_f32_16x16x32_bf16 v[152:155], v[104:107], v[76:79], v[152:155]
    ds_read_b128 v[36:39], v16 offset:38912
    v_mfma_f32_16x16x32_bf16 v[156:159], v[108:111], v[76:79], v[156:159]
    ds_read_b128 v[40:43], v16 offset:40960
    v_mfma_f32_16x16x32_bf16 v[160:163], v[96:99], v[80:83], v[160:163]
    ds_read_b128 v[44:47], v16 offset:43008
    v_mfma_f32_16x16x32_bf16 v[164:167], v[100:103], v[80:83], v[164:167]
    ds_read_b128 v[48:51], v16 offset:45056
    v_mfma_f32_16x16x32_bf16 v[168:171], v[104:107], v[80:83], v[168:171]
    v_mfma_f32_16x16x32_bf16 v[172:175], v[108:111], v[80:83], v[172:175]
    v_mfma_f32_16x16x32_bf16 v[176:179], v[96:99], v[84:87], v[176:179]
    v_mfma_f32_16x16x32_bf16 v[180:183], v[100:103], v[84:87], v[180:183]
    v_mfma_f32_16x16x32_bf16 v[184:187], v[104:107], v[84:87], v[184:187]
    v_mfma_f32_16x16x32_bf16 v[188:191], v[108:111], v[84:87], v[188:191]
    v_mfma_f32_16x16x32_bf16 v[192:195], v[96:99], v[88:91], v[192:195]
    v_mfma_f32_16x16x32_bf16 v[196:199], v[100:103], v[88:91], v[196:199]
    v_mfma_f32_16x16x32_bf16 v[200:203], v[104:107], v[88:91], v[200:203]
    v_mfma_f32_16x16x32_bf16 v[204:207], v[108:111], v[88:91], v[204:207]
    v_mfma_f32_16x16x32_bf16 v[208:211], v[96:99], v[92:95], v[208:211]
    v_mfma_f32_16x16x32_bf16 v[212:215], v[100:103], v[92:95], v[212:215]
    v_mfma_f32_16x16x32_bf16 v[216:219], v[104:107], v[92:95], v[216:219]
    v_mfma_f32_16x16x32_bf16 v[220:223], v[108:111], v[92:95], v[220:223]
    s_waitcnt lgkmcnt(0)
    ds_read_b64_tr_b16 v[96:97], v18 offset:20480
    v_mfma_f32_16x16x32_bf16 v[112:115], v[52:55], v[24:27], v[112:115]
    ds_read_b64_tr_b16 v[98:99], v18 offset:22528
    v_mfma_f32_16x16x32_bf16 v[116:119], v[56:59], v[24:27], v[116:119]
    ds_read_b64_tr_b16 v[100:101], v19 offset:20480
    v_mfma_f32_16x16x32_bf16 v[120:123], v[60:63], v[24:27], v[120:123]
    ds_read_b64_tr_b16 v[102:103], v19 offset:22528
    v_mfma_f32_16x16x32_bf16 v[124:127], v[64:67], v[24:27], v[124:127]
    ds_read_b64_tr_b16 v[104:105], v18 offset:28672
    v_mfma_f32_16x16x32_bf16 v[128:131], v[52:55], v[28:31], v[128:131]
    ds_read_b64_tr_b16 v[106:107], v18 offset:30720
    v_mfma_f32_16x16x32_bf16 v[132:135], v[56:59], v[28:31], v[132:135]
    ds_read_b64_tr_b16 v[108:109], v19 offset:28672
    v_mfma_f32_16x16x32_bf16 v[136:139], v[60:63], v[28:31], v[136:139]
    ds_read_b64_tr_b16 v[110:111], v19 offset:30720
    v_mfma_f32_16x16x32_bf16 v[140:143], v[64:67], v[28:31], v[140:143]
    ds_read_b128 v[68:71], v17 offset:32768
    v_mfma_f32_16x16x32_bf16 v[144:147], v[52:55], v[32:35], v[144:147]
    ds_read_b128 v[72:75], v17 offset:34816
    v_mfma_f32_16x16x32_bf16 v[148:151], v[56:59], v[32:35], v[148:151]
    ds_read_b128 v[76:79], v17 offset:36864
    v_mfma_f32_16x16x32_bf16 v[152:155], v[60:63], v[32:35], v[152:155]
    ds_read_b128 v[80:83], v17 offset:38912
    v_mfma_f32_16x16x32_bf16 v[156:159], v[64:67], v[32:35], v[156:159]
    ds_read_b128 v[84:87], v17 offset:40960
    v_mfma_f32_16x16x32_bf16 v[160:163], v[52:55], v[36:39], v[160:163]
    ds_read_b128 v[88:91], v17 offset:43008
    v_mfma_f32_16x16x32_bf16 v[164:167], v[56:59], v[36:39], v[164:167]
    ds_read_b128 v[92:95], v17 offset:45056
    v_mfma_f32_16x16x32_bf16 v[168:171], v[60:63], v[36:39], v[168:171]
    v_mfma_f32_16x16x32_bf16 v[172:175], v[64:67], v[36:39], v[172:175]
    v_mfma_f32_16x16x32_bf16 v[176:179], v[52:55], v[40:43], v[176:179]
    v_mfma_f32_16x16x32_bf16 v[180:183], v[56:59], v[40:43], v[180:183]
    v_mfma_f32_16x16x32_bf16 v[184:187], v[60:63], v[40:43], v[184:187]
    v_mfma_f32_16x16x32_bf16 v[188:191], v[64:67], v[40:43], v[188:191]
    v_mfma_f32_16x16x32_bf16 v[192:195], v[52:55], v[44:47], v[192:195]
    s_waitcnt lgkmcnt(0)
    s_barrier
    v_mfma_f32_16x16x32_bf16 v[196:199], v[56:59], v[44:47], v[196:199]
    v_mfma_f32_16x16x32_bf16 v[200:203], v[60:63], v[44:47], v[200:203]
    v_mfma_f32_16x16x32_bf16 v[204:207], v[64:67], v[44:47], v[204:207]
    v_mfma_f32_16x16x32_bf16 v[208:211], v[52:55], v[48:51], v[208:211]
    v_mfma_f32_16x16x32_bf16 v[212:215], v[56:59], v[48:51], v[212:215]
    v_mfma_f32_16x16x32_bf16 v[216:219], v[60:63], v[48:51], v[216:219]
    v_mfma_f32_16x16x32_bf16 v[220:223], v[64:67], v[48:51], v[220:223]
    ds_read_b64_tr_b16 v[52:53], v18 offset:32768
    v_mfma_f32_16x16x32_bf16 v[112:115], v[96:99], v[68:71], v[112:115]
    ds_read_b64_tr_b16 v[54:55], v18 offset:34816
    v_mfma_f32_16x16x32_bf16 v[116:119], v[100:103], v[68:71], v[116:119]
    ds_read_b64_tr_b16 v[56:57], v19 offset:32768
    v_mfma_f32_16x16x32_bf16 v[120:123], v[104:107], v[68:71], v[120:123]
    ds_read_b64_tr_b16 v[58:59], v19 offset:34816
    v_mfma_f32_16x16x32_bf16 v[124:127], v[108:111], v[68:71], v[124:127]
    ds_read_b64_tr_b16 v[60:61], v18 offset:40960
    v_mfma_f32_16x16x32_bf16 v[128:131], v[96:99], v[72:75], v[128:131]
    ds_read_b64_tr_b16 v[62:63], v18 offset:43008
    v_mfma_f32_16x16x32_bf16 v[132:135], v[100:103], v[72:75], v[132:135]
    ds_read_b64_tr_b16 v[64:65], v19 offset:40960
    v_mfma_f32_16x16x32_bf16 v[136:139], v[104:107], v[72:75], v[136:139]
    ds_read_b64_tr_b16 v[66:67], v19 offset:43008
    v_mfma_f32_16x16x32_bf16 v[140:143], v[108:111], v[72:75], v[140:143]
    ds_read_b128 v[24:27], v20 offset:0
    v_mfma_f32_16x16x32_bf16 v[144:147], v[96:99], v[76:79], v[144:147]
    ds_read_b128 v[28:31], v20 offset:2048
    v_mfma_f32_16x16x32_bf16 v[148:151], v[100:103], v[76:79], v[148:151]
    ds_read_b128 v[32:35], v20 offset:4096
    v_mfma_f32_16x16x32_bf16 v[152:155], v[104:107], v[76:79], v[152:155]
    ds_read_b128 v[36:39], v20 offset:6144
    v_mfma_f32_16x16x32_bf16 v[156:159], v[108:111], v[76:79], v[156:159]
    ds_read_b128 v[40:43], v20 offset:8192
    v_mfma_f32_16x16x32_bf16 v[160:163], v[96:99], v[80:83], v[160:163]
    ds_read_b128 v[44:47], v20 offset:10240
    v_mfma_f32_16x16x32_bf16 v[164:167], v[100:103], v[80:83], v[164:167]
    ds_read_b128 v[48:51], v20 offset:12288
    v_mfma_f32_16x16x32_bf16 v[168:171], v[104:107], v[80:83], v[168:171]
    v_mfma_f32_16x16x32_bf16 v[172:175], v[108:111], v[80:83], v[172:175]
    v_mfma_f32_16x16x32_bf16 v[176:179], v[96:99], v[84:87], v[176:179]
    v_mfma_f32_16x16x32_bf16 v[180:183], v[100:103], v[84:87], v[180:183]
    v_mfma_f32_16x16x32_bf16 v[184:187], v[104:107], v[84:87], v[184:187]
    v_mfma_f32_16x16x32_bf16 v[188:191], v[108:111], v[84:87], v[188:191]
    v_mfma_f32_16x16x32_bf16 v[192:195], v[96:99], v[88:91], v[192:195]
    v_mfma_f32_16x16x32_bf16 v[196:199], v[100:103], v[88:91], v[196:199]
    v_mfma_f32_16x16x32_bf16 v[200:203], v[104:107], v[88:91], v[200:203]
    v_mfma_f32_16x16x32_bf16 v[204:207], v[108:111], v[88:91], v[204:207]
    v_mfma_f32_16x16x32_bf16 v[208:211], v[96:99], v[92:95], v[208:211]
    v_mfma_f32_16x16x32_bf16 v[212:215], v[100:103], v[92:95], v[212:215]
    v_mfma_f32_16x16x32_bf16 v[216:219], v[104:107], v[92:95], v[216:219]
    v_mfma_f32_16x16x32_bf16 v[220:223], v[108:111], v[92:95], v[220:223]
    s_waitcnt lgkmcnt(0)
    ds_read_b64_tr_b16 v[96:97], v18 offset:36864
    v_mfma_f32_16x16x32_bf16 v[112:115], v[52:55], v[24:27], v[112:115]
    ds_read_b64_tr_b16 v[98:99], v18 offset:38912
    v_mfma_f32_16x16x32_bf16 v[116:119], v[56:59], v[24:27], v[116:119]
    ds_read_b64_tr_b16 v[100:101], v19 offset:36864
    v_mfma_f32_16x16x32_bf16 v[120:123], v[60:63], v[24:27], v[120:123]
    ds_read_b64_tr_b16 v[102:103], v19 offset:38912
    v_mfma_f32_16x16x32_bf16 v[124:127], v[64:67], v[24:27], v[124:127]
    ds_read_b64_tr_b16 v[104:105], v18 offset:45056
    v_mfma_f32_16x16x32_bf16 v[128:131], v[52:55], v[28:31], v[128:131]
    ds_read_b64_tr_b16 v[106:107], v18 offset:47104
    v_mfma_f32_16x16x32_bf16 v[132:135], v[56:59], v[28:31], v[132:135]
    ds_read_b64_tr_b16 v[108:109], v19 offset:45056
    v_mfma_f32_16x16x32_bf16 v[136:139], v[60:63], v[28:31], v[136:139]
    ds_read_b64_tr_b16 v[110:111], v19 offset:47104
    v_mfma_f32_16x16x32_bf16 v[140:143], v[64:67], v[28:31], v[140:143]
    ds_read_b128 v[68:71], v21 offset:0
    v_mfma_f32_16x16x32_bf16 v[144:147], v[52:55], v[32:35], v[144:147]
    ds_read_b128 v[72:75], v21 offset:2048
    v_mfma_f32_16x16x32_bf16 v[148:151], v[56:59], v[32:35], v[148:151]
    ds_read_b128 v[76:79], v21 offset:4096
    v_mfma_f32_16x16x32_bf16 v[152:155], v[60:63], v[32:35], v[152:155]
    ds_read_b128 v[80:83], v21 offset:6144
    v_mfma_f32_16x16x32_bf16 v[156:159], v[64:67], v[32:35], v[156:159]
    ds_read_b128 v[84:87], v21 offset:8192
    v_mfma_f32_16x16x32_bf16 v[160:163], v[52:55], v[36:39], v[160:163]
    ds_read_b128 v[88:91], v21 offset:10240
    v_mfma_f32_16x16x32_bf16 v[164:167], v[56:59], v[36:39], v[164:167]
    ds_read_b128 v[92:95], v21 offset:12288
    v_mfma_f32_16x16x32_bf16 v[168:171], v[60:63], v[36:39], v[168:171]
    v_mfma_f32_16x16x32_bf16 v[172:175], v[64:67], v[36:39], v[172:175]
    v_mfma_f32_16x16x32_bf16 v[176:179], v[52:55], v[40:43], v[176:179]
    v_mfma_f32_16x16x32_bf16 v[180:183], v[56:59], v[40:43], v[180:183]
    v_mfma_f32_16x16x32_bf16 v[184:187], v[60:63], v[40:43], v[184:187]
    v_mfma_f32_16x16x32_bf16 v[188:191], v[64:67], v[40:43], v[188:191]
    v_mfma_f32_16x16x32_bf16 v[192:195], v[52:55], v[44:47], v[192:195]
    s_waitcnt lgkmcnt(0)
    s_barrier
    v_mfma_f32_16x16x32_bf16 v[196:199], v[56:59], v[44:47], v[196:199]
    v_mfma_f32_16x16x32_bf16 v[200:203], v[60:63], v[44:47], v[200:203]
    v_mfma_f32_16x16x32_bf16 v[204:207], v[64:67], v[44:47], v[204:207]
    v_mfma_f32_16x16x32_bf16 v[208:211], v[52:55], v[48:51], v[208:211]
    v_mfma_f32_16x16x32_bf16 v[212:215], v[56:59], v[48:51], v[212:215]
    v_mfma_f32_16x16x32_bf16 v[216:219], v[60:63], v[48:51], v[216:219]
    v_mfma_f32_16x16x32_bf16 v[220:223], v[64:67], v[48:51], v[220:223]
    ds_read_b64_tr_b16 v[52:53], v18 offset:0
    v_mfma_f32_16x16x32_bf16 v[112:115], v[96:99], v[68:71], v[112:115]
    ds_read_b64_tr_b16 v[54:55], v18 offset:2048
    v_mfma_f32_16x16x32_bf16 v[116:119], v[100:103], v[68:71], v[116:119]
    ds_read_b64_tr_b16 v[56:57], v19 offset:0
    v_mfma_f32_16x16x32_bf16 v[120:123], v[104:107], v[68:71], v[120:123]
    ds_read_b64_tr_b16 v[58:59], v19 offset:2048
    v_mfma_f32_16x16x32_bf16 v[124:127], v[108:111], v[68:71], v[124:127]
    ds_read_b64_tr_b16 v[60:61], v18 offset:8192
    v_mfma_f32_16x16x32_bf16 v[128:131], v[96:99], v[72:75], v[128:131]
    ds_read_b64_tr_b16 v[62:63], v18 offset:10240
    v_mfma_f32_16x16x32_bf16 v[132:135], v[100:103], v[72:75], v[132:135]
    ds_read_b64_tr_b16 v[64:65], v19 offset:8192
    v_mfma_f32_16x16x32_bf16 v[136:139], v[104:107], v[72:75], v[136:139]
    ds_read_b64_tr_b16 v[66:67], v19 offset:10240
    v_mfma_f32_16x16x32_bf16 v[140:143], v[108:111], v[72:75], v[140:143]
    ds_read_b128 v[24:27], v16 offset:0
    v_mfma_f32_16x16x32_bf16 v[144:147], v[96:99], v[76:79], v[144:147]
    ds_read_b128 v[28:31], v16 offset:2048
    v_mfma_f32_16x16x32_bf16 v[148:151], v[100:103], v[76:79], v[148:151]
    ds_read_b128 v[32:35], v16 offset:4096
    v_mfma_f32_16x16x32_bf16 v[152:155], v[104:107], v[76:79], v[152:155]
    ds_read_b128 v[36:39], v16 offset:6144
    v_mfma_f32_16x16x32_bf16 v[156:159], v[108:111], v[76:79], v[156:159]
    ds_read_b128 v[40:43], v16 offset:8192
    v_mfma_f32_16x16x32_bf16 v[160:163], v[96:99], v[80:83], v[160:163]
    ds_read_b128 v[44:47], v16 offset:10240
    v_mfma_f32_16x16x32_bf16 v[164:167], v[100:103], v[80:83], v[164:167]
    ds_read_b128 v[48:51], v16 offset:12288
    v_mfma_f32_16x16x32_bf16 v[168:171], v[104:107], v[80:83], v[168:171]
    v_mfma_f32_16x16x32_bf16 v[172:175], v[108:111], v[80:83], v[172:175]
    v_mfma_f32_16x16x32_bf16 v[176:179], v[96:99], v[84:87], v[176:179]
    v_mfma_f32_16x16x32_bf16 v[180:183], v[100:103], v[84:87], v[180:183]
    v_mfma_f32_16x16x32_bf16 v[184:187], v[104:107], v[84:87], v[184:187]
    v_mfma_f32_16x16x32_bf16 v[188:191], v[108:111], v[84:87], v[188:191]
    v_mfma_f32_16x16x32_bf16 v[192:195], v[96:99], v[88:91], v[192:195]
    v_mfma_f32_16x16x32_bf16 v[196:199], v[100:103], v[88:91], v[196:199]
    v_mfma_f32_16x16x32_bf16 v[200:203], v[104:107], v[88:91], v[200:203]
    v_mfma_f32_16x16x32_bf16 v[204:207], v[108:111], v[88:91], v[204:207]
    v_mfma_f32_16x16x32_bf16 v[208:211], v[96:99], v[92:95], v[208:211]
    v_mfma_f32_16x16x32_bf16 v[212:215], v[100:103], v[92:95], v[212:215]
    v_mfma_f32_16x16x32_bf16 v[216:219], v[104:107], v[92:95], v[216:219]
    v_mfma_f32_16x16x32_bf16 v[220:223], v[108:111], v[92:95], v[220:223]
    s_waitcnt lgkmcnt(0)
    ds_read_b64_tr_b16 v[96:97], v18 offset:4096
    v_mfma_f32_16x16x32_bf16 v[112:115], v[52:55], v[24:27], v[112:115]
    ds_read_b64_tr_b16 v[98:99], v18 offset:6144
    v_mfma_f32_16x16x32_bf16 v[116:119], v[56:59], v[24:27], v[116:119]
    ds_read_b64_tr_b16 v[100:101], v19 offset:4096
    v_mfma_f32_16x16x32_bf16 v[120:123], v[60:63], v[24:27], v[120:123]
    ds_read_b64_tr_b16 v[102:103], v19 offset:6144
    v_mfma_f32_16x16x32_bf16 v[124:127], v[64:67], v[24:27], v[124:127]
    ds_read_b64_tr_b16 v[104:105], v18 offset:12288
    v_mfma_f32_16x16x32_bf16 v[128:131], v[52:55], v[28:31], v[128:131]
    ds_read_b64_tr_b16 v[106:107], v18 offset:14336
    v_mfma_f32_16x16x32_bf16 v[132:135], v[56:59], v[28:31], v[132:135]
    ds_read_b64_tr_b16 v[108:109], v19 offset:12288
    v_mfma_f32_16x16x32_bf16 v[136:139], v[60:63], v[28:31], v[136:139]
    ds_read_b64_tr_b16 v[110:111], v19 offset:14336
    v_mfma_f32_16x16x32_bf16 v[140:143], v[64:67], v[28:31], v[140:143]
    ds_read_b128 v[68:71], v17 offset:0
    v_mfma_f32_16x16x32_bf16 v[144:147], v[52:55], v[32:35], v[144:147]
    ds_read_b128 v[72:75], v17 offset:2048
    v_mfma_f32_16x16x32_bf16 v[148:151], v[56:59], v[32:35], v[148:151]
    ds_read_b128 v[76:79], v17 offset:4096
    v_mfma_f32_16x16x32_bf16 v[152:155], v[60:63], v[32:35], v[152:155]
    ds_read_b128 v[80:83], v17 offset:6144
    v_mfma_f32_16x16x32_bf16 v[156:159], v[64:67], v[32:35], v[156:159]
    ds_read_b128 v[84:87], v17 offset:8192
    v_mfma_f32_16x16x32_bf16 v[160:163], v[52:55], v[36:39], v[160:163]
    ds_read_b128 v[88:91], v17 offset:10240
    v_mfma_f32_16x16x32_bf16 v[164:167], v[56:59], v[36:39], v[164:167]
    ds_read_b128 v[92:95], v17 offset:12288
    v_mfma_f32_16x16x32_bf16 v[168:171], v[60:63], v[36:39], v[168:171]
    v_mfma_f32_16x16x32_bf16 v[172:175], v[64:67], v[36:39], v[172:175]
    v_mfma_f32_16x16x32_bf16 v[176:179], v[52:55], v[40:43], v[176:179]
    v_mfma_f32_16x16x32_bf16 v[180:183], v[56:59], v[40:43], v[180:183]
    v_mfma_f32_16x16x32_bf16 v[184:187], v[60:63], v[40:43], v[184:187]
    v_mfma_f32_16x16x32_bf16 v[188:191], v[64:67], v[40:43], v[188:191]
    v_mfma_f32_16x16x32_bf16 v[192:195], v[52:55], v[44:47], v[192:195]
    s_waitcnt lgkmcnt(0)
    s_barrier
    v_mfma_f32_16x16x32_bf16 v[196:199], v[56:59], v[44:47], v[196:199]
    v_mfma_f32_16x16x32_bf16 v[200:203], v[60:63], v[44:47], v[200:203]
    v_mfma_f32_16x16x32_bf16 v[204:207], v[64:67], v[44:47], v[204:207]
    v_mfma_f32_16x16x32_bf16 v[208:211], v[52:55], v[48:51], v[208:211]
    v_mfma_f32_16x16x32_bf16 v[212:215], v[56:59], v[48:51], v[212:215]
    v_mfma_f32_16x16x32_bf16 v[216:219], v[60:63], v[48:51], v[216:219]
    v_mfma_f32_16x16x32_bf16 v[220:223], v[64:67], v[48:51], v[220:223]
    ds_read_b64_tr_b16 v[52:53], v18 offset:16384
    v_mfma_f32_16x16x32_bf16 v[112:115], v[96:99], v[68:71], v[112:115]
    ds_read_b64_tr_b16 v[54:55], v18 offset:18432
    v_mfma_f32_16x16x32_bf16 v[116:119], v[100:103], v[68:71], v[116:119]
    ds_read_b64_tr_b16 v[56:57], v19 offset:16384
    v_mfma_f32_16x16x32_bf16 v[120:123], v[104:107], v[68:71], v[120:123]
    ds_read_b64_tr_b16 v[58:59], v19 offset:18432
    v_mfma_f32_16x16x32_bf16 v[124:127], v[108:111], v[68:71], v[124:127]
    ds_read_b64_tr_b16 v[60:61], v18 offset:24576
    v_mfma_f32_16x16x32_bf16 v[128:131], v[96:99], v[72:75], v[128:131]
    ds_read_b64_tr_b16 v[62:63], v18 offset:26624
    v_mfma_f32_16x16x32_bf16 v[132:135], v[100:103], v[72:75], v[132:135]
    ds_read_b64_tr_b16 v[64:65], v19 offset:24576
    v_mfma_f32_16x16x32_bf16 v[136:139], v[104:107], v[72:75], v[136:139]
    ds_read_b64_tr_b16 v[66:67], v19 offset:26624
    v_mfma_f32_16x16x32_bf16 v[140:143], v[108:111], v[72:75], v[140:143]
    ds_read_b128 v[24:27], v16 offset:32768
    v_mfma_f32_16x16x32_bf16 v[144:147], v[96:99], v[76:79], v[144:147]
    ds_read_b128 v[28:31], v16 offset:34816
    v_mfma_f32_16x16x32_bf16 v[148:151], v[100:103], v[76:79], v[148:151]
    ds_read_b128 v[32:35], v16 offset:36864
    v_mfma_f32_16x16x32_bf16 v[152:155], v[104:107], v[76:79], v[152:155]
    ds_read_b128 v[36:39], v16 offset:38912
    v_mfma_f32_16x16x32_bf16 v[156:159], v[108:111], v[76:79], v[156:159]
    ds_read_b128 v[40:43], v16 offset:40960
    v_mfma_f32_16x16x32_bf16 v[160:163], v[96:99], v[80:83], v[160:163]
    ds_read_b128 v[44:47], v16 offset:43008
    v_mfma_f32_16x16x32_bf16 v[164:167], v[100:103], v[80:83], v[164:167]
    ds_read_b128 v[48:51], v16 offset:45056
    v_mfma_f32_16x16x32_bf16 v[168:171], v[104:107], v[80:83], v[168:171]
    v_mfma_f32_16x16x32_bf16 v[172:175], v[108:111], v[80:83], v[172:175]
    v_mfma_f32_16x16x32_bf16 v[176:179], v[96:99], v[84:87], v[176:179]
    v_mfma_f32_16x16x32_bf16 v[180:183], v[100:103], v[84:87], v[180:183]
    v_mfma_f32_16x16x32_bf16 v[184:187], v[104:107], v[84:87], v[184:187]
    v_mfma_f32_16x16x32_bf16 v[188:191], v[108:111], v[84:87], v[188:191]
    v_mfma_f32_16x16x32_bf16 v[192:195], v[96:99], v[88:91], v[192:195]
    v_mfma_f32_16x16x32_bf16 v[196:199], v[100:103], v[88:91], v[196:199]
    v_mfma_f32_16x16x32_bf16 v[200:203], v[104:107], v[88:91], v[200:203]
    v_mfma_f32_16x16x32_bf16 v[204:207], v[108:111], v[88:91], v[204:207]
    v_mfma_f32_16x16x32_bf16 v[208:211], v[96:99], v[92:95], v[208:211]
    v_mfma_f32_16x16x32_bf16 v[212:215], v[100:103], v[92:95], v[212:215]
    v_mfma_f32_16x16x32_bf16 v[216:219], v[104:107], v[92:95], v[216:219]
    v_mfma_f32_16x16x32_bf16 v[220:223], v[108:111], v[92:95], v[220:223]
    s_waitcnt lgkmcnt(0)
    ds_read_b64_tr_b16 v[96:97], v18 offset:20480
    v_mfma_f32_16x16x32_bf16 v[112:115], v[52:55], v[24:27], v[112:115]
    ds_read_b64_tr_b16 v[98:99], v18 offset:22528
    v_mfma_f32_16x16x32_bf16 v[116:119], v[56:59], v[24:27], v[116:119]
    ds_read_b64_tr_b16 v[100:101], v19 offset:20480
    v_mfma_f32_16x16x32_bf16 v[120:123], v[60:63], v[24:27], v[120:123]
    ds_read_b64_tr_b16 v[102:103], v19 offset:22528
    v_mfma_f32_16x16x32_bf16 v[124:127], v[64:67], v[24:27], v[124:127]
    ds_read_b64_tr_b16 v[104:105], v18 offset:28672
    v_mfma_f32_16x16x32_bf16 v[128:131], v[52:55], v[28:31], v[128:131]
    ds_read_b64_tr_b16 v[106:107], v18 offset:30720
    v_mfma_f32_16x16x32_bf16 v[132:135], v[56:59], v[28:31], v[132:135]
    ds_read_b64_tr_b16 v[108:109], v19 offset:28672
    v_mfma_f32_16x16x32_bf16 v[136:139], v[60:63], v[28:31], v[136:139]
    ds_read_b64_tr_b16 v[110:111], v19 offset:30720
    v_mfma_f32_16x16x32_bf16 v[140:143], v[64:67], v[28:31], v[140:143]
    ds_read_b128 v[68:71], v17 offset:32768
    v_mfma_f32_16x16x32_bf16 v[144:147], v[52:55], v[32:35], v[144:147]
    ds_read_b128 v[72:75], v17 offset:34816
    v_mfma_f32_16x16x32_bf16 v[148:151], v[56:59], v[32:35], v[148:151]
    ds_read_b128 v[76:79], v17 offset:36864
    v_mfma_f32_16x16x32_bf16 v[152:155], v[60:63], v[32:35], v[152:155]
    ds_read_b128 v[80:83], v17 offset:38912
    v_mfma_f32_16x16x32_bf16 v[156:159], v[64:67], v[32:35], v[156:159]
    ds_read_b128 v[84:87], v17 offset:40960
    v_mfma_f32_16x16x32_bf16 v[160:163], v[52:55], v[36:39], v[160:163]
    ds_read_b128 v[88:91], v17 offset:43008
    v_mfma_f32_16x16x32_bf16 v[164:167], v[56:59], v[36:39], v[164:167]
    ds_read_b128 v[92:95], v17 offset:45056
    v_mfma_f32_16x16x32_bf16 v[168:171], v[60:63], v[36:39], v[168:171]
    v_mfma_f32_16x16x32_bf16 v[172:175], v[64:67], v[36:39], v[172:175]
    v_mfma_f32_16x16x32_bf16 v[176:179], v[52:55], v[40:43], v[176:179]
    v_mfma_f32_16x16x32_bf16 v[180:183], v[56:59], v[40:43], v[180:183]
    v_mfma_f32_16x16x32_bf16 v[184:187], v[60:63], v[40:43], v[184:187]
    v_mfma_f32_16x16x32_bf16 v[188:191], v[64:67], v[40:43], v[188:191]
    v_mfma_f32_16x16x32_bf16 v[192:195], v[52:55], v[44:47], v[192:195]
    s_waitcnt lgkmcnt(0)
    s_barrier
    v_mfma_f32_16x16x32_bf16 v[196:199], v[56:59], v[44:47], v[196:199]
    v_mfma_f32_16x16x32_bf16 v[200:203], v[60:63], v[44:47], v[200:203]
    v_mfma_f32_16x16x32_bf16 v[204:207], v[64:67], v[44:47], v[204:207]
    v_mfma_f32_16x16x32_bf16 v[208:211], v[52:55], v[48:51], v[208:211]
    v_mfma_f32_16x16x32_bf16 v[212:215], v[56:59], v[48:51], v[212:215]
    v_mfma_f32_16x16x32_bf16 v[216:219], v[60:63], v[48:51], v[216:219]
    v_mfma_f32_16x16x32_bf16 v[220:223], v[64:67], v[48:51], v[220:223]
    ds_read_b64_tr_b16 v[52:53], v18 offset:32768
    v_mfma_f32_16x16x32_bf16 v[112:115], v[96:99], v[68:71], v[112:115]
    ds_read_b64_tr_b16 v[54:55], v18 offset:34816
    v_mfma_f32_16x16x32_bf16 v[116:119], v[100:103], v[68:71], v[116:119]
    ds_read_b64_tr_b16 v[56:57], v19 offset:32768
    v_mfma_f32_16x16x32_bf16 v[120:123], v[104:107], v[68:71], v[120:123]
    ds_read_b64_tr_b16 v[58:59], v19 offset:34816
    v_mfma_f32_16x16x32_bf16 v[124:127], v[108:111], v[68:71], v[124:127]
    ds_read_b64_tr_b16 v[60:61], v18 offset:40960
    v_mfma_f32_16x16x32_bf16 v[128:131], v[96:99], v[72:75], v[128:131]
    ds_read_b64_tr_b16 v[62:63], v18 offset:43008
    v_mfma_f32_16x16x32_bf16 v[132:135], v[100:103], v[72:75], v[132:135]
    ds_read_b64_tr_b16 v[64:65], v19 offset:40960
    v_mfma_f32_16x16x32_bf16 v[136:139], v[104:107], v[72:75], v[136:139]
    ds_read_b64_tr_b16 v[66:67], v19 offset:43008
    v_mfma_f32_16x16x32_bf16 v[140:143], v[108:111], v[72:75], v[140:143]
    ds_read_b128 v[24:27], v20 offset:0
    v_mfma_f32_16x16x32_bf16 v[144:147], v[96:99], v[76:79], v[144:147]
    ds_read_b128 v[28:31], v20 offset:2048
    v_mfma_f32_16x16x32_bf16 v[148:151], v[100:103], v[76:79], v[148:151]
    ds_read_b128 v[32:35], v20 offset:4096
    v_mfma_f32_16x16x32_bf16 v[152:155], v[104:107], v[76:79], v[152:155]
    ds_read_b128 v[36:39], v20 offset:6144
    v_mfma_f32_16x16x32_bf16 v[156:159], v[108:111], v[76:79], v[156:159]
    ds_read_b128 v[40:43], v20 offset:8192
    v_mfma_f32_16x16x32_bf16 v[160:163], v[96:99], v[80:83], v[160:163]
    ds_read_b128 v[44:47], v20 offset:10240
    v_mfma_f32_16x16x32_bf16 v[164:167], v[100:103], v[80:83], v[164:167]
    ds_read_b128 v[48:51], v20 offset:12288
    v_mfma_f32_16x16x32_bf16 v[168:171], v[104:107], v[80:83], v[168:171]
    v_mfma_f32_16x16x32_bf16 v[172:175], v[108:111], v[80:83], v[172:175]
    v_mfma_f32_16x16x32_bf16 v[176:179], v[96:99], v[84:87], v[176:179]
    v_mfma_f32_16x16x32_bf16 v[180:183], v[100:103], v[84:87], v[180:183]
    v_mfma_f32_16x16x32_bf16 v[184:187], v[104:107], v[84:87], v[184:187]
    v_mfma_f32_16x16x32_bf16 v[188:191], v[108:111], v[84:87], v[188:191]
    v_mfma_f32_16x16x32_bf16 v[192:195], v[96:99], v[88:91], v[192:195]
    v_mfma_f32_16x16x32_bf16 v[196:199], v[100:103], v[88:91], v[196:199]
    v_mfma_f32_16x16x32_bf16 v[200:203], v[104:107], v[88:91], v[200:203]
    v_mfma_f32_16x16x32_bf16 v[204:207], v[108:111], v[88:91], v[204:207]
    v_mfma_f32_16x16x32_bf16 v[208:211], v[96:99], v[92:95], v[208:211]
    v_mfma_f32_16x16x32_bf16 v[212:215], v[100:103], v[92:95], v[212:215]
    v_mfma_f32_16x16x32_bf16 v[216:219], v[104:107], v[92:95], v[216:219]
    v_mfma_f32_16x16x32_bf16 v[220:223], v[108:111], v[92:95], v[220:223]
    s_waitcnt lgkmcnt(0)
    ds_read_b64_tr_b16 v[96:97], v18 offset:36864
    v_mfma_f32_16x16x32_bf16 v[112:115], v[52:55], v[24:27], v[112:115]
    ds_read_b64_tr_b16 v[98:99], v18 offset:38912
    v_mfma_f32_16x16x32_bf16 v[116:119], v[56:59], v[24:27], v[116:119]
    ds_read_b64_tr_b16 v[100:101], v19 offset:36864
    v_mfma_f32_16x16x32_bf16 v[120:123], v[60:63], v[24:27], v[120:123]
    ds_read_b64_tr_b16 v[102:103], v19 offset:38912
    v_mfma_f32_16x16x32_bf16 v[124:127], v[64:67], v[24:27], v[124:127]
    ds_read_b64_tr_b16 v[104:105], v18 offset:45056
    v_mfma_f32_16x16x32_bf16 v[128:131], v[52:55], v[28:31], v[128:131]
    ds_read_b64_tr_b16 v[106:107], v18 offset:47104
    v_mfma_f32_16x16x32_bf16 v[132:135], v[56:59], v[28:31], v[132:135]
    ds_read_b64_tr_b16 v[108:109], v19 offset:45056
    v_mfma_f32_16x16x32_bf16 v[136:139], v[60:63], v[28:31], v[136:139]
    ds_read_b64_tr_b16 v[110:111], v19 offset:47104
    v_mfma_f32_16x16x32_bf16 v[140:143], v[64:67], v[28:31], v[140:143]
    ds_read_b128 v[68:71], v21 offset:0
    v_mfma_f32_16x16x32_bf16 v[144:147], v[52:55], v[32:35], v[144:147]
    ds_read_b128 v[72:75], v21 offset:2048
    v_mfma_f32_16x16x32_bf16 v[148:151], v[56:59], v[32:35], v[148:151]
    ds_read_b128 v[76:79], v21 offset:4096
    v_mfma_f32_16x16x32_bf16 v[152:155], v[60:63], v[32:35], v[152:155]
    ds_read_b128 v[80:83], v21 offset:6144
    v_mfma_f32_16x16x32_bf16 v[156:159], v[64:67], v[32:35], v[156:159]
    ds_read_b128 v[84:87], v21 offset:8192
    v_mfma_f32_16x16x32_bf16 v[160:163], v[52:55], v[36:39], v[160:163]
    ds_read_b128 v[88:91], v21 offset:10240
    v_mfma_f32_16x16x32_bf16 v[164:167], v[56:59], v[36:39], v[164:167]
    ds_read_b128 v[92:95], v21 offset:12288
    v_mfma_f32_16x16x32_bf16 v[168:171], v[60:63], v[36:39], v[168:171]
    v_mfma_f32_16x16x32_bf16 v[172:175], v[64:67], v[36:39], v[172:175]
    v_mfma_f32_16x16x32_bf16 v[176:179], v[52:55], v[40:43], v[176:179]
    v_mfma_f32_16x16x32_bf16 v[180:183], v[56:59], v[40:43], v[180:183]
    v_mfma_f32_16x16x32_bf16 v[184:187], v[60:63], v[40:43], v[184:187]
    v_mfma_f32_16x16x32_bf16 v[188:191], v[64:67], v[40:43], v[188:191]
    v_mfma_f32_16x16x32_bf16 v[192:195], v[52:55], v[44:47], v[192:195]
    s_waitcnt lgkmcnt(0)
    s_barrier
    v_mfma_f32_16x16x32_bf16 v[196:199], v[56:59], v[44:47], v[196:199]
    v_mfma_f32_16x16x32_bf16 v[200:203], v[60:63], v[44:47], v[200:203]
    v_mfma_f32_16x16x32_bf16 v[204:207], v[64:67], v[44:47], v[204:207]
    v_mfma_f32_16x16x32_bf16 v[208:211], v[52:55], v[48:51], v[208:211]
    v_mfma_f32_16x16x32_bf16 v[212:215], v[56:59], v[48:51], v[212:215]
    v_mfma_f32_16x16x32_bf16 v[216:219], v[60:63], v[48:51], v[216:219]
    v_mfma_f32_16x16x32_bf16 v[220:223], v[64:67], v[48:51], v[220:223]
    ds_read_b64_tr_b16 v[52:53], v18 offset:0
    v_mfma_f32_16x16x32_bf16 v[112:115], v[96:99], v[68:71], v[112:115]
    ds_read_b64_tr_b16 v[54:55], v18 offset:2048
    v_mfma_f32_16x16x32_bf16 v[116:119], v[100:103], v[68:71], v[116:119]
    ds_read_b64_tr_b16 v[56:57], v19 offset:0
    v_mfma_f32_16x16x32_bf16 v[120:123], v[104:107], v[68:71], v[120:123]
    ds_read_b64_tr_b16 v[58:59], v19 offset:2048
    v_mfma_f32_16x16x32_bf16 v[124:127], v[108:111], v[68:71], v[124:127]
    ds_read_b64_tr_b16 v[60:61], v18 offset:8192
    v_mfma_f32_16x16x32_bf16 v[128:131], v[96:99], v[72:75], v[128:131]
    ds_read_b64_tr_b16 v[62:63], v18 offset:10240
    v_mfma_f32_16x16x32_bf16 v[132:135], v[100:103], v[72:75], v[132:135]
    ds_read_b64_tr_b16 v[64:65], v19 offset:8192
    v_mfma_f32_16x16x32_bf16 v[136:139], v[104:107], v[72:75], v[136:139]
    ds_read_b64_tr_b16 v[66:67], v19 offset:10240
    v_mfma_f32_16x16x32_bf16 v[140:143], v[108:111], v[72:75], v[140:143]
    ds_read_b128 v[24:27], v16 offset:0
    v_mfma_f32_16x16x32_bf16 v[144:147], v[96:99], v[76:79], v[144:147]
    ds_read_b128 v[28:31], v16 offset:2048
    v_mfma_f32_16x16x32_bf16 v[148:151], v[100:103], v[76:79], v[148:151]
    ds_read_b128 v[32:35], v16 offset:4096
    v_mfma_f32_16x16x32_bf16 v[152:155], v[104:107], v[76:79], v[152:155]
    ds_read_b128 v[36:39], v16 offset:6144
    v_mfma_f32_16x16x32_bf16 v[156:159], v[108:111], v[76:79], v[156:159]
    ds_read_b128 v[40:43], v16 offset:8192
    v_mfma_f32_16x16x32_bf16 v[160:163], v[96:99], v[80:83], v[160:163]
    ds_read_b128 v[44:47], v16 offset:10240
    v_mfma_f32_16x16x32_bf16 v[164:167], v[100:103], v[80:83], v[164:167]
    ds_read_b128 v[48:51], v16 offset:12288
    v_mfma_f32_16x16x32_bf16 v[168:171], v[104:107], v[80:83], v[168:171]
    v_mfma_f32_16x16x32_bf16 v[172:175], v[108:111], v[80:83], v[172:175]
    v_mfma_f32_16x16x32_bf16 v[176:179], v[96:99], v[84:87], v[176:179]
    v_mfma_f32_16x16x32_bf16 v[180:183], v[100:103], v[84:87], v[180:183]
    v_mfma_f32_16x16x32_bf16 v[184:187], v[104:107], v[84:87], v[184:187]
    v_mfma_f32_16x16x32_bf16 v[188:191], v[108:111], v[84:87], v[188:191]
    v_mfma_f32_16x16x32_bf16 v[192:195], v[96:99], v[88:91], v[192:195]
    v_mfma_f32_16x16x32_bf16 v[196:199], v[100:103], v[88:91], v[196:199]
    v_mfma_f32_16x16x32_bf16 v[200:203], v[104:107], v[88:91], v[200:203]
    v_mfma_f32_16x16x32_bf16 v[204:207], v[108:111], v[88:91], v[204:207]
    v_mfma_f32_16x16x32_bf16 v[208:211], v[96:99], v[92:95], v[208:211]
    v_mfma_f32_16x16x32_bf16 v[212:215], v[100:103], v[92:95], v[212:215]
    v_mfma_f32_16x16x32_bf16 v[216:219], v[104:107], v[92:95], v[216:219]
    v_mfma_f32_16x16x32_bf16 v[220:223], v[108:111], v[92:95], v[220:223]
    s_waitcnt lgkmcnt(0)
    ds_read_b64_tr_b16 v[96:97], v18 offset:4096
    v_mfma_f32_16x16x32_bf16 v[112:115], v[52:55], v[24:27], v[112:115]
    ds_read_b64_tr_b16 v[98:99], v18 offset:6144
    v_mfma_f32_16x16x32_bf16 v[116:119], v[56:59], v[24:27], v[116:119]
    ds_read_b64_tr_b16 v[100:101], v19 offset:4096
    v_mfma_f32_16x16x32_bf16 v[120:123], v[60:63], v[24:27], v[120:123]
    ds_read_b64_tr_b16 v[102:103], v19 offset:6144
    v_mfma_f32_16x16x32_bf16 v[124:127], v[64:67], v[24:27], v[124:127]
    ds_read_b64_tr_b16 v[104:105], v18 offset:12288
    v_mfma_f32_16x16x32_bf16 v[128:131], v[52:55], v[28:31], v[128:131]
    ds_read_b64_tr_b16 v[106:107], v18 offset:14336
    v_mfma_f32_16x16x32_bf16 v[132:135], v[56:59], v[28:31], v[132:135]
    ds_read_b64_tr_b16 v[108:109], v19 offset:12288
    v_mfma_f32_16x16x32_bf16 v[136:139], v[60:63], v[28:31], v[136:139]
    ds_read_b64_tr_b16 v[110:111], v19 offset:14336
    v_mfma_f32_16x16x32_bf16 v[140:143], v[64:67], v[28:31], v[140:143]
    ds_read_b128 v[68:71], v17 offset:0
    v_mfma_f32_16x16x32_bf16 v[144:147], v[52:55], v[32:35], v[144:147]
    ds_read_b128 v[72:75], v17 offset:2048
    v_mfma_f32_16x16x32_bf16 v[148:151], v[56:59], v[32:35], v[148:151]
    ds_read_b128 v[76:79], v17 offset:4096
    v_mfma_f32_16x16x32_bf16 v[152:155], v[60:63], v[32:35], v[152:155]
    ds_read_b128 v[80:83], v17 offset:6144
    v_mfma_f32_16x16x32_bf16 v[156:159], v[64:67], v[32:35], v[156:159]
    ds_read_b128 v[84:87], v17 offset:8192
    v_mfma_f32_16x16x32_bf16 v[160:163], v[52:55], v[36:39], v[160:163]
    ds_read_b128 v[88:91], v17 offset:10240
    v_mfma_f32_16x16x32_bf16 v[164:167], v[56:59], v[36:39], v[164:167]
    ds_read_b128 v[92:95], v17 offset:12288
    v_mfma_f32_16x16x32_bf16 v[168:171], v[60:63], v[36:39], v[168:171]
    v_mfma_f32_16x16x32_bf16 v[172:175], v[64:67], v[36:39], v[172:175]
    v_mfma_f32_16x16x32_bf16 v[176:179], v[52:55], v[40:43], v[176:179]
    v_mfma_f32_16x16x32_bf16 v[180:183], v[56:59], v[40:43], v[180:183]
    v_mfma_f32_16x16x32_bf16 v[184:187], v[60:63], v[40:43], v[184:187]
    v_mfma_f32_16x16x32_bf16 v[188:191], v[64:67], v[40:43], v[188:191]
    v_mfma_f32_16x16x32_bf16 v[192:195], v[52:55], v[44:47], v[192:195]
    s_waitcnt lgkmcnt(0)
    s_barrier
    v_mfma_f32_16x16x32_bf16 v[196:199], v[56:59], v[44:47], v[196:199]
    v_mfma_f32_16x16x32_bf16 v[200:203], v[60:63], v[44:47], v[200:203]
    v_mfma_f32_16x16x32_bf16 v[204:207], v[64:67], v[44:47], v[204:207]
    v_mfma_f32_16x16x32_bf16 v[208:211], v[52:55], v[48:51], v[208:211]
    v_mfma_f32_16x16x32_bf16 v[212:215], v[56:59], v[48:51], v[212:215]
    v_mfma_f32_16x16x32_bf16 v[216:219], v[60:63], v[48:51], v[216:219]
    v_mfma_f32_16x16x32_bf16 v[220:223], v[64:67], v[48:51], v[220:223]
    ds_read_b128 v[24:27], v8 offset:0
    v_mfma_f32_16x16x32_bf16 v[112:115], v[96:99], v[68:71], v[112:115]
    ds_read_b128 v[28:31], v8 offset:64
    v_mfma_f32_16x16x32_bf16 v[116:119], v[100:103], v[68:71], v[116:119]
    ds_read_b128 v[32:35], v8 offset:256
    v_mfma_f32_16x16x32_bf16 v[120:123], v[104:107], v[68:71], v[120:123]
    ds_read_b128 v[36:39], v8 offset:320
    v_mfma_f32_16x16x32_bf16 v[124:127], v[108:111], v[68:71], v[124:127]
    ds_read_b128 v[40:43], v11 offset:0
    v_mfma_f32_16x16x32_bf16 v[128:131], v[96:99], v[72:75], v[128:131]
    ds_read_b128 v[44:47], v11 offset:256
    v_mfma_f32_16x16x32_bf16 v[132:135], v[100:103], v[72:75], v[132:135]
    ds_read_b128 v[48:51], v11 offset:512
    v_mfma_f32_16x16x32_bf16 v[136:139], v[104:107], v[72:75], v[136:139]
    ds_read_b128 v[52:55], v11 offset:768
    v_mfma_f32_16x16x32_bf16 v[140:143], v[108:111], v[72:75], v[140:143]
    ds_read_b128 v[56:59], v11 offset:1024
    v_mfma_f32_16x16x32_bf16 v[144:147], v[96:99], v[76:79], v[144:147]
    ds_read_b128 v[60:63], v11 offset:1280
    v_mfma_f32_16x16x32_bf16 v[148:151], v[100:103], v[76:79], v[148:151]
    ds_read_b128 v[64:67], v11 offset:1536
    v_mfma_f32_16x16x32_bf16 v[152:155], v[104:107], v[76:79], v[152:155]
    v_mfma_f32_16x16x32_bf16 v[156:159], v[108:111], v[76:79], v[156:159]
    v_mfma_f32_16x16x32_bf16 v[160:163], v[96:99], v[80:83], v[160:163]
    v_mfma_f32_16x16x32_bf16 v[164:167], v[100:103], v[80:83], v[164:167]
    v_mfma_f32_16x16x32_bf16 v[168:171], v[104:107], v[80:83], v[168:171]
    v_mfma_f32_16x16x32_bf16 v[172:175], v[108:111], v[80:83], v[172:175]
    v_mfma_f32_16x16x32_bf16 v[176:179], v[96:99], v[84:87], v[176:179]
    v_mfma_f32_16x16x32_bf16 v[180:183], v[100:103], v[84:87], v[180:183]
    v_mfma_f32_16x16x32_bf16 v[184:187], v[104:107], v[84:87], v[184:187]
    v_mfma_f32_16x16x32_bf16 v[188:191], v[108:111], v[84:87], v[188:191]
    v_mfma_f32_16x16x32_bf16 v[192:195], v[96:99], v[88:91], v[192:195]
    v_mfma_f32_16x16x32_bf16 v[196:199], v[100:103], v[88:91], v[196:199]
    v_mfma_f32_16x16x32_bf16 v[200:203], v[104:107], v[88:91], v[200:203]
    v_mfma_f32_16x16x32_bf16 v[204:207], v[108:111], v[88:91], v[204:207]
    v_mfma_f32_16x16x32_bf16 v[208:211], v[96:99], v[92:95], v[208:211]
    v_mfma_f32_16x16x32_bf16 v[212:215], v[100:103], v[92:95], v[212:215]
    v_mfma_f32_16x16x32_bf16 v[216:219], v[104:107], v[92:95], v[216:219]
    v_mfma_f32_16x16x32_bf16 v[220:223], v[108:111], v[92:95], v[220:223]
    s_waitcnt lgkmcnt(0)
    v_pk_fma_f32 v[112:113], v[24:25], v[40:41], v[112:113] op_sel_hi:[1,0,1]
    v_pk_fma_f32 v[114:115], v[26:27], v[40:41], v[114:115] op_sel_hi:[1,0,1]
    v_pk_fma_f32 v[116:117], v[28:29], v[40:41], v[116:117] op_sel_hi:[1,0,1]
    v_pk_fma_f32 v[118:119], v[30:31], v[40:41], v[118:119] op_sel_hi:[1,0,1]
    v_pk_mul_f32 v[68:69], v[112:113], v[112:113]
    v_pk_mul_f32 v[70:71], v[114:115], v[114:115]
    v_pk_mul_f32 v[72:73], v[116:117], v[116:117]
    v_pk_mul_f32 v[74:75], v[118:119], v[118:119]
    v_pk_fma_f32 v[68:69], v[68:69], v[42:43], v[40:41] op_sel:[0,0,1] op_sel_hi:[1,0,1]
    v_pk_fma_f32 v[70:71], v[70:71], v[42:43], v[40:41] op_sel:[0,0,1] op_sel_hi:[1,0,1]
    v_pk_fma_f32 v[72:73], v[72:73], v[42:43], v[40:41] op_sel:[0,0,1] op_sel_hi:[1,0,1]
    v_pk_fma_f32 v[74:75], v[74:75], v[42:43], v[40:41] op_sel:[0,0,1] op_sel_hi:[1,0,1]
    v_pk_mul_f32 v[68:69], v[68:69], v[112:113]
    v_pk_mul_f32 v[70:71], v[70:71], v[114:115]
    v_pk_mul_f32 v[72:73], v[72:73], v[116:117]
    v_pk_mul_f32 v[74:75], v[74:75], v[118:119]
    v_exp_f32 v68, v68
    v_exp_f32 v69, v69
    v_exp_f32 v70, v70
    v_exp_f32 v71, v71
    v_exp_f32 v72, v72
    v_exp_f32 v73, v73
    v_exp_f32 v74, v74
    v_exp_f32 v75, v75
    v_pk_fma_f32 v[120:121], v[32:33], v[40:41], v[120:121] op_sel_hi:[1,0,1]
    v_pk_fma_f32 v[122:123], v[34:35], v[40:41], v[122:123] op_sel_hi:[1,0,1]
    v_pk_fma_f32 v[124:125], v[36:37], v[40:41], v[124:125] op_sel_hi:[1,0,1]
    v_pk_fma_f32 v[126:127], v[38:39], v[40:41], v[126:127] op_sel_hi:[1,0,1]
    v_pk_fma_f32 v[68:69], v[68:69], v[42:43], v[42:43] op_sel:[0,1,1] op_sel_hi:[1,1,1]
    v_pk_fma_f32 v[70:71], v[70:71], v[42:43], v[42:43] op_sel:[0,1,1] op_sel_hi:[1,1,1]
    v_pk_fma_f32 v[72:73], v[72:73], v[42:43], v[42:43] op_sel:[0,1,1] op_sel_hi:[1,1,1]
    v_pk_fma_f32 v[74:75], v[74:75], v[42:43], v[42:43] op_sel:[0,1,1] op_sel_hi:[1,1,1]
    v_rcp_f32 v68, v68
    v_rcp_f32 v69, v69
    v_rcp_f32 v70, v70
    v_rcp_f32 v71, v71
    v_rcp_f32 v72, v72
    v_rcp_f32 v73, v73
    v_rcp_f32 v74, v74
    v_rcp_f32 v75, v75
    v_pk_mul_f32 v[112:113], v[112:113], v[120:121]
    v_pk_mul_f32 v[114:115], v[114:115], v[122:123]
    v_pk_mul_f32 v[116:117], v[116:117], v[124:125]
    v_pk_mul_f32 v[118:119], v[118:119], v[126:127]
    v_pk_mul_f32 v[112:113], v[112:113], v[68:69]
    v_pk_mul_f32 v[114:115], v[114:115], v[70:71]
    v_pk_mul_f32 v[116:117], v[116:117], v[72:73]
    v_pk_mul_f32 v[118:119], v[118:119], v[74:75]
    v_cvt_pk_bf16_f32 v76, v112, v113
    v_cvt_pk_bf16_f32 v77, v114, v115
    v_cvt_pk_bf16_f32 v78, v116, v117
    v_cvt_pk_bf16_f32 v79, v118, v119
    s_nop 0
    v_permlane16_swap_b32 v76, v78
    v_permlane16_swap_b32 v77, v79
    s_mov_b32 s38, 0
    buffer_store_dwordx4 v[76:79], v10, s[52:55], s38 offen sc1
    v_pk_fma_f32 v[128:129], v[24:25], v[44:45], v[128:129] op_sel_hi:[1,0,1]
    v_pk_fma_f32 v[130:131], v[26:27], v[44:45], v[130:131] op_sel_hi:[1,0,1]
    v_pk_fma_f32 v[132:133], v[28:29], v[44:45], v[132:133] op_sel_hi:[1,0,1]
    v_pk_fma_f32 v[134:135], v[30:31], v[44:45], v[134:135] op_sel_hi:[1,0,1]
    v_pk_mul_f32 v[68:69], v[128:129], v[128:129]
    v_pk_mul_f32 v[70:71], v[130:131], v[130:131]
    v_pk_mul_f32 v[72:73], v[132:133], v[132:133]
    v_pk_mul_f32 v[74:75], v[134:135], v[134:135]
    v_pk_fma_f32 v[68:69], v[68:69], v[46:47], v[44:45] op_sel:[0,0,1] op_sel_hi:[1,0,1]
    v_pk_fma_f32 v[70:71], v[70:71], v[46:47], v[44:45] op_sel:[0,0,1] op_sel_hi:[1,0,1]
    v_pk_fma_f32 v[72:73], v[72:73], v[46:47], v[44:45] op_sel:[0,0,1] op_sel_hi:[1,0,1]
    v_pk_fma_f32 v[74:75], v[74:75], v[46:47], v[44:45] op_sel:[0,0,1] op_sel_hi:[1,0,1]
    v_pk_mul_f32 v[68:69], v[68:69], v[128:129]
    v_pk_mul_f32 v[70:71], v[70:71], v[130:131]
    v_pk_mul_f32 v[72:73], v[72:73], v[132:133]
    v_pk_mul_f32 v[74:75], v[74:75], v[134:135]
    v_exp_f32 v68, v68
    v_exp_f32 v69, v69
    v_exp_f32 v70, v70
    v_exp_f32 v71, v71
    v_exp_f32 v72, v72
    v_exp_f32 v73, v73
    v_exp_f32 v74, v74
    v_exp_f32 v75, v75
    v_pk_fma_f32 v[136:137], v[32:33], v[44:45], v[136:137] op_sel_hi:[1,0,1]
    v_pk_fma_f32 v[138:139], v[34:35], v[44:45], v[138:139] op_sel_hi:[1,0,1]
    v_pk_fma_f32 v[140:141], v[36:37], v[44:45], v[140:141] op_sel_hi:[1,0,1]
    v_pk_fma_f32 v[142:143], v[38:39], v[44:45], v[142:143] op_sel_hi:[1,0,1]
    v_pk_fma_f32 v[68:69], v[68:69], v[46:47], v[46:47] op_sel:[0,1,1] op_sel_hi:[1,1,1]
    v_pk_fma_f32 v[70:71], v[70:71], v[46:47], v[46:47] op_sel:[0,1,1] op_sel_hi:[1,1,1]
    v_pk_fma_f32 v[72:73], v[72:73], v[46:47], v[46:47] op_sel:[0,1,1] op_sel_hi:[1,1,1]
    v_pk_fma_f32 v[74:75], v[74:75], v[46:47], v[46:47] op_sel:[0,1,1] op_sel_hi:[1,1,1]
    v_rcp_f32 v68, v68
    v_rcp_f32 v69, v69
    v_rcp_f32 v70, v70
    v_rcp_f32 v71, v71
    v_rcp_f32 v72, v72
    v_rcp_f32 v73, v73
    v_rcp_f32 v74, v74
    v_rcp_f32 v75, v75
    v_pk_mul_f32 v[128:129], v[128:129], v[136:137]
    v_pk_mul_f32 v[130:131], v[130:131], v[138:139]
    v_pk_mul_f32 v[132:133], v[132:133], v[140:141]
    v_pk_mul_f32 v[134:135], v[134:135], v[142:143]
    v_pk_mul_f32 v[128:129], v[128:129], v[68:69]
    v_pk_mul_f32 v[130:131], v[130:131], v[70:71]
    v_pk_mul_f32 v[132:133], v[132:133], v[72:73]
    v_pk_mul_f32 v[134:135], v[134:135], v[74:75]
    v_cvt_pk_bf16_f32 v80, v128, v129
    v_cvt_pk_bf16_f32 v81, v130, v131
    v_cvt_pk_bf16_f32 v82, v132, v133
    v_cvt_pk_bf16_f32 v83, v134, v135
    s_nop 0
    v_permlane16_swap_b32 v80, v82
    v_permlane16_swap_b32 v81, v83
    s_mov_b32 s38, 55296
    buffer_store_dwordx4 v[80:83], v10, s[52:55], s38 offen sc1
    v_pk_fma_f32 v[144:145], v[24:25], v[48:49], v[144:145] op_sel_hi:[1,0,1]
    v_pk_fma_f32 v[146:147], v[26:27], v[48:49], v[146:147] op_sel_hi:[1,0,1]
    v_pk_fma_f32 v[148:149], v[28:29], v[48:49], v[148:149] op_sel_hi:[1,0,1]
    v_pk_fma_f32 v[150:151], v[30:31], v[48:49], v[150:151] op_sel_hi:[1,0,1]
    v_pk_mul_f32 v[68:69], v[144:145], v[144:145]
    v_pk_mul_f32 v[70:71], v[146:147], v[146:147]
    v_pk_mul_f32 v[72:73], v[148:149], v[148:149]
    v_pk_mul_f32 v[74:75], v[150:151], v[150:151]
    v_pk_fma_f32 v[68:69], v[68:69], v[50:51], v[48:49] op_sel:[0,0,1] op_sel_hi:[1,0,1]
    v_pk_fma_f32 v[70:71], v[70:71], v[50:51], v[48:49] op_sel:[0,0,1] op_sel_hi:[1,0,1]
    v_pk_fma_f32 v[72:73], v[72:73], v[50:51], v[48:49] op_sel:[0,0,1] op_sel_hi:[1,0,1]
    v_pk_fma_f32 v[74:75], v[74:75], v[50:51], v[48:49] op_sel:[0,0,1] op_sel_hi:[1,0,1]
    v_pk_mul_f32 v[68:69], v[68:69], v[144:145]
    v_pk_mul_f32 v[70:71], v[70:71], v[146:147]
    v_pk_mul_f32 v[72:73], v[72:73], v[148:149]
    v_pk_mul_f32 v[74:75], v[74:75], v[150:151]
    v_exp_f32 v68, v68
    v_exp_f32 v69, v69
    v_exp_f32 v70, v70
    v_exp_f32 v71, v71
    v_exp_f32 v72, v72
    v_exp_f32 v73, v73
    v_exp_f32 v74, v74
    v_exp_f32 v75, v75
    v_pk_fma_f32 v[152:153], v[32:33], v[48:49], v[152:153] op_sel_hi:[1,0,1]
    v_pk_fma_f32 v[154:155], v[34:35], v[48:49], v[154:155] op_sel_hi:[1,0,1]
    v_pk_fma_f32 v[156:157], v[36:37], v[48:49], v[156:157] op_sel_hi:[1,0,1]
    v_pk_fma_f32 v[158:159], v[38:39], v[48:49], v[158:159] op_sel_hi:[1,0,1]
    v_pk_fma_f32 v[68:69], v[68:69], v[50:51], v[50:51] op_sel:[0,1,1] op_sel_hi:[1,1,1]
    v_pk_fma_f32 v[70:71], v[70:71], v[50:51], v[50:51] op_sel:[0,1,1] op_sel_hi:[1,1,1]
    v_pk_fma_f32 v[72:73], v[72:73], v[50:51], v[50:51] op_sel:[0,1,1] op_sel_hi:[1,1,1]
    v_pk_fma_f32 v[74:75], v[74:75], v[50:51], v[50:51] op_sel:[0,1,1] op_sel_hi:[1,1,1]
    v_rcp_f32 v68, v68
    v_rcp_f32 v69, v69
    v_rcp_f32 v70, v70
    v_rcp_f32 v71, v71
    v_rcp_f32 v72, v72
    v_rcp_f32 v73, v73
    v_rcp_f32 v74, v74
    v_rcp_f32 v75, v75
    v_pk_mul_f32 v[144:145], v[144:145], v[152:153]
    v_pk_mul_f32 v[146:147], v[146:147], v[154:155]
    v_pk_mul_f32 v[148:149], v[148:149], v[156:157]
    v_pk_mul_f32 v[150:151], v[150:151], v[158:159]
    v_pk_mul_f32 v[144:145], v[144:145], v[68:69]
    v_pk_mul_f32 v[146:147], v[146:147], v[70:71]
    v_pk_mul_f32 v[148:149], v[148:149], v[72:73]
    v_pk_mul_f32 v[150:151], v[150:151], v[74:75]
    v_cvt_pk_bf16_f32 v76, v144, v145
    v_cvt_pk_bf16_f32 v77, v146, v147
    v_cvt_pk_bf16_f32 v78, v148, v149
    v_cvt_pk_bf16_f32 v79, v150, v151
    s_nop 0
    v_permlane16_swap_b32 v76, v78
    v_permlane16_swap_b32 v77, v79
    s_mov_b32 s38, 110592
    buffer_store_dwordx4 v[76:79], v10, s[52:55], s38 offen sc1
    v_pk_fma_f32 v[160:161], v[24:25], v[52:53], v[160:161] op_sel_hi:[1,0,1]
    v_pk_fma_f32 v[162:163], v[26:27], v[52:53], v[162:163] op_sel_hi:[1,0,1]
    v_pk_fma_f32 v[164:165], v[28:29], v[52:53], v[164:165] op_sel_hi:[1,0,1]
    v_pk_fma_f32 v[166:167], v[30:31], v[52:53], v[166:167] op_sel_hi:[1,0,1]
    v_pk_mul_f32 v[68:69], v[160:161], v[160:161]
    v_pk_mul_f32 v[70:71], v[162:163], v[162:163]
    v_pk_mul_f32 v[72:73], v[164:165], v[164:165]
    v_pk_mul_f32 v[74:75], v[166:167], v[166:167]
    v_pk_fma_f32 v[68:69], v[68:69], v[54:55], v[52:53] op_sel:[0,0,1] op_sel_hi:[1,0,1]
    v_pk_fma_f32 v[70:71], v[70:71], v[54:55], v[52:53] op_sel:[0,0,1] op_sel_hi:[1,0,1]
    v_pk_fma_f32 v[72:73], v[72:73], v[54:55], v[52:53] op_sel:[0,0,1] op_sel_hi:[1,0,1]
    v_pk_fma_f32 v[74:75], v[74:75], v[54:55], v[52:53] op_sel:[0,0,1] op_sel_hi:[1,0,1]
    v_pk_mul_f32 v[68:69], v[68:69], v[160:161]
    v_pk_mul_f32 v[70:71], v[70:71], v[162:163]
    v_pk_mul_f32 v[72:73], v[72:73], v[164:165]
    v_pk_mul_f32 v[74:75], v[74:75], v[166:167]
    v_exp_f32 v68, v68
    v_exp_f32 v69, v69
    v_exp_f32 v70, v70
    v_exp_f32 v71, v71
    v_exp_f32 v72, v72
    v_exp_f32 v73, v73
    v_exp_f32 v74, v74
    v_exp_f32 v75, v75
    v_pk_fma_f32 v[168:169], v[32:33], v[52:53], v[168:169] op_sel_hi:[1,0,1]
    v_pk_fma_f32 v[170:171], v[34:35], v[52:53], v[170:171] op_sel_hi:[1,0,1]
    v_pk_fma_f32 v[172:173], v[36:37], v[52:53], v[172:173] op_sel_hi:[1,0,1]
    v_pk_fma_f32 v[174:175], v[38:39], v[52:53], v[174:175] op_sel_hi:[1,0,1]
    v_pk_fma_f32 v[68:69], v[68:69], v[54:55], v[54:55] op_sel:[0,1,1] op_sel_hi:[1,1,1]
    v_pk_fma_f32 v[70:71], v[70:71], v[54:55], v[54:55] op_sel:[0,1,1] op_sel_hi:[1,1,1]
    v_pk_fma_f32 v[72:73], v[72:73], v[54:55], v[54:55] op_sel:[0,1,1] op_sel_hi:[1,1,1]
    v_pk_fma_f32 v[74:75], v[74:75], v[54:55], v[54:55] op_sel:[0,1,1] op_sel_hi:[1,1,1]
    v_rcp_f32 v68, v68
    v_rcp_f32 v69, v69
    v_rcp_f32 v70, v70
    v_rcp_f32 v71, v71
    v_rcp_f32 v72, v72
    v_rcp_f32 v73, v73
    v_rcp_f32 v74, v74
    v_rcp_f32 v75, v75
    v_pk_mul_f32 v[160:161], v[160:161], v[168:169]
    v_pk_mul_f32 v[162:163], v[162:163], v[170:171]
    v_pk_mul_f32 v[164:165], v[164:165], v[172:173]
    v_pk_mul_f32 v[166:167], v[166:167], v[174:175]
    v_pk_mul_f32 v[160:161], v[160:161], v[68:69]
    v_pk_mul_f32 v[162:163], v[162:163], v[70:71]
    v_pk_mul_f32 v[164:165], v[164:165], v[72:73]
    v_pk_mul_f32 v[166:167], v[166:167], v[74:75]
    v_cvt_pk_bf16_f32 v80, v160, v161
    v_cvt_pk_bf16_f32 v81, v162, v163
    v_cvt_pk_bf16_f32 v82, v164, v165
    v_cvt_pk_bf16_f32 v83, v166, v167
    s_nop 0
    v_permlane16_swap_b32 v80, v82
    v_permlane16_swap_b32 v81, v83
    s_mov_b32 s38, 165888
    buffer_store_dwordx4 v[80:83], v10, s[52:55], s38 offen sc1
    v_pk_fma_f32 v[176:177], v[24:25], v[56:57], v[176:177] op_sel_hi:[1,0,1]
    v_pk_fma_f32 v[178:179], v[26:27], v[56:57], v[178:179] op_sel_hi:[1,0,1]
    v_pk_fma_f32 v[180:181], v[28:29], v[56:57], v[180:181] op_sel_hi:[1,0,1]
    v_pk_fma_f32 v[182:183], v[30:31], v[56:57], v[182:183] op_sel_hi:[1,0,1]
    v_pk_mul_f32 v[68:69], v[176:177], v[176:177]
    v_pk_mul_f32 v[70:71], v[178:179], v[178:179]
    v_pk_mul_f32 v[72:73], v[180:181], v[180:181]
    v_pk_mul_f32 v[74:75], v[182:183], v[182:183]
    v_pk_fma_f32 v[68:69], v[68:69], v[58:59], v[56:57] op_sel:[0,0,1] op_sel_hi:[1,0,1]
    v_pk_fma_f32 v[70:71], v[70:71], v[58:59], v[56:57] op_sel:[0,0,1] op_sel_hi:[1,0,1]
    v_pk_fma_f32 v[72:73], v[72:73], v[58:59], v[56:57] op_sel:[0,0,1] op_sel_hi:[1,0,1]
    v_pk_fma_f32 v[74:75], v[74:75], v[58:59], v[56:57] op_sel:[0,0,1] op_sel_hi:[1,0,1]
    v_pk_mul_f32 v[68:69], v[68:69], v[176:177]
    v_pk_mul_f32 v[70:71], v[70:71], v[178:179]
    v_pk_mul_f32 v[72:73], v[72:73], v[180:181]
    v_pk_mul_f32 v[74:75], v[74:75], v[182:183]
    v_exp_f32 v68, v68
    v_exp_f32 v69, v69
    v_exp_f32 v70, v70
    v_exp_f32 v71, v71
    v_exp_f32 v72, v72
    v_exp_f32 v73, v73
    v_exp_f32 v74, v74
    v_exp_f32 v75, v75
    v_pk_fma_f32 v[184:185], v[32:33], v[56:57], v[184:185] op_sel_hi:[1,0,1]
    v_pk_fma_f32 v[186:187], v[34:35], v[56:57], v[186:187] op_sel_hi:[1,0,1]
    v_pk_fma_f32 v[188:189], v[36:37], v[56:57], v[188:189] op_sel_hi:[1,0,1]
    v_pk_fma_f32 v[190:191], v[38:39], v[56:57], v[190:191] op_sel_hi:[1,0,1]
    v_pk_fma_f32 v[68:69], v[68:69], v[58:59], v[58:59] op_sel:[0,1,1] op_sel_hi:[1,1,1]
    v_pk_fma_f32 v[70:71], v[70:71], v[58:59], v[58:59] op_sel:[0,1,1] op_sel_hi:[1,1,1]
    v_pk_fma_f32 v[72:73], v[72:73], v[58:59], v[58:59] op_sel:[0,1,1] op_sel_hi:[1,1,1]
    v_pk_fma_f32 v[74:75], v[74:75], v[58:59], v[58:59] op_sel:[0,1,1] op_sel_hi:[1,1,1]
    v_rcp_f32 v68, v68
    v_rcp_f32 v69, v69
    v_rcp_f32 v70, v70
    v_rcp_f32 v71, v71
    v_rcp_f32 v72, v72
    v_rcp_f32 v73, v73
    v_rcp_f32 v74, v74
    v_rcp_f32 v75, v75
    v_pk_mul_f32 v[176:177], v[176:177], v[184:185]
    v_pk_mul_f32 v[178:179], v[178:179], v[186:187]
    v_pk_mul_f32 v[180:181], v[180:181], v[188:189]
    v_pk_mul_f32 v[182:183], v[182:183], v[190:191]
    v_pk_mul_f32 v[176:177], v[176:177], v[68:69]
    v_pk_mul_f32 v[178:179], v[178:179], v[70:71]
    v_pk_mul_f32 v[180:181], v[180:181], v[72:73]
    v_pk_mul_f32 v[182:183], v[182:183], v[74:75]
    v_cvt_pk_bf16_f32 v76, v176, v177
    v_cvt_pk_bf16_f32 v77, v178, v179
    v_cvt_pk_bf16_f32 v78, v180, v181
    v_cvt_pk_bf16_f32 v79, v182, v183
    s_nop 0
    v_permlane16_swap_b32 v76, v78
    v_permlane16_swap_b32 v77, v79
    s_mov_b32 s38, 221184
    buffer_store_dwordx4 v[76:79], v10, s[52:55], s38 offen sc1
    v_pk_fma_f32 v[192:193], v[24:25], v[60:61], v[192:193] op_sel_hi:[1,0,1]
    v_pk_fma_f32 v[194:195], v[26:27], v[60:61], v[194:195] op_sel_hi:[1,0,1]
    v_pk_fma_f32 v[196:197], v[28:29], v[60:61], v[196:197] op_sel_hi:[1,0,1]
    v_pk_fma_f32 v[198:199], v[30:31], v[60:61], v[198:199] op_sel_hi:[1,0,1]
    v_pk_mul_f32 v[68:69], v[192:193], v[192:193]
    v_pk_mul_f32 v[70:71], v[194:195], v[194:195]
    v_pk_mul_f32 v[72:73], v[196:197], v[196:197]
    v_pk_mul_f32 v[74:75], v[198:199], v[198:199]
    v_pk_fma_f32 v[68:69], v[68:69], v[62:63], v[60:61] op_sel:[0,0,1] op_sel_hi:[1,0,1]
    v_pk_fma_f32 v[70:71], v[70:71], v[62:63], v[60:61] op_sel:[0,0,1] op_sel_hi:[1,0,1]
    v_pk_fma_f32 v[72:73], v[72:73], v[62:63], v[60:61] op_sel:[0,0,1] op_sel_hi:[1,0,1]
    v_pk_fma_f32 v[74:75], v[74:75], v[62:63], v[60:61] op_sel:[0,0,1] op_sel_hi:[1,0,1]
    v_pk_mul_f32 v[68:69], v[68:69], v[192:193]
    v_pk_mul_f32 v[70:71], v[70:71], v[194:195]
    v_pk_mul_f32 v[72:73], v[72:73], v[196:197]
    v_pk_mul_f32 v[74:75], v[74:75], v[198:199]
    v_exp_f32 v68, v68
    v_exp_f32 v69, v69
    v_exp_f32 v70, v70
    v_exp_f32 v71, v71
    v_exp_f32 v72, v72
    v_exp_f32 v73, v73
    v_exp_f32 v74, v74
    v_exp_f32 v75, v75
    v_pk_fma_f32 v[200:201], v[32:33], v[60:61], v[200:201] op_sel_hi:[1,0,1]
    v_pk_fma_f32 v[202:203], v[34:35], v[60:61], v[202:203] op_sel_hi:[1,0,1]
    v_pk_fma_f32 v[204:205], v[36:37], v[60:61], v[204:205] op_sel_hi:[1,0,1]
    v_pk_fma_f32 v[206:207], v[38:39], v[60:61], v[206:207] op_sel_hi:[1,0,1]
    v_pk_fma_f32 v[68:69], v[68:69], v[62:63], v[62:63] op_sel:[0,1,1] op_sel_hi:[1,1,1]
    v_pk_fma_f32 v[70:71], v[70:71], v[62:63], v[62:63] op_sel:[0,1,1] op_sel_hi:[1,1,1]
    v_pk_fma_f32 v[72:73], v[72:73], v[62:63], v[62:63] op_sel:[0,1,1] op_sel_hi:[1,1,1]
    v_pk_fma_f32 v[74:75], v[74:75], v[62:63], v[62:63] op_sel:[0,1,1] op_sel_hi:[1,1,1]
    v_rcp_f32 v68, v68
    v_rcp_f32 v69, v69
    v_rcp_f32 v70, v70
    v_rcp_f32 v71, v71
    v_rcp_f32 v72, v72
    v_rcp_f32 v73, v73
    v_rcp_f32 v74, v74
    v_rcp_f32 v75, v75
    v_pk_mul_f32 v[192:193], v[192:193], v[200:201]
    v_pk_mul_f32 v[194:195], v[194:195], v[202:203]
    v_pk_mul_f32 v[196:197], v[196:197], v[204:205]
    v_pk_mul_f32 v[198:199], v[198:199], v[206:207]
    v_pk_mul_f32 v[192:193], v[192:193], v[68:69]
    v_pk_mul_f32 v[194:195], v[194:195], v[70:71]
    v_pk_mul_f32 v[196:197], v[196:197], v[72:73]
    v_pk_mul_f32 v[198:199], v[198:199], v[74:75]
    v_cvt_pk_bf16_f32 v80, v192, v193
    v_cvt_pk_bf16_f32 v81, v194, v195
    v_cvt_pk_bf16_f32 v82, v196, v197
    v_cvt_pk_bf16_f32 v83, v198, v199
    s_nop 0
    v_permlane16_swap_b32 v80, v82
    v_permlane16_swap_b32 v81, v83
    s_mov_b32 s38, 276480
    buffer_store_dwordx4 v[80:83], v10, s[52:55], s38 offen sc1
    v_pk_fma_f32 v[208:209], v[24:25], v[64:65], v[208:209] op_sel_hi:[1,0,1]
    v_pk_fma_f32 v[210:211], v[26:27], v[64:65], v[210:211] op_sel_hi:[1,0,1]
    v_pk_fma_f32 v[212:213], v[28:29], v[64:65], v[212:213] op_sel_hi:[1,0,1]
    v_pk_fma_f32 v[214:215], v[30:31], v[64:65], v[214:215] op_sel_hi:[1,0,1]
    v_pk_mul_f32 v[68:69], v[208:209], v[208:209]
    v_pk_mul_f32 v[70:71], v[210:211], v[210:211]
    v_pk_mul_f32 v[72:73], v[212:213], v[212:213]
    v_pk_mul_f32 v[74:75], v[214:215], v[214:215]
    v_pk_fma_f32 v[68:69], v[68:69], v[66:67], v[64:65] op_sel:[0,0,1] op_sel_hi:[1,0,1]
    v_pk_fma_f32 v[70:71], v[70:71], v[66:67], v[64:65] op_sel:[0,0,1] op_sel_hi:[1,0,1]
    v_pk_fma_f32 v[72:73], v[72:73], v[66:67], v[64:65] op_sel:[0,0,1] op_sel_hi:[1,0,1]
    v_pk_fma_f32 v[74:75], v[74:75], v[66:67], v[64:65] op_sel:[0,0,1] op_sel_hi:[1,0,1]
    v_pk_mul_f32 v[68:69], v[68:69], v[208:209]
    v_pk_mul_f32 v[70:71], v[70:71], v[210:211]
    v_pk_mul_f32 v[72:73], v[72:73], v[212:213]
    v_pk_mul_f32 v[74:75], v[74:75], v[214:215]
    v_exp_f32 v68, v68
    v_exp_f32 v69, v69
    v_exp_f32 v70, v70
    v_exp_f32 v71, v71
    v_exp_f32 v72, v72
    v_exp_f32 v73, v73
    v_exp_f32 v74, v74
    v_exp_f32 v75, v75
    v_pk_fma_f32 v[216:217], v[32:33], v[64:65], v[216:217] op_sel_hi:[1,0,1]
    v_pk_fma_f32 v[218:219], v[34:35], v[64:65], v[218:219] op_sel_hi:[1,0,1]
    v_pk_fma_f32 v[220:221], v[36:37], v[64:65], v[220:221] op_sel_hi:[1,0,1]
    v_pk_fma_f32 v[222:223], v[38:39], v[64:65], v[222:223] op_sel_hi:[1,0,1]
    v_pk_fma_f32 v[68:69], v[68:69], v[66:67], v[66:67] op_sel:[0,1,1] op_sel_hi:[1,1,1]
    v_pk_fma_f32 v[70:71], v[70:71], v[66:67], v[66:67] op_sel:[0,1,1] op_sel_hi:[1,1,1]
    v_pk_fma_f32 v[72:73], v[72:73], v[66:67], v[66:67] op_sel:[0,1,1] op_sel_hi:[1,1,1]
    v_pk_fma_f32 v[74:75], v[74:75], v[66:67], v[66:67] op_sel:[0,1,1] op_sel_hi:[1,1,1]
    v_rcp_f32 v68, v68
    v_rcp_f32 v69, v69
    v_rcp_f32 v70, v70
    v_rcp_f32 v71, v71
    v_rcp_f32 v72, v72
    v_rcp_f32 v73, v73
    v_rcp_f32 v74, v74
    v_rcp_f32 v75, v75
    v_pk_mul_f32 v[208:209], v[208:209], v[216:217]
    v_pk_mul_f32 v[210:211], v[210:211], v[218:219]
    v_pk_mul_f32 v[212:213], v[212:213], v[220:221]
    v_pk_mul_f32 v[214:215], v[214:215], v[222:223]
    v_pk_mul_f32 v[208:209], v[208:209], v[68:69]
    v_pk_mul_f32 v[210:211], v[210:211], v[70:71]
    v_pk_mul_f32 v[212:213], v[212:213], v[72:73]
    v_pk_mul_f32 v[214:215], v[214:215], v[74:75]
    v_cvt_pk_bf16_f32 v76, v208, v209
    v_cvt_pk_bf16_f32 v77, v210, v211
    v_cvt_pk_bf16_f32 v78, v212, v213
    v_cvt_pk_bf16_f32 v79, v214, v215
    s_nop 0
    v_permlane16_swap_b32 v76, v78
    v_permlane16_swap_b32 v77, v79
    s_mov_b32 s38, 331776
    buffer_store_dwordx4 v[76:79], v10, s[52:55], s38 offen sc1
    s_lshl_b32 s38, s22, 5
    s_add_u32 s38, s38, s31
    s_lshl_b32 s38, s38, 7
    s_add_u32 s38, s38, 262144
    v_mov_b32 v12, 147572
    v_mov_b32 v13, 1
    s_mov_b64 exec, 1
    s_waitcnt vmcnt(0)
    ds_add_rtn_u32 v13, v12, v13
    s_mov_b64 exec, -1
    v_mov_b32 v244, s33
    v_mov_b32 v245, s33
    v_mov_b32 v246, s33
    v_mov_b32 v247, s33
    v_lshlrev_b32 v12, 7, v0
    s_waitcnt lgkmcnt(0)
    v_readfirstlane_b32 s70, v13
    s_nop 0
    s_cmp_lg_u32 s70, 3
    s_cbranch_scc1 notlast_107
    s_mov_b64 exec, 1
    buffer_store_dwordx4 v[244:247], v12, s[44:47], s38 offen sc1
    s_mov_b64 exec, -1
notlast_107:
    s_branch c4_100
csmall_102:
    s_mul_i32 s30, s22, 224
    s_lshl_b32 s34, s31, 7
    s_lshr_b32 s36, s35, 1
    s_and_b32 s37, s35, 1
    v_and_b32 v2, 15, v0
    v_lshrrev_b32 v3, 4, v0
    s_mul_i32 s38, s36, 2048
    v_lshlrev_b32 v16, 4, v0
    v_add_u32 v16, s38, v16
    v_add_u32 v17, 1024, v16
    v_bfe_u32 v8, v0, 2, 3
    v_bfe_u32 v9, v0, 3, 2
    v_lshrrev_b32 v10, 5, v0
    s_lshl_b32 s39, s37, 1
    v_xor_b32 v9, s39, v9
    v_and_b32 v11, 3, v0
    v_lshlrev_b32 v11, 3, v11
    v_lshl_add_u32 v11, v8, 7, v11
    v_lshl_add_u32 v11, v10, 10, v11
    v_add_u32 v11, 40960, v11
    v_lshl_add_u32 v18, v9, 5, v11
    v_xor_b32 v19, 32, v18
    v_add_u32 v20, 49152, v18
    v_add_u32 v21, 49152, v19
    v_and_b32 v8, 1, v3
    v_lshlrev_b32 v8, 5, v8
    v_lshrrev_b32 v9, 1, v3
    v_lshl_add_u32 v8, v9, 4, v8
    s_lshl_b32 s39, s37, 6
    s_add_u32 s39, s39, s34
    v_add_u32 v8, s39, v8
    s_mul_i32 s38, s36, 16
    v_add_u32 v9, s38, v2
    v_add_u32 v10, s30, v9
    v_mul_u32_u24 v10, 3456, v10
    v_add_u32 v10, v10, v8
    v_and_b32 v10, 1, v3
    v_lshlrev_b32 v10, 1, v10
    v_lshrrev_b32 v8, 1, v3
    v_add_u32 v10, v10, v8
    v_lshlrev_b32 v10, 8, v10
    v_lshl_add_u32 v10, v2, 4, v10
    s_lshl_b32 s39, s31, 1
    s_add_u32 s39, s39, s37
    s_lshl_b32 s39, s39, 10
    v_add_u32 v10, s39, v10
    s_add_u32 s39, s30, s38
    s_mul_i32 s39, s39, 3456
    v_add_u32 v10, s39, v10
    s_add_u32 s52, s4, 16777216
    s_addc_u32 s53, s5, 0
    s_mov_b32 s54, 7077888
    s_mov_b32 s55, 0x20000
    v_lshlrev_b32 v8, 4, v3
    s_lshl_b32 s39, s37, 7
    v_add_u32 v8, s39, v8
    v_add_u32 v8, 151808, v8
    v_lshlrev_b32 v11, 4, v9
    v_add_u32 v11, 147712, v11
    s_lshr_b32 s38, s30, 6
    s_add_u32 s39, s30, 31
    s_lshr_b32 s39, s39, 6
    v_lshrrev_b32 v12, 3, v0
    v_add_u32 v12, s38, v12
    v_min_u32 v12, s39, v12
    v_and_b32 v13, 7, v0
    v_lshl_add_u32 v12, v12, 3, v13
    v_lshlrev_b32 v12, 7, v12
    v_add_u32 v12, 196608, v12
    v_bfe_u32 v13, v0, 2, 1
    v_mul_u32_u24 v13, 108, v13
    v_and_b32 v14, 3, v0
    v_add_u32 v13, v13, v14
    s_lshl_b32 s39, s31, 2
    v_add_u32 v13, s39, v13
    v_lshrrev_b32 v14, 3, v0
    v_subrev_u32 v14, 5, v14
    v_lshl_add_u32 v13, v14, 2, v13
    v_lshlrev_b32 v13, 7, v13
    v_add_u32 v13, 229376, v13
    v_cmp_gt_u32 vcc, 40, v0
    s_nop 1
    v_cndmask_b32 v12, v13, v12, vcc
    s_cmp_lg_u32 s35, 0
    s_cbranch_scc1 pd_108
    s_waitcnt vmcnt(0)
    s_mov_b32 s71, 50000
pl_109:
    buffer_load_dwordx4 v[248:251], v12, s[44:47], 0 offen sc1
    s_waitcnt vmcnt(0)
    v_xor_b32 v13, s33, v248
    v_xor_b32 v14, s33, v249
    v_or_b32 v13, v13, v14
    v_xor_b32 v14, s33, v250
    v_or_b32 v13, v13, v14
    v_xor_b32 v14, s33, v251
    v_or_b32 v13, v13, v14
    v_cmp_ne_u32 vcc, 0, v13
    s_nop 0
    s_and_b64 vcc, vcc, exec
    s_cbranch_scc0 pk_110
    s_mov_b64 exec, vcc
    s_sub_u32 s71, s71, 1
    s_cmp_lg_u32 s71, 0
    s_cbranch_scc1 pl_109
pk_110:
    s_mov_b64 exec, -1
pd_108:
    s_barrier
    s_add_u32 s56, s4, 14680064
    s_addc_u32 s57, s5, 0
    s_mov_b32 s58, 131072
    s_mov_b32 s59, 0x20000
    s_add_u32 s60, s4, 15204352
    s_addc_u32 s61, s5, 0
    s_mov_b32 s62, 110592
    s_mov_b32 s63, 0x20000
    s_lshl_b32 s72, s35, 6
    s_add_u32 s72, s72, s30
    v_add_u32 v12, s72, v0
    v_lshlrev_b32 v12, 3, v12
    s_mov_b32 s73, 0
    buffer_load_dwordx2 v[200:201], v12, s[56:59], s73 offen sc1
    s_mov_b32 s73, 16384
    buffer_load_dwordx2 v[202:203], v12, s[56:59], s73 offen sc1
    s_mov_b32 s73, 32768
    buffer_load_dwordx2 v[204:205], v12, s[56:59], s73 offen sc1
    s_mov_b32 s73, 49152
    buffer_load_dwordx2 v[206:207], v12, s[56:59], s73 offen sc1
    s_mov_b32 s73, 65536
    buffer_load_dwordx2 v[208:209], v12, s[56:59], s73 offen sc1
    s_mov_b32 s73, 81920
    buffer_load_dwordx2 v[210:211], v12, s[56:59], s73 offen sc1
    s_mov_b32 s73, 98304
    buffer_load_dwordx2 v[212:213], v12, s[56:59], s73 offen sc1
    s_mov_b32 s73, 114688
    buffer_load_dwordx2 v[214:215], v12, s[56:59], s73 offen sc1
    v_and_b32 v13, 31, v0
    s_and_b32 s72, s35, 1
    s_lshl_b32 s72, s72, 5
    s_lshr_b32 s73, s35, 1
    s_mul_i32 s73, s73, 1728
    s_add_u32 s72, s72, s73
    s_lshl_b32 s73, s31, 6
    s_add_u32 s72, s72, s73
    v_add_u32 v13, s72, v13
    v_lshlrev_b32 v13, 2, v13
    v_lshrrev_b32 v14, 5, v0
    v_mul_u32_u24 v14, 55296, v14
    v_add_u32 v13, v13, v14
    s_mov_b32 s73, 0
    buffer_load_dword v224, v13, s[60:63], s73 offen offset:0 sc1
    s_mov_b32 s73, 13824
    buffer_load_dword v225, v13, s[60:63], s73 offen offset:0 sc1
    s_mov_b32 s73, 27648
    buffer_load_dword v226, v13, s[60:63], s73 offen offset:0 sc1
    s_mov_b32 s73, 41472
    buffer_load_dword v227, v13, s[60:63], s73 offen offset:0 sc1
    s_mov_b32 s73, 0
    buffer_load_dword v228, v13, s[60:63], s73 offen offset:256 sc1
    s_mov_b32 s73, 13824
    buffer_load_dword v229, v13, s[60:63], s73 offen offset:256 sc1
    s_mov_b32 s73, 27648
    buffer_load_dword v230, v13, s[60:63], s73 offen offset:256 sc1
    s_mov_b32 s73, 41472
    buffer_load_dword v231, v13, s[60:63], s73 offen offset:256 sc1
    s_mov_b32 s73, 0
    buffer_load_dword v232, v13, s[60:63], s73 offen offset:512 sc1
    s_mov_b32 s73, 13824
    buffer_load_dword v233, v13, s[60:63], s73 offen offset:512 sc1
    s_mov_b32 s73, 27648
    buffer_load_dword v234, v13, s[60:63], s73 offen offset:512 sc1
    s_mov_b32 s73, 41472
    buffer_load_dword v235, v13, s[60:63], s73 offen offset:512 sc1
    s_waitcnt vmcnt(12)
    v_add_f32 v200, v200, v202
    v_add_f32 v201, v201, v203
    v_add_f32 v200, v200, v204
    v_add_f32 v201, v201, v205
    v_add_f32 v200, v200, v206
    v_add_f32 v201, v201, v207
    v_add_f32 v200, v200, v208
    v_add_f32 v201, v201, v209
    v_add_f32 v200, v200, v210
    v_add_f32 v201, v201, v211
    v_add_f32 v200, v200, v212
    v_add_f32 v201, v201, v213
    v_add_f32 v200, v200, v214
    v_add_f32 v201, v201, v215
    v_mul_f32 v200, 3133983949, v200
    v_mul_f32 v201, 986500301, v201
    v_fma_f32 v201, -v200, v200, v201
    v_max_f32 v201, 0, v201
    v_add_f32 v203, 925353388, v201
    v_rsq_f32 v204, v203
    s_nop 0
    v_mul_f32 v201, 3222493025, v204
    v_mul_f32 v202, v204, v204
    v_mul_f32 v202, v202, v204
    v_mul_f32 v202, 3184710632, v202
    s_lshl_b32 s72, s35, 10
    v_lshlrev_b32 v12, 4, v0
    v_add_u32 v12, s72, v12
    v_add_u32 v12, 147712, v12
    ds_write_b128 v12, v[200:203]
    s_waitcnt vmcnt(0)
    v_and_b32 v13, 31, v0
    v_lshlrev_b32 v13, 2, v13
    s_lshl_b32 s72, s35, 7
    v_add_u32 v13, s72, v13
    v_add_u32 v13, 151808, v13
    v_add_f32 v224, v224, v225
    v_add_f32 v224, v224, v226
    v_add_f32 v224, v224, v227
    v_mov_b32 v225, v224
    s_nop 1
    v_permlane32_swap_b32 v224, v225
    v_add_f32 v224, v224, v225
    ds_write_b32 v13, v224 offset:0
    v_add_f32 v228, v228, v229
    v_add_f32 v228, v228, v230
    v_add_f32 v228, v228, v231
    v_mov_b32 v229, v228
    s_nop 1
    v_permlane32_swap_b32 v228, v229
    v_add_f32 v228, v228, v229
    ds_write_b32 v13, v228 offset:512
    v_add_f32 v232, v232, v233
    v_add_f32 v232, v232, v234
    v_add_f32 v232, v232, v235
    v_mov_b32 v233, v232
    s_nop 1
    v_permlane32_swap_b32 v232, v233
    v_add_f32 v232, v232, v233
    ds_write_b32 v13, v232 offset:1024
    s_waitcnt lgkmcnt(0)
    s_barrier
    ds_read_b64_tr_b16 v[28:29], v18 offset:0
    ds_read_b64_tr_b16 v[30:31], v18 offset:2048
    ds_read_b64_tr_b16 v[32:33], v19 offset:0
    ds_read_b64_tr_b16 v[34:35], v19 offset:2048
    ds_read_b64_tr_b16 v[36:37], v18 offset:8192
    ds_read_b64_tr_b16 v[38:39], v18 offset:10240
    ds_read_b64_tr_b16 v[40:41], v19 offset:8192
    ds_read_b64_tr_b16 v[42:43], v19 offset:10240
    ds_read_b128 v[24:27], v16 offset:0
    s_waitcnt lgkmcnt(0)
    ds_read_b64_tr_b16 v[48:49], v18 offset:4096
    ds_read_b64_tr_b16 v[50:51], v18 offset:6144
    ds_read_b64_tr_b16 v[52:53], v19 offset:4096
    ds_read_b64_tr_b16 v[54:55], v19 offset:6144
    ds_read_b64_tr_b16 v[56:57], v18 offset:12288
    v_mfma_f32_16x16x32_bf16 v[64:67], v[28:31], v[24:27], 0
    ds_read_b64_tr_b16 v[58:59], v18 offset:14336
    ds_read_b64_tr_b16 v[60:61], v19 offset:12288
    ds_read_b64_tr_b16 v[62:63], v19 offset:14336
    ds_read_b128 v[44:47], v17 offset:0
    v_mfma_f32_16x16x32_bf16 v[68:71], v[32:35], v[24:27], 0
    s_waitcnt lgkmcnt(0)
    s_barrier
    v_mfma_f32_16x16x32_bf16 v[72:75], v[36:39], v[24:27], 0
    v_mfma_f32_16x16x32_bf16 v[76:79], v[40:43], v[24:27], 0
    ds_read_b64_tr_b16 v[28:29], v18 offset:16384
    ds_read_b64_tr_b16 v[30:31], v18 offset:18432
    ds_read_b64_tr_b16 v[32:33], v19 offset:16384
    ds_read_b64_tr_b16 v[34:35], v19 offset:18432
    ds_read_b64_tr_b16 v[36:37], v18 offset:24576
    v_mfma_f32_16x16x32_bf16 v[64:67], v[48:51], v[44:47], v[64:67]
    ds_read_b64_tr_b16 v[38:39], v18 offset:26624
    ds_read_b64_tr_b16 v[40:41], v19 offset:24576
    ds_read_b64_tr_b16 v[42:43], v19 offset:26624
    ds_read_b128 v[24:27], v16 offset:4096
    v_mfma_f32_16x16x32_bf16 v[68:71], v[52:55], v[44:47], v[68:71]
    v_mfma_f32_16x16x32_bf16 v[72:75], v[56:59], v[44:47], v[72:75]
    v_mfma_f32_16x16x32_bf16 v[76:79], v[60:63], v[44:47], v[76:79]
    s_waitcnt lgkmcnt(0)
    ds_read_b64_tr_b16 v[48:49], v18 offset:20480
    ds_read_b64_tr_b16 v[50:51], v18 offset:22528
    ds_read_b64_tr_b16 v[52:53], v19 offset:20480
    ds_read_b64_tr_b16 v[54:55], v19 offset:22528
    ds_read_b64_tr_b16 v[56:57], v18 offset:28672
    v_mfma_f32_16x16x32_bf16 v[64:67], v[28:31], v[24:27], v[64:67]
    ds_read_b64_tr_b16 v[58:59], v18 offset:30720
    ds_read_b64_tr_b16 v[60:61], v19 offset:28672
    ds_read_b64_tr_b16 v[62:63], v19 offset:30720
    ds_read_b128 v[44:47], v17 offset:4096
    v_mfma_f32_16x16x32_bf16 v[68:71], v[32:35], v[24:27], v[68:71]
    s_waitcnt lgkmcnt(0)
    s_barrier
    v_mfma_f32_16x16x32_bf16 v[72:75], v[36:39], v[24:27], v[72:75]
    v_mfma_f32_16x16x32_bf16 v[76:79], v[40:43], v[24:27], v[76:79]
    ds_read_b64_tr_b16 v[28:29], v18 offset:32768
    ds_read_b64_tr_b16 v[30:31], v18 offset:34816
    ds_read_b64_tr_b16 v[32:33], v19 offset:32768
    ds_read_b64_tr_b16 v[34:35], v19 offset:34816
    ds_read_b64_tr_b16 v[36:37], v18 offset:40960
    v_mfma_f32_16x16x32_bf16 v[64:67], v[48:51], v[44:47], v[64:67]
    ds_read_b64_tr_b16 v[38:39], v18 offset:43008
    ds_read_b64_tr_b16 v[40:41], v19 offset:40960
    ds_read_b64_tr_b16 v[42:43], v19 offset:43008
    ds_read_b128 v[24:27], v16 offset:8192
    v_mfma_f32_16x16x32_bf16 v[68:71], v[52:55], v[44:47], v[68:71]
    v_mfma_f32_16x16x32_bf16 v[72:75], v[56:59], v[44:47], v[72:75]
    v_mfma_f32_16x16x32_bf16 v[76:79], v[60:63], v[44:47], v[76:79]
    s_waitcnt lgkmcnt(0)
    ds_read_b64_tr_b16 v[48:49], v18 offset:36864
    ds_read_b64_tr_b16 v[50:51], v18 offset:38912
    ds_read_b64_tr_b16 v[52:53], v19 offset:36864
    ds_read_b64_tr_b16 v[54:55], v19 offset:38912
    ds_read_b64_tr_b16 v[56:57], v18 offset:45056
    v_mfma_f32_16x16x32_bf16 v[64:67], v[28:31], v[24:27], v[64:67]
    ds_read_b64_tr_b16 v[58:59], v18 offset:47104
    ds_read_b64_tr_b16 v[60:61], v19 offset:45056
    ds_read_b64_tr_b16 v[62:63], v19 offset:47104
    ds_read_b128 v[44:47], v17 offset:8192
    v_mfma_f32_16x16x32_bf16 v[68:71], v[32:35], v[24:27], v[68:71]
    s_waitcnt lgkmcnt(0)
    s_barrier
    v_mfma_f32_16x16x32_bf16 v[72:75], v[36:39], v[24:27], v[72:75]
    v_mfma_f32_16x16x32_bf16 v[76:79], v[40:43], v[24:27], v[76:79]
    ds_read_b64_tr_b16 v[28:29], v20 offset:0
    ds_read_b64_tr_b16 v[30:31], v20 offset:2048
    ds_read_b64_tr_b16 v[32:33], v21 offset:0
    ds_read_b64_tr_b16 v[34:35], v21 offset:2048
    ds_read_b64_tr_b16 v[36:37], v20 offset:8192
    v_mfma_f32_16x16x32_bf16 v[64:67], v[48:51], v[44:47], v[64:67]
    ds_read_b64_tr_b16 v[38:39], v20 offset:10240
    ds_read_b64_tr_b16 v[40:41], v21 offset:8192
    ds_read_b64_tr_b16 v[42:43], v21 offset:10240
    ds_read_b128 v[24:27], v16 offset:12288
    v_mfma_f32_16x16x32_bf16 v[68:71], v[52:55], v[44:47], v[68:71]
    v_mfma_f32_16x16x32_bf16 v[72:75], v[56:59], v[44:47], v[72:75]
    v_mfma_f32_16x16x32_bf16 v[76:79], v[60:63], v[44:47], v[76:79]
    s_waitcnt lgkmcnt(0)
    ds_read_b64_tr_b16 v[48:49], v20 offset:4096
    ds_read_b64_tr_b16 v[50:51], v20 offset:6144
    ds_read_b64_tr_b16 v[52:53], v21 offset:4096
    ds_read_b64_tr_b16 v[54:55], v21 offset:6144
    ds_read_b64_tr_b16 v[56:57], v20 offset:12288
    v_mfma_f32_16x16x32_bf16 v[64:67], v[28:31], v[24:27], v[64:67]
    ds_read_b64_tr_b16 v[58:59], v20 offset:14336
    ds_read_b64_tr_b16 v[60:61], v21 offset:12288
    ds_read_b64_tr_b16 v[62:63], v21 offset:14336
    ds_read_b128 v[44:47], v17 offset:12288
    v_mfma_f32_16x16x32_bf16 v[68:71], v[32:35], v[24:27], v[68:71]
    s_waitcnt lgkmcnt(0)
    s_barrier
    v_mfma_f32_16x16x32_bf16 v[72:75], v[36:39], v[24:27], v[72:75]
    v_mfma_f32_16x16x32_bf16 v[76:79], v[40:43], v[24:27], v[76:79]
    ds_read_b64_tr_b16 v[28:29], v20 offset:16384
    ds_read_b64_tr_b16 v[30:31], v20 offset:18432
    ds_read_b64_tr_b16 v[32:33], v21 offset:16384
    ds_read_b64_tr_b16 v[34:35], v21 offset:18432
    ds_read_b64_tr_b16 v[36:37], v20 offset:24576
    v_mfma_f32_16x16x32_bf16 v[64:67], v[48:51], v[44:47], v[64:67]
    ds_read_b64_tr_b16 v[38:39], v20 offset:26624
    ds_read_b64_tr_b16 v[40:41], v21 offset:24576
    ds_read_b64_tr_b16 v[42:43], v21 offset:26624
    ds_read_b128 v[24:27], v16 offset:16384
    v_mfma_f32_16x16x32_bf16 v[68:71], v[52:55], v[44:47], v[68:71]
    v_mfma_f32_16x16x32_bf16 v[72:75], v[56:59], v[44:47], v[72:75]
    v_mfma_f32_16x16x32_bf16 v[76:79], v[60:63], v[44:47], v[76:79]
    s_waitcnt lgkmcnt(0)
    ds_read_b64_tr_b16 v[48:49], v20 offset:20480
    ds_read_b64_tr_b16 v[50:51], v20 offset:22528
    ds_read_b64_tr_b16 v[52:53], v21 offset:20480
    ds_read_b64_tr_b16 v[54:55], v21 offset:22528
    ds_read_b64_tr_b16 v[56:57], v20 offset:28672
    v_mfma_f32_16x16x32_bf16 v[64:67], v[28:31], v[24:27], v[64:67]
    ds_read_b64_tr_b16 v[58:59], v20 offset:30720
    ds_read_b64_tr_b16 v[60:61], v21 offset:28672
    ds_read_b64_tr_b16 v[62:63], v21 offset:30720
    ds_read_b128 v[44:47], v17 offset:16384
    v_mfma_f32_16x16x32_bf16 v[68:71], v[32:35], v[24:27], v[68:71]
    s_waitcnt lgkmcnt(0)
    s_barrier
    v_mfma_f32_16x16x32_bf16 v[72:75], v[36:39], v[24:27], v[72:75]
    v_mfma_f32_16x16x32_bf16 v[76:79], v[40:43], v[24:27], v[76:79]
    ds_read_b64_tr_b16 v[28:29], v20 offset:32768
    ds_read_b64_tr_b16 v[30:31], v20 offset:34816
    ds_read_b64_tr_b16 v[32:33], v21 offset:32768
    ds_read_b64_tr_b16 v[34:35], v21 offset:34816
    ds_read_b64_tr_b16 v[36:37], v20 offset:40960
    v_mfma_f32_16x16x32_bf16 v[64:67], v[48:51], v[44:47], v[64:67]
    ds_read_b64_tr_b16 v[38:39], v20 offset:43008
    ds_read_b64_tr_b16 v[40:41], v21 offset:40960
    ds_read_b64_tr_b16 v[42:43], v21 offset:43008
    ds_read_b128 v[24:27], v16 offset:20480
    v_mfma_f32_16x16x32_bf16 v[68:71], v[52:55], v[44:47], v[68:71]
    v_mfma_f32_16x16x32_bf16 v[72:75], v[56:59], v[44:47], v[72:75]
    v_mfma_f32_16x16x32_bf16 v[76:79], v[60:63], v[44:47], v[76:79]
    s_waitcnt lgkmcnt(0)
    ds_read_b64_tr_b16 v[48:49], v20 offset:36864
    ds_read_b64_tr_b16 v[50:51], v20 offset:38912
    ds_read_b64_tr_b16 v[52:53], v21 offset:36864
    ds_read_b64_tr_b16 v[54:55], v21 offset:38912
    ds_read_b64_tr_b16 v[56:57], v20 offset:45056
    v_mfma_f32_16x16x32_bf16 v[64:67], v[28:31], v[24:27], v[64:67]
    ds_read_b64_tr_b16 v[58:59], v20 offset:47104
    ds_read_b64_tr_b16 v[60:61], v21 offset:45056
    ds_read_b64_tr_b16 v[62:63], v21 offset:47104
    ds_read_b128 v[44:47], v17 offset:20480
    v_mfma_f32_16x16x32_bf16 v[68:71], v[32:35], v[24:27], v[68:71]
    s_waitcnt lgkmcnt(0)
    s_barrier
    v_mfma_f32_16x16x32_bf16 v[72:75], v[36:39], v[24:27], v[72:75]
    v_mfma_f32_16x16x32_bf16 v[76:79], v[40:43], v[24:27], v[76:79]
    ds_read_b64_tr_b16 v[28:29], v18 offset:0
    ds_read_b64_tr_b16 v[30:31], v18 offset:2048
    ds_read_b64_tr_b16 v[32:33], v19 offset:0
    ds_read_b64_tr_b16 v[34:35], v19 offset:2048
    ds_read_b64_tr_b16 v[36:37], v18 offset:8192
    v_mfma_f32_16x16x32_bf16 v[64:67], v[48:51], v[44:47], v[64:67]
    ds_read_b64_tr_b16 v[38:39], v18 offset:10240
    ds_read_b64_tr_b16 v[40:41], v19 offset:8192
    ds_read_b64_tr_b16 v[42:43], v19 offset:10240
    ds_read_b128 v[24:27], v16 offset:24576
    v_mfma_f32_16x16x32_bf16 v[68:71], v[52:55], v[44:47], v[68:71]
    v_mfma_f32_16x16x32_bf16 v[72:75], v[56:59], v[44:47], v[72:75]
    v_mfma_f32_16x16x32_bf16 v[76:79], v[60:63], v[44:47], v[76:79]
    s_waitcnt lgkmcnt(0)
    ds_read_b64_tr_b16 v[48:49], v18 offset:4096
    ds_read_b64_tr_b16 v[50:51], v18 offset:6144
    ds_read_b64_tr_b16 v[52:53], v19 offset:4096
    ds_read_b64_tr_b16 v[54:55], v19 offset:6144
    ds_read_b64_tr_b16 v[56:57], v18 offset:12288
    v_mfma_f32_16x16x32_bf16 v[64:67], v[28:31], v[24:27], v[64:67]
    ds_read_b64_tr_b16 v[58:59], v18 offset:14336
    ds_read_b64_tr_b16 v[60:61], v19 offset:12288
    ds_read_b64_tr_b16 v[62:63], v19 offset:14336
    ds_read_b128 v[44:47], v17 offset:24576
    v_mfma_f32_16x16x32_bf16 v[68:71], v[32:35], v[24:27], v[68:71]
    s_waitcnt lgkmcnt(0)
    s_barrier
    v_mfma_f32_16x16x32_bf16 v[72:75], v[36:39], v[24:27], v[72:75]
    v_mfma_f32_16x16x32_bf16 v[76:79], v[40:43], v[24:27], v[76:79]
    ds_read_b64_tr_b16 v[28:29], v18 offset:16384
    ds_read_b64_tr_b16 v[30:31], v18 offset:18432
    ds_read_b64_tr_b16 v[32:33], v19 offset:16384
    ds_read_b64_tr_b16 v[34:35], v19 offset:18432
    ds_read_b64_tr_b16 v[36:37], v18 offset:24576
    v_mfma_f32_16x16x32_bf16 v[64:67], v[48:51], v[44:47], v[64:67]
    ds_read_b64_tr_b16 v[38:39], v18 offset:26624
    ds_read_b64_tr_b16 v[40:41], v19 offset:24576
    ds_read_b64_tr_b16 v[42:43], v19 offset:26624
    ds_read_b128 v[24:27], v16 offset:28672
    v_mfma_f32_16x16x32_bf16 v[68:71], v[52:55], v[44:47], v[68:71]
    v_mfma_f32_16x16x32_bf16 v[72:75], v[56:59], v[44:47], v[72:75]
    v_mfma_f32_16x16x32_bf16 v[76:79], v[60:63], v[44:47], v[76:79]
    s_waitcnt lgkmcnt(0)
    ds_read_b64_tr_b16 v[48:49], v18 offset:20480
    ds_read_b64_tr_b16 v[50:51], v18 offset:22528
    ds_read_b64_tr_b16 v[52:53], v19 offset:20480
    ds_read_b64_tr_b16 v[54:55], v19 offset:22528
    ds_read_b64_tr_b16 v[56:57], v18 offset:28672
    v_mfma_f32_16x16x32_bf16 v[64:67], v[28:31], v[24:27], v[64:67]
    ds_read_b64_tr_b16 v[58:59], v18 offset:30720
    ds_read_b64_tr_b16 v[60:61], v19 offset:28672
    ds_read_b64_tr_b16 v[62:63], v19 offset:30720
    ds_read_b128 v[44:47], v17 offset:28672
    v_mfma_f32_16x16x32_bf16 v[68:71], v[32:35], v[24:27], v[68:71]
    s_waitcnt lgkmcnt(0)
    s_barrier
    v_mfma_f32_16x16x32_bf16 v[72:75], v[36:39], v[24:27], v[72:75]
    v_mfma_f32_16x16x32_bf16 v[76:79], v[40:43], v[24:27], v[76:79]
    ds_read_b64_tr_b16 v[28:29], v18 offset:32768
    ds_read_b64_tr_b16 v[30:31], v18 offset:34816
    ds_read_b64_tr_b16 v[32:33], v19 offset:32768
    ds_read_b64_tr_b16 v[34:35], v19 offset:34816
    ds_read_b64_tr_b16 v[36:37], v18 offset:40960
    v_mfma_f32_16x16x32_bf16 v[64:67], v[48:51], v[44:47], v[64:67]
    ds_read_b64_tr_b16 v[38:39], v18 offset:43008
    ds_read_b64_tr_b16 v[40:41], v19 offset:40960
    ds_read_b64_tr_b16 v[42:43], v19 offset:43008
    ds_read_b128 v[24:27], v16 offset:32768
    v_mfma_f32_16x16x32_bf16 v[68:71], v[52:55], v[44:47], v[68:71]
    v_mfma_f32_16x16x32_bf16 v[72:75], v[56:59], v[44:47], v[72:75]
    v_mfma_f32_16x16x32_bf16 v[76:79], v[60:63], v[44:47], v[76:79]
    s_waitcnt lgkmcnt(0)
    ds_read_b64_tr_b16 v[48:49], v18 offset:36864
    ds_read_b64_tr_b16 v[50:51], v18 offset:38912
    ds_read_b64_tr_b16 v[52:53], v19 offset:36864
    ds_read_b64_tr_b16 v[54:55], v19 offset:38912
    ds_read_b64_tr_b16 v[56:57], v18 offset:45056
    v_mfma_f32_16x16x32_bf16 v[64:67], v[28:31], v[24:27], v[64:67]
    ds_read_b64_tr_b16 v[58:59], v18 offset:47104
    ds_read_b64_tr_b16 v[60:61], v19 offset:45056
    ds_read_b64_tr_b16 v[62:63], v19 offset:47104
    ds_read_b128 v[44:47], v17 offset:32768
    v_mfma_f32_16x16x32_bf16 v[68:71], v[32:35], v[24:27], v[68:71]
    s_waitcnt lgkmcnt(0)
    s_barrier
    v_mfma_f32_16x16x32_bf16 v[72:75], v[36:39], v[24:27], v[72:75]
    v_mfma_f32_16x16x32_bf16 v[76:79], v[40:43], v[24:27], v[76:79]
    ds_read_b64_tr_b16 v[28:29], v20 offset:0
    ds_read_b64_tr_b16 v[30:31], v20 offset:2048
    ds_read_b64_tr_b16 v[32:33], v21 offset:0
    ds_read_b64_tr_b16 v[34:35], v21 offset:2048
    ds_read_b64_tr_b16 v[36:37], v20 offset:8192
    v_mfma_f32_16x16x32_bf16 v[64:67], v[48:51], v[44:47], v[64:67]
    ds_read_b64_tr_b16 v[38:39], v20 offset:10240
    ds_read_b64_tr_b16 v[40:41], v21 offset:8192
    ds_read_b64_tr_b16 v[42:43], v21 offset:10240
    ds_read_b128 v[24:27], v16 offset:36864
    v_mfma_f32_16x16x32_bf16 v[68:71], v[52:55], v[44:47], v[68:71]
    v_mfma_f32_16x16x32_bf16 v[72:75], v[56:59], v[44:47], v[72:75]
    v_mfma_f32_16x16x32_bf16 v[76:79], v[60:63], v[44:47], v[76:79]
    s_waitcnt lgkmcnt(0)
    ds_read_b64_tr_b16 v[48:49], v20 offset:4096
    ds_read_b64_tr_b16 v[50:51], v20 offset:6144
    ds_read_b64_tr_b16 v[52:53], v21 offset:4096
    ds_read_b64_tr_b16 v[54:55], v21 offset:6144
    ds_read_b64_tr_b16 v[56:57], v20 offset:12288
    v_mfma_f32_16x16x32_bf16 v[64:67], v[28:31], v[24:27], v[64:67]
    ds_read_b64_tr_b16 v[58:59], v20 offset:14336
    ds_read_b64_tr_b16 v[60:61], v21 offset:12288
    ds_read_b64_tr_b16 v[62:63], v21 offset:14336
    ds_read_b128 v[44:47], v17 offset:36864
    v_mfma_f32_16x16x32_bf16 v[68:71], v[32:35], v[24:27], v[68:71]
    s_waitcnt lgkmcnt(0)
    s_barrier
    v_mfma_f32_16x16x32_bf16 v[72:75], v[36:39], v[24:27], v[72:75]
    v_mfma_f32_16x16x32_bf16 v[76:79], v[40:43], v[24:27], v[76:79]
    ds_read_b128 v[100:103], v8 offset:0
    ds_read_b128 v[104:107], v8 offset:64
    ds_read_b128 v[108:111], v8 offset:256
    v_mfma_f32_16x16x32_bf16 v[64:67], v[48:51], v[44:47], v[64:67]
    ds_read_b128 v[112:115], v8 offset:320
    ds_read_b128 v[116:119], v11 offset:0
    v_mfma_f32_16x16x32_bf16 v[68:71], v[52:55], v[44:47], v[68:71]
    v_mfma_f32_16x16x32_bf16 v[72:75], v[56:59], v[44:47], v[72:75]
    v_mfma_f32_16x16x32_bf16 v[76:79], v[60:63], v[44:47], v[76:79]
    s_waitcnt lgkmcnt(0)
    s_nop 1
    v_pk_fma_f32 v[64:65], v[100:101], v[116:117], v[64:65] op_sel_hi:[1,0,1]
    v_pk_fma_f32 v[66:67], v[102:103], v[116:117], v[66:67] op_sel_hi:[1,0,1]
    s_nop 0
    v_pk_fma_f32 v[68:69], v[104:105], v[116:117], v[68:69] op_sel_hi:[1,0,1]
    v_pk_fma_f32 v[70:71], v[106:107], v[116:117], v[70:71] op_sel_hi:[1,0,1]
    v_pk_mul_f32 v[140:141], v[64:65], v[64:65]
    v_pk_mul_f32 v[142:143], v[66:67], v[66:67]
    v_pk_mul_f32 v[144:145], v[68:69], v[68:69]
    v_pk_mul_f32 v[146:147], v[70:71], v[70:71]
    v_pk_fma_f32 v[140:141], v[140:141], v[118:119], v[116:117] op_sel:[0,0,1] op_sel_hi:[1,0,1]
    v_pk_fma_f32 v[142:143], v[142:143], v[118:119], v[116:117] op_sel:[0,0,1] op_sel_hi:[1,0,1]
    v_pk_fma_f32 v[144:145], v[144:145], v[118:119], v[116:117] op_sel:[0,0,1] op_sel_hi:[1,0,1]
    v_pk_fma_f32 v[146:147], v[146:147], v[118:119], v[116:117] op_sel:[0,0,1] op_sel_hi:[1,0,1]
    v_pk_mul_f32 v[140:141], v[140:141], v[64:65]
    v_pk_mul_f32 v[142:143], v[142:143], v[66:67]
    v_pk_mul_f32 v[144:145], v[144:145], v[68:69]
    v_pk_mul_f32 v[146:147], v[146:147], v[70:71]
    v_exp_f32 v140, v140
    v_exp_f32 v141, v141
    v_exp_f32 v142, v142
    v_exp_f32 v143, v143
    v_exp_f32 v144, v144
    v_exp_f32 v145, v145
    v_exp_f32 v146, v146
    v_exp_f32 v147, v147
    v_pk_fma_f32 v[72:73], v[108:109], v[116:117], v[72:73] op_sel_hi:[1,0,1]
    v_pk_fma_f32 v[74:75], v[110:111], v[116:117], v[74:75] op_sel_hi:[1,0,1]
    v_pk_fma_f32 v[76:77], v[112:113], v[116:117], v[76:77] op_sel_hi:[1,0,1]
    v_pk_fma_f32 v[78:79], v[114:115], v[116:117], v[78:79] op_sel_hi:[1,0,1]
    v_pk_fma_f32 v[140:141], v[140:141], v[118:119], v[118:119] op_sel:[0,1,1] op_sel_hi:[1,1,1]
    v_pk_fma_f32 v[142:143], v[142:143], v[118:119], v[118:119] op_sel:[0,1,1] op_sel_hi:[1,1,1]
    v_pk_fma_f32 v[144:145], v[144:145], v[118:119], v[118:119] op_sel:[0,1,1] op_sel_hi:[1,1,1]
    v_pk_fma_f32 v[146:147], v[146:147], v[118:119], v[118:119] op_sel:[0,1,1] op_sel_hi:[1,1,1]
    v_rcp_f32 v140, v140
    v_rcp_f32 v141, v141
    v_rcp_f32 v142, v142
    v_rcp_f32 v143, v143
    v_rcp_f32 v144, v144
    v_rcp_f32 v145, v145
    v_rcp_f32 v146, v146
    v_rcp_f32 v147, v147
    v_pk_mul_f32 v[64:65], v[64:65], v[72:73]
    v_pk_mul_f32 v[66:67], v[66:67], v[74:75]
    v_pk_mul_f32 v[68:69], v[68:69], v[76:77]
    v_pk_mul_f32 v[70:71], v[70:71], v[78:79]
    v_pk_mul_f32 v[64:65], v[64:65], v[140:141]
    v_pk_mul_f32 v[66:67], v[66:67], v[142:143]
    v_pk_mul_f32 v[68:69], v[68:69], v[144:145]
    v_pk_mul_f32 v[70:71], v[70:71], v[146:147]
    v_cvt_pk_bf16_f32 v148, v64, v65
    v_cvt_pk_bf16_f32 v149, v66, v67
    v_cvt_pk_bf16_f32 v150, v68, v69
    v_cvt_pk_bf16_f32 v151, v70, v71
    s_nop 0
    v_permlane16_swap_b32 v148, v150
    v_permlane16_swap_b32 v149, v151
    s_mov_b32 s38, 0
    buffer_store_dwordx4 v[148:151], v10, s[52:55], s38 offen sc1
    ds_read_b64_tr_b16 v[28:29], v20 offset:16384
    ds_read_b64_tr_b16 v[30:31], v20 offset:18432
    ds_read_b64_tr_b16 v[32:33], v21 offset:16384
    ds_read_b64_tr_b16 v[34:35], v21 offset:18432
    ds_read_b64_tr_b16 v[36:37], v20 offset:24576
    ds_read_b64_tr_b16 v[38:39], v20 offset:26624
    ds_read_b64_tr_b16 v[40:41], v21 offset:24576
    ds_read_b64_tr_b16 v[42:43], v21 offset:26624
    ds_read_b128 v[24:27], v16 offset:0
    s_waitcnt lgkmcnt(0)
    ds_read_b64_tr_b16 v[48:49], v20 offset:20480
    ds_read_b64_tr_b16 v[50:51], v20 offset:22528
    ds_read_b64_tr_b16 v[52:53], v21 offset:20480
    ds_read_b64_tr_b16 v[54:55], v21 offset:22528
    ds_read_b64_tr_b16 v[56:57], v20 offset:28672
    v_mfma_f32_16x16x32_bf16 v[64:67], v[28:31], v[24:27], 0
    ds_read_b64_tr_b16 v[58:59], v20 offset:30720
    ds_read_b64_tr_b16 v[60:61], v21 offset:28672
    ds_read_b64_tr_b16 v[62:63], v21 offset:30720
    ds_read_b128 v[44:47], v17 offset:0
    v_mfma_f32_16x16x32_bf16 v[68:71], v[32:35], v[24:27], 0
    s_waitcnt lgkmcnt(0)
    s_barrier
    v_mfma_f32_16x16x32_bf16 v[72:75], v[36:39], v[24:27], 0
    v_mfma_f32_16x16x32_bf16 v[76:79], v[40:43], v[24:27], 0
    ds_read_b64_tr_b16 v[28:29], v20 offset:32768
    ds_read_b64_tr_b16 v[30:31], v20 offset:34816
    ds_read_b64_tr_b16 v[32:33], v21 offset:32768
    ds_read_b64_tr_b16 v[34:35], v21 offset:34816
    ds_read_b64_tr_b16 v[36:37], v20 offset:40960
    v_mfma_f32_16x16x32_bf16 v[64:67], v[48:51], v[44:47], v[64:67]
    ds_read_b64_tr_b16 v[38:39], v20 offset:43008
    ds_read_b64_tr_b16 v[40:41], v21 offset:40960
    ds_read_b64_tr_b16 v[42:43], v21 offset:43008
    ds_read_b128 v[24:27], v16 offset:4096
    v_mfma_f32_16x16x32_bf16 v[68:71], v[52:55], v[44:47], v[68:71]
    v_mfma_f32_16x16x32_bf16 v[72:75], v[56:59], v[44:47], v[72:75]
    v_mfma_f32_16x16x32_bf16 v[76:79], v[60:63], v[44:47], v[76:79]
    s_waitcnt lgkmcnt(0)
    ds_read_b64_tr_b16 v[48:49], v20 offset:36864
    ds_read_b64_tr_b16 v[50:51], v20 offset:38912
    ds_read_b64_tr_b16 v[52:53], v21 offset:36864
    ds_read_b64_tr_b16 v[54:55], v21 offset:38912
    ds_read_b64_tr_b16 v[56:57], v20 offset:45056
    v_mfma_f32_16x16x32_bf16 v[64:67], v[28:31], v[24:27], v[64:67]
    ds_read_b64_tr_b16 v[58:59], v20 offset:47104
    ds_read_b64_tr_b16 v[60:61], v21 offset:45056
    ds_read_b64_tr_b16 v[62:63], v21 offset:47104
    ds_read_b128 v[44:47], v17 offset:4096
    v_mfma_f32_16x16x32_bf16 v[68:71], v[32:35], v[24:27], v[68:71]
    s_waitcnt lgkmcnt(0)
    s_barrier
    v_mfma_f32_16x16x32_bf16 v[72:75], v[36:39], v[24:27], v[72:75]
    v_mfma_f32_16x16x32_bf16 v[76:79], v[40:43], v[24:27], v[76:79]
    ds_read_b64_tr_b16 v[28:29], v18 offset:0
    ds_read_b64_tr_b16 v[30:31], v18 offset:2048
    ds_read_b64_tr_b16 v[32:33], v19 offset:0
    ds_read_b64_tr_b16 v[34:35], v19 offset:2048
    ds_read_b64_tr_b16 v[36:37], v18 offset:8192
    v_mfma_f32_16x16x32_bf16 v[64:67], v[48:51], v[44:47], v[64:67]
    ds_read_b64_tr_b16 v[38:39], v18 offset:10240
    ds_read_b64_tr_b16 v[40:41], v19 offset:8192
    ds_read_b64_tr_b16 v[42:43], v19 offset:10240
    ds_read_b128 v[24:27], v16 offset:8192
    v_mfma_f32_16x16x32_bf16 v[68:71], v[52:55], v[44:47], v[68:71]
    v_mfma_f32_16x16x32_bf16 v[72:75], v[56:59], v[44:47], v[72:75]
    v_mfma_f32_16x16x32_bf16 v[76:79], v[60:63], v[44:47], v[76:79]
    s_waitcnt lgkmcnt(0)
    ds_read_b64_tr_b16 v[48:49], v18 offset:4096
    ds_read_b64_tr_b16 v[50:51], v18 offset:6144
    ds_read_b64_tr_b16 v[52:53], v19 offset:4096
    ds_read_b64_tr_b16 v[54:55], v19 offset:6144
    ds_read_b64_tr_b16 v[56:57], v18 offset:12288
    v_mfma_f32_16x16x32_bf16 v[64:67], v[28:31], v[24:27], v[64:67]
    ds_read_b64_tr_b16 v[58:59], v18 offset:14336
    ds_read_b64_tr_b16 v[60:61], v19 offset:12288
    ds_read_b64_tr_b16 v[62:63], v19 offset:14336
    ds_read_b128 v[44:47], v17 offset:8192
    v_mfma_f32_16x16x32_bf16 v[68:71], v[32:35], v[24:27], v[68:71]
    s_waitcnt lgkmcnt(0)
    s_barrier
    v_mfma_f32_16x16x32_bf16 v[72:75], v[36:39], v[24:27], v[72:75]
    v_mfma_f32_16x16x32_bf16 v[76:79], v[40:43], v[24:27], v[76:79]
    ds_read_b64_tr_b16 v[28:29], v18 offset:16384
    ds_read_b64_tr_b16 v[30:31], v18 offset:18432
    ds_read_b64_tr_b16 v[32:33], v19 offset:16384
    ds_read_b64_tr_b16 v[34:35], v19 offset:18432
    ds_read_b64_tr_b16 v[36:37], v18 offset:24576
    v_mfma_f32_16x16x32_bf16 v[64:67], v[48:51], v[44:47], v[64:67]
    ds_read_b64_tr_b16 v[38:39], v18 offset:26624
    ds_read_b64_tr_b16 v[40:41], v19 offset:24576
    ds_read_b64_tr_b16 v[42:43], v19 offset:26624
    ds_read_b128 v[24:27], v16 offset:12288
    v_mfma_f32_16x16x32_bf16 v[68:71], v[52:55], v[44:47], v[68:71]
    v_mfma_f32_16x16x32_bf16 v[72:75], v[56:59], v[44:47], v[72:75]
    v_mfma_f32_16x16x32_bf16 v[76:79], v[60:63], v[44:47], v[76:79]
    s_waitcnt lgkmcnt(0)
    ds_read_b64_tr_b16 v[48:49], v18 offset:20480
    ds_read_b64_tr_b16 v[50:51], v18 offset:22528
    ds_read_b64_tr_b16 v[52:53], v19 offset:20480
    ds_read_b64_tr_b16 v[54:55], v19 offset:22528
    ds_read_b64_tr_b16 v[56:57], v18 offset:28672
    v_mfma_f32_16x16x32_bf16 v[64:67], v[28:31], v[24:27], v[64:67]
    ds_read_b64_tr_b16 v[58:59], v18 offset:30720
    ds_read_b64_tr_b16 v[60:61], v19 offset:28672
    ds_read_b64_tr_b16 v[62:63], v19 offset:30720
    ds_read_b128 v[44:47], v17 offset:12288
    v_mfma_f32_16x16x32_bf16 v[68:71], v[32:35], v[24:27], v[68:71]
    s_waitcnt lgkmcnt(0)
    s_barrier
    v_mfma_f32_16x16x32_bf16 v[72:75], v[36:39], v[24:27], v[72:75]
    v_mfma_f32_16x16x32_bf16 v[76:79], v[40:43], v[24:27], v[76:79]
    ds_read_b64_tr_b16 v[28:29], v18 offset:32768
    ds_read_b64_tr_b16 v[30:31], v18 offset:34816
    ds_read_b64_tr_b16 v[32:33], v19 offset:32768
    ds_read_b64_tr_b16 v[34:35], v19 offset:34816
    ds_read_b64_tr_b16 v[36:37], v18 offset:40960
    v_mfma_f32_16x16x32_bf16 v[64:67], v[48:51], v[44:47], v[64:67]
    ds_read_b64_tr_b16 v[38:39], v18 offset:43008
    ds_read_b64_tr_b16 v[40:41], v19 offset:40960
    ds_read_b64_tr_b16 v[42:43], v19 offset:43008
    ds_read_b128 v[24:27], v16 offset:16384
    v_mfma_f32_16x16x32_bf16 v[68:71], v[52:55], v[44:47], v[68:71]
    v_mfma_f32_16x16x32_bf16 v[72:75], v[56:59], v[44:47], v[72:75]
    v_mfma_f32_16x16x32_bf16 v[76:79], v[60:63], v[44:47], v[76:79]
    s_waitcnt lgkmcnt(0)
    ds_read_b64_tr_b16 v[48:49], v18 offset:36864
    ds_read_b64_tr_b16 v[50:51], v18 offset:38912
    ds_read_b64_tr_b16 v[52:53], v19 offset:36864
    ds_read_b64_tr_b16 v[54:55], v19 offset:38912
    ds_read_b64_tr_b16 v[56:57], v18 offset:45056
    v_mfma_f32_16x16x32_bf16 v[64:67], v[28:31], v[24:27], v[64:67]
    ds_read_b64_tr_b16 v[58:59], v18 offset:47104
    ds_read_b64_tr_b16 v[60:61], v19 offset:45056
    ds_read_b64_tr_b16 v[62:63], v19 offset:47104
    ds_read_b128 v[44:47], v17 offset:16384
    v_mfma_f32_16x16x32_bf16 v[68:71], v[32:35], v[24:27], v[68:71]
    s_waitcnt lgkmcnt(0)
    s_barrier
    v_mfma_f32_16x16x32_bf16 v[72:75], v[36:39], v[24:27], v[72:75]
    v_mfma_f32_16x16x32_bf16 v[76:79], v[40:43], v[24:27], v[76:79]
    ds_read_b64_tr_b16 v[28:29], v20 offset:0
    ds_read_b64_tr_b16 v[30:31], v20 offset:2048
    ds_read_b64_tr_b16 v[32:33], v21 offset:0
    ds_read_b64_tr_b16 v[34:35], v21 offset:2048
    ds_read_b64_tr_b16 v[36:37], v20 offset:8192
    v_mfma_f32_16x16x32_bf16 v[64:67], v[48:51], v[44:47], v[64:67]
    ds_read_b64_tr_b16 v[38:39], v20 offset:10240
    ds_read_b64_tr_b16 v[40:41], v21 offset:8192
    ds_read_b64_tr_b16 v[42:43], v21 offset:10240
    ds_read_b128 v[24:27], v16 offset:20480
    v_mfma_f32_16x16x32_bf16 v[68:71], v[52:55], v[44:47], v[68:71]
    v_mfma_f32_16x16x32_bf16 v[72:75], v[56:59], v[44:47], v[72:75]
    v_mfma_f32_16x16x32_bf16 v[76:79], v[60:63], v[44:47], v[76:79]
    s_waitcnt lgkmcnt(0)
    ds_read_b64_tr_b16 v[48:49], v20 offset:4096
    ds_read_b64_tr_b16 v[50:51], v20 offset:6144
    ds_read_b64_tr_b16 v[52:53], v21 offset:4096
    ds_read_b64_tr_b16 v[54:55], v21 offset:6144
    ds_read_b64_tr_b16 v[56:57], v20 offset:12288
    v_mfma_f32_16x16x32_bf16 v[64:67], v[28:31], v[24:27], v[64:67]
    ds_read_b64_tr_b16 v[58:59], v20 offset:14336
    ds_read_b64_tr_b16 v[60:61], v21 offset:12288
    ds_read_b64_tr_b16 v[62:63], v21 offset:14336
    ds_read_b128 v[44:47], v17 offset:20480
    v_mfma_f32_16x16x32_bf16 v[68:71], v[32:35], v[24:27], v[68:71]
    s_waitcnt lgkmcnt(0)
    s_barrier
    v_mfma_f32_16x16x32_bf16 v[72:75], v[36:39], v[24:27], v[72:75]
    v_mfma_f32_16x16x32_bf16 v[76:79], v[40:43], v[24:27], v[76:79]
    ds_read_b64_tr_b16 v[28:29], v20 offset:16384
    ds_read_b64_tr_b16 v[30:31], v20 offset:18432
    ds_read_b64_tr_b16 v[32:33], v21 offset:16384
    ds_read_b64_tr_b16 v[34:35], v21 offset:18432
    ds_read_b64_tr_b16 v[36:37], v20 offset:24576
    v_mfma_f32_16x16x32_bf16 v[64:67], v[48:51], v[44:47], v[64:67]
    ds_read_b64_tr_b16 v[38:39], v20 offset:26624
    ds_read_b64_tr_b16 v[40:41], v21 offset:24576
    ds_read_b64_tr_b16 v[42:43], v21 offset:26624
    ds_read_b128 v[24:27], v16 offset:24576
    v_mfma_f32_16x16x32_bf16 v[68:71], v[52:55], v[44:47], v[68:71]
    v_mfma_f32_16x16x32_bf16 v[72:75], v[56:59], v[44:47], v[72:75]
    v_mfma_f32_16x16x32_bf16 v[76:79], v[60:63], v[44:47], v[76:79]
    s_waitcnt lgkmcnt(0)
    ds_read_b64_tr_b16 v[48:49], v20 offset:20480
    ds_read_b64_tr_b16 v[50:51], v20 offset:22528
    ds_read_b64_tr_b16 v[52:53], v21 offset:20480
    ds_read_b64_tr_b16 v[54:55], v21 offset:22528
    ds_read_b64_tr_b16 v[56:57], v20 offset:28672
    v_mfma_f32_16x16x32_bf16 v[64:67], v[28:31], v[24:27], v[64:67]
    ds_read_b64_tr_b16 v[58:59], v20 offset:30720
    ds_read_b64_tr_b16 v[60:61], v21 offset:28672
    ds_read_b64_tr_b16 v[62:63], v21 offset:30720
    ds_read_b128 v[44:47], v17 offset:24576
    v_mfma_f32_16x16x32_bf16 v[68:71], v[32:35], v[24:27], v[68:71]
    s_waitcnt lgkmcnt(0)
    s_barrier
    v_mfma_f32_16x16x32_bf16 v[72:75], v[36:39], v[24:27], v[72:75]
    v_mfma_f32_16x16x32_bf16 v[76:79], v[40:43], v[24:27], v[76:79]
    ds_read_b64_tr_b16 v[28:29], v20 offset:32768
    ds_read_b64_tr_b16 v[30:31], v20 offset:34816
    ds_read_b64_tr_b16 v[32:33], v21 offset:32768
    ds_read_b64_tr_b16 v[34:35], v21 offset:34816
    ds_read_b64_tr_b16 v[36:37], v20 offset:40960
    v_mfma_f32_16x16x32_bf16 v[64:67], v[48:51], v[44:47], v[64:67]
    ds_read_b64_tr_b16 v[38:39], v20 offset:43008
    ds_read_b64_tr_b16 v[40:41], v21 offset:40960
    ds_read_b64_tr_b16 v[42:43], v21 offset:43008
    ds_read_b128 v[24:27], v16 offset:28672
    v_mfma_f32_16x16x32_bf16 v[68:71], v[52:55], v[44:47], v[68:71]
    v_mfma_f32_16x16x32_bf16 v[72:75], v[56:59], v[44:47], v[72:75]
    v_mfma_f32_16x16x32_bf16 v[76:79], v[60:63], v[44:47], v[76:79]
    s_waitcnt lgkmcnt(0)
    ds_read_b64_tr_b16 v[48:49], v20 offset:36864
    ds_read_b64_tr_b16 v[50:51], v20 offset:38912
    ds_read_b64_tr_b16 v[52:53], v21 offset:36864
    ds_read_b64_tr_b16 v[54:55], v21 offset:38912
    ds_read_b64_tr_b16 v[56:57], v20 offset:45056
    v_mfma_f32_16x16x32_bf16 v[64:67], v[28:31], v[24:27], v[64:67]
    ds_read_b64_tr_b16 v[58:59], v20 offset:47104
    ds_read_b64_tr_b16 v[60:61], v21 offset:45056
    ds_read_b64_tr_b16 v[62:63], v21 offset:47104
    ds_read_b128 v[44:47], v17 offset:28672
    v_mfma_f32_16x16x32_bf16 v[68:71], v[32:35], v[24:27], v[68:71]
    s_waitcnt lgkmcnt(0)
    s_barrier
    v_mfma_f32_16x16x32_bf16 v[72:75], v[36:39], v[24:27], v[72:75]
    v_mfma_f32_16x16x32_bf16 v[76:79], v[40:43], v[24:27], v[76:79]
    ds_read_b64_tr_b16 v[28:29], v18 offset:0
    ds_read_b64_tr_b16 v[30:31], v18 offset:2048
    ds_read_b64_tr_b16 v[32:33], v19 offset:0
    ds_read_b64_tr_b16 v[34:35], v19 offset:2048
    ds_read_b64_tr_b16 v[36:37], v18 offset:8192
    v_mfma_f32_16x16x32_bf16 v[64:67], v[48:51], v[44:47], v[64:67]
    ds_read_b64_tr_b16 v[38:39], v18 offset:10240
    ds_read_b64_tr_b16 v[40:41], v19 offset:8192
    ds_read_b64_tr_b16 v[42:43], v19 offset:10240
    ds_read_b128 v[24:27], v16 offset:32768
    v_mfma_f32_16x16x32_bf16 v[68:71], v[52:55], v[44:47], v[68:71]
    v_mfma_f32_16x16x32_bf16 v[72:75], v[56:59], v[44:47], v[72:75]
    v_mfma_f32_16x16x32_bf16 v[76:79], v[60:63], v[44:47], v[76:79]
    s_waitcnt lgkmcnt(0)
    ds_read_b64_tr_b16 v[48:49], v18 offset:4096
    ds_read_b64_tr_b16 v[50:51], v18 offset:6144
    ds_read_b64_tr_b16 v[52:53], v19 offset:4096
    ds_read_b64_tr_b16 v[54:55], v19 offset:6144
    ds_read_b64_tr_b16 v[56:57], v18 offset:12288
    v_mfma_f32_16x16x32_bf16 v[64:67], v[28:31], v[24:27], v[64:67]
    ds_read_b64_tr_b16 v[58:59], v18 offset:14336
    ds_read_b64_tr_b16 v[60:61], v19 offset:12288
    ds_read_b64_tr_b16 v[62:63], v19 offset:14336
    ds_read_b128 v[44:47], v17 offset:32768
    v_mfma_f32_16x16x32_bf16 v[68:71], v[32:35], v[24:27], v[68:71]
    s_waitcnt lgkmcnt(0)
    s_barrier
    v_mfma_f32_16x16x32_bf16 v[72:75], v[36:39], v[24:27], v[72:75]
    v_mfma_f32_16x16x32_bf16 v[76:79], v[40:43], v[24:27], v[76:79]
    ds_read_b64_tr_b16 v[28:29], v18 offset:16384
    ds_read_b64_tr_b16 v[30:31], v18 offset:18432
    ds_read_b64_tr_b16 v[32:33], v19 offset:16384
    ds_read_b64_tr_b16 v[34:35], v19 offset:18432
    ds_read_b64_tr_b16 v[36:37], v18 offset:24576
    v_mfma_f32_16x16x32_bf16 v[64:67], v[48:51], v[44:47], v[64:67]
    ds_read_b64_tr_b16 v[38:39], v18 offset:26624
    ds_read_b64_tr_b16 v[40:41], v19 offset:24576
    ds_read_b64_tr_b16 v[42:43], v19 offset:26624
    ds_read_b128 v[24:27], v16 offset:36864
    v_mfma_f32_16x16x32_bf16 v[68:71], v[52:55], v[44:47], v[68:71]
    v_mfma_f32_16x16x32_bf16 v[72:75], v[56:59], v[44:47], v[72:75]
    v_mfma_f32_16x16x32_bf16 v[76:79], v[60:63], v[44:47], v[76:79]
    s_waitcnt lgkmcnt(0)
    ds_read_b64_tr_b16 v[48:49], v18 offset:20480
    ds_read_b64_tr_b16 v[50:51], v18 offset:22528
    ds_read_b64_tr_b16 v[52:53], v19 offset:20480
    ds_read_b64_tr_b16 v[54:55], v19 offset:22528
    ds_read_b64_tr_b16 v[56:57], v18 offset:28672
    v_mfma_f32_16x16x32_bf16 v[64:67], v[28:31], v[24:27], v[64:67]
    ds_read_b64_tr_b16 v[58:59], v18 offset:30720
    ds_read_b64_tr_b16 v[60:61], v19 offset:28672
    ds_read_b64_tr_b16 v[62:63], v19 offset:30720
    ds_read_b128 v[44:47], v17 offset:36864
    v_mfma_f32_16x16x32_bf16 v[68:71], v[32:35], v[24:27], v[68:71]
    s_waitcnt lgkmcnt(0)
    s_barrier
    v_mfma_f32_16x16x32_bf16 v[72:75], v[36:39], v[24:27], v[72:75]
    v_mfma_f32_16x16x32_bf16 v[76:79], v[40:43], v[24:27], v[76:79]
    ds_read_b128 v[100:103], v8 offset:512
    ds_read_b128 v[104:107], v8 offset:576
    ds_read_b128 v[108:111], v8 offset:768
    v_mfma_f32_16x16x32_bf16 v[64:67], v[48:51], v[44:47], v[64:67]
    ds_read_b128 v[112:115], v8 offset:832
    ds_read_b128 v[116:119], v11 offset:0
    v_mfma_f32_16x16x32_bf16 v[68:71], v[52:55], v[44:47], v[68:71]
    v_mfma_f32_16x16x32_bf16 v[72:75], v[56:59], v[44:47], v[72:75]
    v_mfma_f32_16x16x32_bf16 v[76:79], v[60:63], v[44:47], v[76:79]
    s_waitcnt lgkmcnt(0)
    s_nop 1
    v_pk_fma_f32 v[64:65], v[100:101], v[116:117], v[64:65] op_sel_hi:[1,0,1]
    v_pk_fma_f32 v[66:67], v[102:103], v[116:117], v[66:67] op_sel_hi:[1,0,1]
    s_nop 0
    v_pk_fma_f32 v[68:69], v[104:105], v[116:117], v[68:69] op_sel_hi:[1,0,1]
    v_pk_fma_f32 v[70:71], v[106:107], v[116:117], v[70:71] op_sel_hi:[1,0,1]
    v_pk_mul_f32 v[140:141], v[64:65], v[64:65]
    v_pk_mul_f32 v[142:143], v[66:67], v[66:67]
    v_pk_mul_f32 v[144:145], v[68:69], v[68:69]
    v_pk_mul_f32 v[146:147], v[70:71], v[70:71]
    v_pk_fma_f32 v[140:141], v[140:141], v[118:119], v[116:117] op_sel:[0,0,1] op_sel_hi:[1,0,1]
    v_pk_fma_f32 v[142:143], v[142:143], v[118:119], v[116:117] op_sel:[0,0,1] op_sel_hi:[1,0,1]
    v_pk_fma_f32 v[144:145], v[144:145], v[118:119], v[116:117] op_sel:[0,0,1] op_sel_hi:[1,0,1]
    v_pk_fma_f32 v[146:147], v[146:147], v[118:119], v[116:117] op_sel:[0,0,1] op_sel_hi:[1,0,1]
    v_pk_mul_f32 v[140:141], v[140:141], v[64:65]
    v_pk_mul_f32 v[142:143], v[142:143], v[66:67]
    v_pk_mul_f32 v[144:145], v[144:145], v[68:69]
    v_pk_mul_f32 v[146:147], v[146:147], v[70:71]
    v_exp_f32 v140, v140
    v_exp_f32 v141, v141
    v_exp_f32 v142, v142
    v_exp_f32 v143, v143
    v_exp_f32 v144, v144
    v_exp_f32 v145, v145
    v_exp_f32 v146, v146
    v_exp_f32 v147, v147
    v_pk_fma_f32 v[72:73], v[108:109], v[116:117], v[72:73] op_sel_hi:[1,0,1]
    v_pk_fma_f32 v[74:75], v[110:111], v[116:117], v[74:75] op_sel_hi:[1,0,1]
    v_pk_fma_f32 v[76:77], v[112:113], v[116:117], v[76:77] op_sel_hi:[1,0,1]
    v_pk_fma_f32 v[78:79], v[114:115], v[116:117], v[78:79] op_sel_hi:[1,0,1]
    v_pk_fma_f32 v[140:141], v[140:141], v[118:119], v[118:119] op_sel:[0,1,1] op_sel_hi:[1,1,1]
    v_pk_fma_f32 v[142:143], v[142:143], v[118:119], v[118:119] op_sel:[0,1,1] op_sel_hi:[1,1,1]
    v_pk_fma_f32 v[144:145], v[144:145], v[118:119], v[118:119] op_sel:[0,1,1] op_sel_hi:[1,1,1]
    v_pk_fma_f32 v[146:147], v[146:147], v[118:119], v[118:119] op_sel:[0,1,1] op_sel_hi:[1,1,1]
    v_rcp_f32 v140, v140
    v_rcp_f32 v141, v141
    v_rcp_f32 v142, v142
    v_rcp_f32 v143, v143
    v_rcp_f32 v144, v144
    v_rcp_f32 v145, v145
    v_rcp_f32 v146, v146
    v_rcp_f32 v147, v147
    v_pk_mul_f32 v[64:65], v[64:65], v[72:73]
    v_pk_mul_f32 v[66:67], v[66:67], v[74:75]
    v_pk_mul_f32 v[68:69], v[68:69], v[76:77]
    v_pk_mul_f32 v[70:71], v[70:71], v[78:79]
    v_pk_mul_f32 v[64:65], v[64:65], v[140:141]
    v_pk_mul_f32 v[66:67], v[66:67], v[142:143]
    v_pk_mul_f32 v[68:69], v[68:69], v[144:145]
    v_pk_mul_f32 v[70:71], v[70:71], v[146:147]
    v_cvt_pk_bf16_f32 v148, v64, v65
    v_cvt_pk_bf16_f32 v149, v66, v67
    v_cvt_pk_bf16_f32 v150, v68, v69
    v_cvt_pk_bf16_f32 v151, v70, v71
    s_nop 0
    v_permlane16_swap_b32 v148, v150
    v_permlane16_swap_b32 v149, v151
    s_mov_b32 s38, 2048
    buffer_store_dwordx4 v[148:151], v10, s[52:55], s38 offen sc1
    ds_read_b64_tr_b16 v[28:29], v18 offset:32768
    ds_read_b64_tr_b16 v[30:31], v18 offset:34816
    ds_read_b64_tr_b16 v[32:33], v19 offset:32768
    ds_read_b64_tr_b16 v[34:35], v19 offset:34816
    ds_read_b64_tr_b16 v[36:37], v18 offset:40960
    ds_read_b64_tr_b16 v[38:39], v18 offset:43008
    ds_read_b64_tr_b16 v[40:41], v19 offset:40960
    ds_read_b64_tr_b16 v[42:43], v19 offset:43008
    ds_read_b128 v[24:27], v16 offset:0
    s_waitcnt lgkmcnt(0)
    ds_read_b64_tr_b16 v[48:49], v18 offset:36864
    ds_read_b64_tr_b16 v[50:51], v18 offset:38912
    ds_read_b64_tr_b16 v[52:53], v19 offset:36864
    ds_read_b64_tr_b16 v[54:55], v19 offset:38912
    ds_read_b64_tr_b16 v[56:57], v18 offset:45056
    v_mfma_f32_16x16x32_bf16 v[64:67], v[28:31], v[24:27], 0
    ds_read_b64_tr_b16 v[58:59], v18 offset:47104
    ds_read_b64_tr_b16 v[60:61], v19 offset:45056
    ds_read_b64_tr_b16 v[62:63], v19 offset:47104
    ds_read_b128 v[44:47], v17 offset:0
    v_mfma_f32_16x16x32_bf16 v[68:71], v[32:35], v[24:27], 0
    s_waitcnt lgkmcnt(0)
    s_barrier
    v_mfma_f32_16x16x32_bf16 v[72:75], v[36:39], v[24:27], 0
    v_mfma_f32_16x16x32_bf16 v[76:79], v[40:43], v[24:27], 0
    ds_read_b64_tr_b16 v[28:29], v20 offset:0
    ds_read_b64_tr_b16 v[30:31], v20 offset:2048
    ds_read_b64_tr_b16 v[32:33], v21 offset:0
    ds_read_b64_tr_b16 v[34:35], v21 offset:2048
    ds_read_b64_tr_b16 v[36:37], v20 offset:8192
    v_mfma_f32_16x16x32_bf16 v[64:67], v[48:51], v[44:47], v[64:67]
    ds_read_b64_tr_b16 v[38:39], v20 offset:10240
    ds_read_b64_tr_b16 v[40:41], v21 offset:8192
    ds_read_b64_tr_b16 v[42:43], v21 offset:10240
    ds_read_b128 v[24:27], v16 offset:4096
    v_mfma_f32_16x16x32_bf16 v[68:71], v[52:55], v[44:47], v[68:71]
    v_mfma_f32_16x16x32_bf16 v[72:75], v[56:59], v[44:47], v[72:75]
    v_mfma_f32_16x16x32_bf16 v[76:79], v[60:63], v[44:47], v[76:79]
    s_waitcnt lgkmcnt(0)
    ds_read_b64_tr_b16 v[48:49], v20 offset:4096
    ds_read_b64_tr_b16 v[50:51], v20 offset:6144
    ds_read_b64_tr_b16 v[52:53], v21 offset:4096
    ds_read_b64_tr_b16 v[54:55], v21 offset:6144
    ds_read_b64_tr_b16 v[56:57], v20 offset:12288
    v_mfma_f32_16x16x32_bf16 v[64:67], v[28:31], v[24:27], v[64:67]
    ds_read_b64_tr_b16 v[58:59], v20 offset:14336
    ds_read_b64_tr_b16 v[60:61], v21 offset:12288
    ds_read_b64_tr_b16 v[62:63], v21 offset:14336
    ds_read_b128 v[44:47], v17 offset:4096
    v_mfma_f32_16x16x32_bf16 v[68:71], v[32:35], v[24:27], v[68:71]
    s_waitcnt lgkmcnt(0)
    s_barrier
    v_mfma_f32_16x16x32_bf16 v[72:75], v[36:39], v[24:27], v[72:75]
    v_mfma_f32_16x16x32_bf16 v[76:79], v[40:43], v[24:27], v[76:79]
    ds_read_b64_tr_b16 v[28:29], v20 offset:16384
    ds_read_b64_tr_b16 v[30:31], v20 offset:18432
    ds_read_b64_tr_b16 v[32:33], v21 offset:16384
    ds_read_b64_tr_b16 v[34:35], v21 offset:18432
    ds_read_b64_tr_b16 v[36:37], v20 offset:24576
    v_mfma_f32_16x16x32_bf16 v[64:67], v[48:51], v[44:47], v[64:67]
    ds_read_b64_tr_b16 v[38:39], v20 offset:26624
    ds_read_b64_tr_b16 v[40:41], v21 offset:24576
    ds_read_b64_tr_b16 v[42:43], v21 offset:26624
    ds_read_b128 v[24:27], v16 offset:8192
    v_mfma_f32_16x16x32_bf16 v[68:71], v[52:55], v[44:47], v[68:71]
    v_mfma_f32_16x16x32_bf16 v[72:75], v[56:59], v[44:47], v[72:75]
    v_mfma_f32_16x16x32_bf16 v[76:79], v[60:63], v[44:47], v[76:79]
    s_waitcnt lgkmcnt(0)
    ds_read_b64_tr_b16 v[48:49], v20 offset:20480
    ds_read_b64_tr_b16 v[50:51], v20 offset:22528
    ds_read_b64_tr_b16 v[52:53], v21 offset:20480
    ds_read_b64_tr_b16 v[54:55], v21 offset:22528
    ds_read_b64_tr_b16 v[56:57], v20 offset:28672
    v_mfma_f32_16x16x32_bf16 v[64:67], v[28:31], v[24:27], v[64:67]
    ds_read_b64_tr_b16 v[58:59], v20 offset:30720
    ds_read_b64_tr_b16 v[60:61], v21 offset:28672
    ds_read_b64_tr_b16 v[62:63], v21 offset:30720
    ds_read_b128 v[44:47], v17 offset:8192
    v_mfma_f32_16x16x32_bf16 v[68:71], v[32:35], v[24:27], v[68:71]
    s_waitcnt lgkmcnt(0)
    s_barrier
    v_mfma_f32_16x16x32_bf16 v[72:75], v[36:39], v[24:27], v[72:75]
    v_mfma_f32_16x16x32_bf16 v[76:79], v[40:43], v[24:27], v[76:79]
    ds_read_b64_tr_b16 v[28:29], v20 offset:32768
    ds_read_b64_tr_b16 v[30:31], v20 offset:34816
    ds_read_b64_tr_b16 v[32:33], v21 offset:32768
    ds_read_b64_tr_b16 v[34:35], v21 offset:34816
    ds_read_b64_tr_b16 v[36:37], v20 offset:40960
    v_mfma_f32_16x16x32_bf16 v[64:67], v[48:51], v[44:47], v[64:67]
    ds_read_b64_tr_b16 v[38:39], v20 offset:43008
    ds_read_b64_tr_b16 v[40:41], v21 offset:40960
    ds_read_b64_tr_b16 v[42:43], v21 offset:43008
    ds_read_b128 v[24:27], v16 offset:12288
    v_mfma_f32_16x16x32_bf16 v[68:71], v[52:55], v[44:47], v[68:71]
    v_mfma_f32_16x16x32_bf16 v[72:75], v[56:59], v[44:47], v[72:75]
    v_mfma_f32_16x16x32_bf16 v[76:79], v[60:63], v[44:47], v[76:79]
    s_waitcnt lgkmcnt(0)
    ds_read_b64_tr_b16 v[48:49], v20 offset:36864
    ds_read_b64_tr_b16 v[50:51], v20 offset:38912
    ds_read_b64_tr_b16 v[52:53], v21 offset:36864
    ds_read_b64_tr_b16 v[54:55], v21 offset:38912
    ds_read_b64_tr_b16 v[56:57], v20 offset:45056
    v_mfma_f32_16x16x32_bf16 v[64:67], v[28:31], v[24:27], v[64:67]
    ds_read_b64_tr_b16 v[58:59], v20 offset:47104
    ds_read_b64_tr_b16 v[60:61], v21 offset:45056
    ds_read_b64_tr_b16 v[62:63], v21 offset:47104
    ds_read_b128 v[44:47], v17 offset:12288
    v_mfma_f32_16x16x32_bf16 v[68:71], v[32:35], v[24:27], v[68:71]
    s_waitcnt lgkmcnt(0)
    s_barrier
    v_mfma_f32_16x16x32_bf16 v[72:75], v[36:39], v[24:27], v[72:75]
    v_mfma_f32_16x16x32_bf16 v[76:79], v[40:43], v[24:27], v[76:79]
    ds_read_b64_tr_b16 v[28:29], v18 offset:0
    ds_read_b64_tr_b16 v[30:31], v18 offset:2048
    ds_read_b64_tr_b16 v[32:33], v19 offset:0
    ds_read_b64_tr_b16 v[34:35], v19 offset:2048
    ds_read_b64_tr_b16 v[36:37], v18 offset:8192
    v_mfma_f32_16x16x32_bf16 v[64:67], v[48:51], v[44:47], v[64:67]
    ds_read_b64_tr_b16 v[38:39], v18 offset:10240
    ds_read_b64_tr_b16 v[40:41], v19 offset:8192
    ds_read_b64_tr_b16 v[42:43], v19 offset:10240
    ds_read_b128 v[24:27], v16 offset:16384
    v_mfma_f32_16x16x32_bf16 v[68:71], v[52:55], v[44:47], v[68:71]
    v_mfma_f32_16x16x32_bf16 v[72:75], v[56:59], v[44:47], v[72:75]
    v_mfma_f32_16x16x32_bf16 v[76:79], v[60:63], v[44:47], v[76:79]
    s_waitcnt lgkmcnt(0)
    ds_read_b64_tr_b16 v[48:49], v18 offset:4096
    ds_read_b64_tr_b16 v[50:51], v18 offset:6144
    ds_read_b64_tr_b16 v[52:53], v19 offset:4096
    ds_read_b64_tr_b16 v[54:55], v19 offset:6144
    ds_read_b64_tr_b16 v[56:57], v18 offset:12288
    v_mfma_f32_16x16x32_bf16 v[64:67], v[28:31], v[24:27], v[64:67]
    ds_read_b64_tr_b16 v[58:59], v18 offset:14336
    ds_read_b64_tr_b16 v[60:61], v19 offset:12288
    ds_read_b64_tr_b16 v[62:63], v19 offset:14336
    ds_read_b128 v[44:47], v17 offset:16384
    v_mfma_f32_16x16x32_bf16 v[68:71], v[32:35], v[24:27], v[68:71]
    s_waitcnt lgkmcnt(0)
    s_barrier
    v_mfma_f32_16x16x32_bf16 v[72:75], v[36:39], v[24:27], v[72:75]
    v_mfma_f32_16x16x32_bf16 v[76:79], v[40:43], v[24:27], v[76:79]
    ds_read_b64_tr_b16 v[28:29], v18 offset:16384
    ds_read_b64_tr_b16 v[30:31], v18 offset:18432
    ds_read_b64_tr_b16 v[32:33], v19 offset:16384
    ds_read_b64_tr_b16 v[34:35], v19 offset:18432
    ds_read_b64_tr_b16 v[36:37], v18 offset:24576
    v_mfma_f32_16x16x32_bf16 v[64:67], v[48:51], v[44:47], v[64:67]
    ds_read_b64_tr_b16 v[38:39], v18 offset:26624
    ds_read_b64_tr_b16 v[40:41], v19 offset:24576
    ds_read_b64_tr_b16 v[42:43], v19 offset:26624
    ds_read_b128 v[24:27], v16 offset:20480
    v_mfma_f32_16x16x32_bf16 v[68:71], v[52:55], v[44:47], v[68:71]
    v_mfma_f32_16x16x32_bf16 v[72:75], v[56:59], v[44:47], v[72:75]
    v_mfma_f32_16x16x32_bf16 v[76:79], v[60:63], v[44:47], v[76:79]
    s_waitcnt lgkmcnt(0)
    ds_read_b64_tr_b16 v[48:49], v18 offset:20480
    ds_read_b64_tr_b16 v[50:51], v18 offset:22528
    ds_read_b64_tr_b16 v[52:53], v19 offset:20480
    ds_read_b64_tr_b16 v[54:55], v19 offset:22528
    ds_read_b64_tr_b16 v[56:57], v18 offset:28672
    v_mfma_f32_16x16x32_bf16 v[64:67], v[28:31], v[24:27], v[64:67]
    ds_read_b64_tr_b16 v[58:59], v18 offset:30720
    ds_read_b64_tr_b16 v[60:61], v19 offset:28672
    ds_read_b64_tr_b16 v[62:63], v19 offset:30720
    ds_read_b128 v[44:47], v17 offset:20480
    v_mfma_f32_16x16x32_bf16 v[68:71], v[32:35], v[24:27], v[68:71]
    s_waitcnt lgkmcnt(0)
    s_barrier
    v_mfma_f32_16x16x32_bf16 v[72:75], v[36:39], v[24:27], v[72:75]
    v_mfma_f32_16x16x32_bf16 v[76:79], v[40:43], v[24:27], v[76:79]
    ds_read_b64_tr_b16 v[28:29], v18 offset:32768
    ds_read_b64_tr_b16 v[30:31], v18 offset:34816
    ds_read_b64_tr_b16 v[32:33], v19 offset:32768
    ds_read_b64_tr_b16 v[34:35], v19 offset:34816
    ds_read_b64_tr_b16 v[36:37], v18 offset:40960
    v_mfma_f32_16x16x32_bf16 v[64:67], v[48:51], v[44:47], v[64:67]
    ds_read_b64_tr_b16 v[38:39], v18 offset:43008
    ds_read_b64_tr_b16 v[40:41], v19 offset:40960
    ds_read_b64_tr_b16 v[42:43], v19 offset:43008
    ds_read_b128 v[24:27], v16 offset:24576
    v_mfma_f32_16x16x32_bf16 v[68:71], v[52:55], v[44:47], v[68:71]
    v_mfma_f32_16x16x32_bf16 v[72:75], v[56:59], v[44:47], v[72:75]
    v_mfma_f32_16x16x32_bf16 v[76:79], v[60:63], v[44:47], v[76:79]
    s_waitcnt lgkmcnt(0)
    ds_read_b64_tr_b16 v[48:49], v18 offset:36864
    ds_read_b64_tr_b16 v[50:51], v18 offset:38912
    ds_read_b64_tr_b16 v[52:53], v19 offset:36864
    ds_read_b64_tr_b16 v[54:55], v19 offset:38912
    ds_read_b64_tr_b16 v[56:57], v18 offset:45056
    v_mfma_f32_16x16x32_bf16 v[64:67], v[28:31], v[24:27], v[64:67]
    ds_read_b64_tr_b16 v[58:59], v18 offset:47104
    ds_read_b64_tr_b16 v[60:61], v19 offset:45056
    ds_read_b64_tr_b16 v[62:63], v19 offset:47104
    ds_read_b128 v[44:47], v17 offset:24576
    v_mfma_f32_16x16x32_bf16 v[68:71], v[32:35], v[24:27], v[68:71]
    s_waitcnt lgkmcnt(0)
    s_barrier
    v_mfma_f32_16x16x32_bf16 v[72:75], v[36:39], v[24:27], v[72:75]
    v_mfma_f32_16x16x32_bf16 v[76:79], v[40:43], v[24:27], v[76:79]
    ds_read_b64_tr_b16 v[28:29], v20 offset:0
    ds_read_b64_tr_b16 v[30:31], v20 offset:2048
    ds_read_b64_tr_b16 v[32:33], v21 offset:0
    ds_read_b64_tr_b16 v[34:35], v21 offset:2048
    ds_read_b64_tr_b16 v[36:37], v20 offset:8192
    v_mfma_f32_16x16x32_bf16 v[64:67], v[48:51], v[44:47], v[64:67]
    ds_read_b64_tr_b16 v[38:39], v20 offset:10240
    ds_read_b64_tr_b16 v[40:41], v21 offset:8192
    ds_read_b64_tr_b16 v[42:43], v21 offset:10240
    ds_read_b128 v[24:27], v16 offset:28672
    v_mfma_f32_16x16x32_bf16 v[68:71], v[52:55], v[44:47], v[68:71]
    v_mfma_f32_16x16x32_bf16 v[72:75], v[56:59], v[44:47], v[72:75]
    v_mfma_f32_16x16x32_bf16 v[76:79], v[60:63], v[44:47], v[76:79]
    s_waitcnt lgkmcnt(0)
    ds_read_b64_tr_b16 v[48:49], v20 offset:4096
    ds_read_b64_tr_b16 v[50:51], v20 offset:6144
    ds_read_b64_tr_b16 v[52:53], v21 offset:4096
    ds_read_b64_tr_b16 v[54:55], v21 offset:6144
    ds_read_b64_tr_b16 v[56:57], v20 offset:12288
    v_mfma_f32_16x16x32_bf16 v[64:67], v[28:31], v[24:27], v[64:67]
    ds_read_b64_tr_b16 v[58:59], v20 offset:14336
    ds_read_b64_tr_b16 v[60:61], v21 offset:12288
    ds_read_b64_tr_b16 v[62:63], v21 offset:14336
    ds_read_b128 v[44:47], v17 offset:28672
    v_mfma_f32_16x16x32_bf16 v[68:71], v[32:35], v[24:27], v[68:71]
    s_waitcnt lgkmcnt(0)
    s_barrier
    v_mfma_f32_16x16x32_bf16 v[72:75], v[36:39], v[24:27], v[72:75]
    v_mfma_f32_16x16x32_bf16 v[76:79], v[40:43], v[24:27], v[76:79]
    ds_read_b64_tr_b16 v[28:29], v20 offset:16384
    ds_read_b64_tr_b16 v[30:31], v20 offset:18432
    ds_read_b64_tr_b16 v[32:33], v21 offset:16384
    ds_read_b64_tr_b16 v[34:35], v21 offset:18432
    ds_read_b64_tr_b16 v[36:37], v20 offset:24576
    v_mfma_f32_16x16x32_bf16 v[64:67], v[48:51], v[44:47], v[64:67]
    ds_read_b64_tr_b16 v[38:39], v20 offset:26624
    ds_read_b64_tr_b16 v[40:41], v21 offset:24576
    ds_read_b64_tr_b16 v[42:43], v21 offset:26624
    ds_read_b128 v[24:27], v16 offset:32768
    v_mfma_f32_16x16x32_bf16 v[68:71], v[52:55], v[44:47], v[68:71]
    v_mfma_f32_16x16x32_bf16 v[72:75], v[56:59], v[44:47], v[72:75]
    v_mfma_f32_16x16x32_bf16 v[76:79], v[60:63], v[44:47], v[76:79]
    s_waitcnt lgkmcnt(0)
    ds_read_b64_tr_b16 v[48:49], v20 offset:20480
    ds_read_b64_tr_b16 v[50:51], v20 offset:22528
    ds_read_b64_tr_b16 v[52:53], v21 offset:20480
    ds_read_b64_tr_b16 v[54:55], v21 offset:22528
    ds_read_b64_tr_b16 v[56:57], v20 offset:28672
    v_mfma_f32_16x16x32_bf16 v[64:67], v[28:31], v[24:27], v[64:67]
    ds_read_b64_tr_b16 v[58:59], v20 offset:30720
    ds_read_b64_tr_b16 v[60:61], v21 offset:28672
    ds_read_b64_tr_b16 v[62:63], v21 offset:30720
    ds_read_b128 v[44:47], v17 offset:32768
    v_mfma_f32_16x16x32_bf16 v[68:71], v[32:35], v[24:27], v[68:71]
    s_waitcnt lgkmcnt(0)
    s_barrier
    v_mfma_f32_16x16x32_bf16 v[72:75], v[36:39], v[24:27], v[72:75]
    v_mfma_f32_16x16x32_bf16 v[76:79], v[40:43], v[24:27], v[76:79]
    ds_read_b64_tr_b16 v[28:29], v20 offset:32768
    ds_read_b64_tr_b16 v[30:31], v20 offset:34816
    ds_read_b64_tr_b16 v[32:33], v21 offset:32768
    ds_read_b64_tr_b16 v[34:35], v21 offset:34816
    ds_read_b64_tr_b16 v[36:37], v20 offset:40960
    v_mfma_f32_16x16x32_bf16 v[64:67], v[48:51], v[44:47], v[64:67]
    ds_read_b64_tr_b16 v[38:39], v20 offset:43008
    ds_read_b64_tr_b16 v[40:41], v21 offset:40960
    ds_read_b64_tr_b16 v[42:43], v21 offset:43008
    ds_read_b128 v[24:27], v16 offset:36864
    v_mfma_f32_16x16x32_bf16 v[68:71], v[52:55], v[44:47], v[68:71]
    v_mfma_f32_16x16x32_bf16 v[72:75], v[56:59], v[44:47], v[72:75]
    v_mfma_f32_16x16x32_bf16 v[76:79], v[60:63], v[44:47], v[76:79]
    s_waitcnt lgkmcnt(0)
    ds_read_b64_tr_b16 v[48:49], v20 offset:36864
    ds_read_b64_tr_b16 v[50:51], v20 offset:38912
    ds_read_b64_tr_b16 v[52:53], v21 offset:36864
    ds_read_b64_tr_b16 v[54:55], v21 offset:38912
    ds_read_b64_tr_b16 v[56:57], v20 offset:45056
    v_mfma_f32_16x16x32_bf16 v[64:67], v[28:31], v[24:27], v[64:67]
    ds_read_b64_tr_b16 v[58:59], v20 offset:47104
    ds_read_b64_tr_b16 v[60:61], v21 offset:45056
    ds_read_b64_tr_b16 v[62:63], v21 offset:47104
    ds_read_b128 v[44:47], v17 offset:36864
    v_mfma_f32_16x16x32_bf16 v[68:71], v[32:35], v[24:27], v[68:71]
    s_waitcnt lgkmcnt(0)
    s_barrier
    v_mfma_f32_16x16x32_bf16 v[72:75], v[36:39], v[24:27], v[72:75]
    v_mfma_f32_16x16x32_bf16 v[76:79], v[40:43], v[24:27], v[76:79]
    ds_read_b128 v[100:103], v8 offset:1024
    ds_read_b128 v[104:107], v8 offset:1088
    ds_read_b128 v[108:111], v8 offset:1280
    v_mfma_f32_16x16x32_bf16 v[64:67], v[48:51], v[44:47], v[64:67]
    ds_read_b128 v[112:115], v8 offset:1344
    ds_read_b128 v[116:119], v11 offset:0
    v_mfma_f32_16x16x32_bf16 v[68:71], v[52:55], v[44:47], v[68:71]
    v_mfma_f32_16x16x32_bf16 v[72:75], v[56:59], v[44:47], v[72:75]
    v_mfma_f32_16x16x32_bf16 v[76:79], v[60:63], v[44:47], v[76:79]
    s_waitcnt lgkmcnt(0)
    s_nop 1
    v_pk_fma_f32 v[64:65], v[100:101], v[116:117], v[64:65] op_sel_hi:[1,0,1]
    v_pk_fma_f32 v[66:67], v[102:103], v[116:117], v[66:67] op_sel_hi:[1,0,1]
    s_nop 0
    v_pk_fma_f32 v[68:69], v[104:105], v[116:117], v[68:69] op_sel_hi:[1,0,1]
    v_pk_fma_f32 v[70:71], v[106:107], v[116:117], v[70:71] op_sel_hi:[1,0,1]
    v_pk_mul_f32 v[140:141], v[64:65], v[64:65]
    v_pk_mul_f32 v[142:143], v[66:67], v[66:67]
    v_pk_mul_f32 v[144:145], v[68:69], v[68:69]
    v_pk_mul_f32 v[146:147], v[70:71], v[70:71]
    v_pk_fma_f32 v[140:141], v[140:141], v[118:119], v[116:117] op_sel:[0,0,1] op_sel_hi:[1,0,1]
    v_pk_fma_f32 v[142:143], v[142:143], v[118:119], v[116:117] op_sel:[0,0,1] op_sel_hi:[1,0,1]
    v_pk_fma_f32 v[144:145], v[144:145], v[118:119], v[116:117] op_sel:[0,0,1] op_sel_hi:[1,0,1]
    v_pk_fma_f32 v[146:147], v[146:147], v[118:119], v[116:117] op_sel:[0,0,1] op_sel_hi:[1,0,1]
    v_pk_mul_f32 v[140:141], v[140:141], v[64:65]
    v_pk_mul_f32 v[142:143], v[142:143], v[66:67]
    v_pk_mul_f32 v[144:145], v[144:145], v[68:69]
    v_pk_mul_f32 v[146:147], v[146:147], v[70:71]
    v_exp_f32 v140, v140
    v_exp_f32 v141, v141
    v_exp_f32 v142, v142
    v_exp_f32 v143, v143
    v_exp_f32 v144, v144
    v_exp_f32 v145, v145
    v_exp_f32 v146, v146
    v_exp_f32 v147, v147
    v_pk_fma_f32 v[72:73], v[108:109], v[116:117], v[72:73] op_sel_hi:[1,0,1]
    v_pk_fma_f32 v[74:75], v[110:111], v[116:117], v[74:75] op_sel_hi:[1,0,1]
    v_pk_fma_f32 v[76:77], v[112:113], v[116:117], v[76:77] op_sel_hi:[1,0,1]
    v_pk_fma_f32 v[78:79], v[114:115], v[116:117], v[78:79] op_sel_hi:[1,0,1]
    v_pk_fma_f32 v[140:141], v[140:141], v[118:119], v[118:119] op_sel:[0,1,1] op_sel_hi:[1,1,1]
    v_pk_fma_f32 v[142:143], v[142:143], v[118:119], v[118:119] op_sel:[0,1,1] op_sel_hi:[1,1,1]
    v_pk_fma_f32 v[144:145], v[144:145], v[118:119], v[118:119] op_sel:[0,1,1] op_sel_hi:[1,1,1]
    v_pk_fma_f32 v[146:147], v[146:147], v[118:119], v[118:119] op_sel:[0,1,1] op_sel_hi:[1,1,1]
    v_rcp_f32 v140, v140
    v_rcp_f32 v141, v141
    v_rcp_f32 v142, v142
    v_rcp_f32 v143, v143
    v_rcp_f32 v144, v144
    v_rcp_f32 v145, v145
    v_rcp_f32 v146, v146
    v_rcp_f32 v147, v147
    v_pk_mul_f32 v[64:65], v[64:65], v[72:73]
    v_pk_mul_f32 v[66:67], v[66:67], v[74:75]
    v_pk_mul_f32 v[68:69], v[68:69], v[76:77]
    v_pk_mul_f32 v[70:71], v[70:71], v[78:79]
    v_pk_mul_f32 v[64:65], v[64:65], v[140:141]
    v_pk_mul_f32 v[66:67], v[66:67], v[142:143]
    v_pk_mul_f32 v[68:69], v[68:69], v[144:145]
    v_pk_mul_f32 v[70:71], v[70:71], v[146:147]
    v_cvt_pk_bf16_f32 v148, v64, v65
    v_cvt_pk_bf16_f32 v149, v66, v67
    v_cvt_pk_bf16_f32 v150, v68, v69
    v_cvt_pk_bf16_f32 v151, v70, v71
    s_nop 0
    v_permlane16_swap_b32 v148, v150
    v_permlane16_swap_b32 v149, v151
    s_mov_b32 s38, 4096
    buffer_store_dwordx4 v[148:151], v10, s[52:55], s38 offen sc1
    s_lshl_b32 s38, s22, 5
    s_add_u32 s38, s38, s31
    s_lshl_b32 s38, s38, 7
    s_add_u32 s38, s38, 262144
    v_mov_b32 v12, 147572
    v_mov_b32 v13, 1
    s_mov_b64 exec, 1
    s_waitcnt vmcnt(0)
    ds_add_rtn_u32 v13, v12, v13
    s_mov_b64 exec, -1
    v_mov_b32 v244, s33
    v_mov_b32 v245, s33
    v_mov_b32 v246, s33
    v_mov_b32 v247, s33
    v_lshlrev_b32 v12, 7, v0
    s_waitcnt lgkmcnt(0)
    v_readfirstlane_b32 s70, v13
    s_nop 0
    s_cmp_lg_u32 s70, 3
    s_cbranch_scc1 notlast_111
    s_mov_b64 exec, 7
    buffer_store_dwordx4 v[244:247], v12, s[44:47], s38 offen sc1
    s_mov_b64 exec, -1
notlast_111:
c4_100:
    s_cmp_ge_u32 s21, 30
    s_cbranch_scc1 cx_101
    s_cmp_ge_u32 s21, 15
    s_cselect_b32 s24, 1, 0
    s_cselect_b32 s25, 15, 0
    s_sub_u32 s25, s21, s25
    s_and_b32 s22, s20, 3
    s_lshl_b32 s22, s22, 1
    s_add_u32 s22, s22, s24
    s_mul_i32 s24, s25, 13
    s_lshr_b32 s24, s24, 6
    s_mul_i32 s23, s24, 5
    s_sub_u32 s25, s25, s23
    s_lshr_b32 s23, s20, 2
    s_mul_i32 s31, s23, 5
    s_add_u32 s31, s31, s25
    s_lshl_b32 s30, s22, 8
    s_mul_i32 s23, s24, 80
    s_add_u32 s30, s30, s23
    s_cmp_eq_u32 s24, 2
    s_cselect_b32 s32, 16, 0
    s_add_u32 s32, s32, 80
    s_lshl_b32 s34, s31, 7
    s_lshr_b32 s36, s35, 1
    s_and_b32 s37, s35, 1
    v_and_b32 v2, 15, v0
    v_lshrrev_b32 v3, 4, v0
    v_bfe_u32 v8, v0, 2, 3
    v_bfe_u32 v9, v0, 3, 2
    v_lshrrev_b32 v10, 5, v0
    v_and_b32 v11, 3, v0
    v_lshlrev_b32 v11, 3, v11
    v_lshl_add_u32 v11, v8, 7, v11
    v_lshl_add_u32 v11, v10, 10, v11
    s_lshl_b32 s39, s37, 12
    v_add_u32 v11, s39, v11
    v_lshl_add_u32 v16, v9, 5, v11
    v_xor_b32 v17, 32, v16
    v_xor_b32 v18, 64, v16
    v_xor_b32 v19, 0x60, v16
    v_add_u32 v20, 57344, v16
    v_add_u32 v21, 57344, v17
    v_add_u32 v22, 57344, v18
    v_add_u32 v23, 57344, v19
    v_add_u32 v24, 114688, v16
    v_add_u32 v25, 114688, v17
    v_add_u32 v26, 114688, v18
    v_add_u32 v27, 114688, v19
    s_add_u32 s40, s4, 16777216
    s_addc_u32 s41, s5, 0
    s_mov_b32 s42, 7077888
    s_mov_b32 s43, 0x20000
    s_add_u32 s48, s4, 11534336
    s_addc_u32 s49, s5, 0
    s_mov_b32 s50, 2621440
    s_mov_b32 s51, 0x20000
    s_mov_b32 s52, s28
    s_mov_b32 s53, s29
    s_mov_b32 s54, 2621440
    s_mov_b32 s55, 0x20000
    s_mul_i32 s38, s36, 48
    s_add_u32 s39, s38, s30
    s_mul_i32 s72, s39, 3456
    s_lshl_b32 s73, s37, 10
    s_add_u32 s72, s72, s73
    v_lshlrev_b32 v28, 4, v0
    v_add_u32 v28, s72, v28
    v_add_u32 v29, 55296, v28
    v_add_u32 v30, 110592, v28
    v_mov_b32 v7, 1073741824
    s_add_u32 s72, s38, 32
    s_cmp_lt_u32 s72, s32
    s_cselect_b64 vcc, -1, 0
    v_cndmask_b32 v30, v7, v30, vcc
    v_lshrrev_b32 v31, 1, v3
    v_lshlrev_b32 v31, 8, v31
    v_lshl_add_u32 v31, v2, 4, v31
    v_and_b32 v11, 1, v3
    v_lshl_add_u32 v31, v11, 3, v31
    s_mul_i32 s72, s39, 1280
    s_add_u32 s72, s72, s73
    s_lshl_b32 s73, s31, 11
    s_add_u32 s72, s72, s73
    v_add_u32 v31, s72, v31
    v_lshlrev_b32 v8, 5, v11
    v_lshrrev_b32 v9, 1, v3
    v_lshl_add_u32 v8, v9, 4, v8
    s_lshl_b32 s73, s37, 6
    s_add_u32 s73, s73, s34
    v_add_u32 v8, s73, v8
    v_add_u32 v4, s39, v2
    v_mul_u32_u24 v4, 1280, v4
    v_add_u32 v4, v4, v8
    v_add_u32 v5, 20480, v4
    v_add_u32 v6, 40960, v4
    v_cndmask_b32 v6, v7, v6, vcc
    s_mul_i32 s73, s35, 6144
    s_add_u32 s73, s73, 73728
    v_lshlrev_b32 v8, 4, v0
    v_add_u32 v9, s73, v8
    s_xor_b32 s73, s35, 1
    s_mul_i32 s73, s73, 6144
    s_add_u32 s73, s73, 73728
    v_add_u32 v10, s73, v8
    s_mul_i32 s38, s30, 2341
    s_lshr_b32 s38, s38, 19
    s_add_u32 s39, s30, s32
    s_sub_u32 s39, s39, 1
    s_mul_i32 s39, s39, 2341
    s_lshr_b32 s39, s39, 19
    v_mov_b32 v12, s38
    v_mov_b32 v13, s39
    v_cmp_gt_u32 vcc, 32, v0
    s_nop 1
    v_cndmask_b32 v12, v13, v12, vcc
    v_and_b32 v13, 31, v0
    v_min_u32 v13, 26, v13
    v_lshl_add_u32 v12, v12, 5, v13
    v_lshlrev_b32 v12, 7, v12
    v_add_u32 v12, 262144, v12
    s_cmp_lg_u32 s35, 0
    s_cbranch_scc1 pd_112
    s_waitcnt vmcnt(0)
    s_mov_b32 s71, 50000
pl_113:
    buffer_load_dwordx4 v[248:251], v12, s[44:47], 0 offen sc1
    s_waitcnt vmcnt(0)
    v_xor_b32 v13, s33, v248
    v_xor_b32 v14, s33, v249
    v_or_b32 v13, v13, v14
    v_xor_b32 v14, s33, v250
    v_or_b32 v13, v13, v14
    v_xor_b32 v14, s33, v251
    v_or_b32 v13, v13, v14
    v_cmp_ne_u32 vcc, 0, v13
    s_nop 0
    s_and_b64 vcc, vcc, exec
    s_cbranch_scc0 pk_114
    s_mov_b64 exec, vcc
    s_sub_u32 s71, s71, 1
    s_cmp_lg_u32 s71, 0
    s_cbranch_scc1 pl_113
pk_114:
    s_mov_b64 exec, -1
pd_112:
    s_barrier
    s_mov_b32 s73, 0
    buffer_load_dwordx4 v[140:143], v28, s[40:43], s73 offen sc1
    buffer_load_dwordx4 v[144:147], v29, s[40:43], s73 offen sc1
    buffer_load_dwordx4 v[148:151], v30, s[40:43], s73 offen sc1
    s_mov_b32 s73, 2048
    buffer_load_dwordx4 v[152:155], v28, s[40:43], s73 offen sc1
    buffer_load_dwordx4 v[156:159], v29, s[40:43], s73 offen sc1
    buffer_load_dwordx4 v[160:163], v30, s[40:43], s73 offen sc1
    s_mov_b32 s73, 4096
    buffer_load_dwordx4 v[164:167], v28, s[40:43], s73 offen sc1
    buffer_load_dwordx4 v[168:171], v29, s[40:43], s73 offen sc1
    buffer_load_dwordx4 v[172:175], v30, s[40:43], s73 offen sc1
    s_mov_b32 s73, 6144
    buffer_load_dwordx4 v[176:179], v28, s[40:43], s73 offen sc1
    buffer_load_dwordx4 v[180:183], v29, s[40:43], s73 offen sc1
    buffer_load_dwordx4 v[184:187], v30, s[40:43], s73 offen sc1
    s_mov_b32 s73, 8192
    buffer_load_dwordx4 v[188:191], v28, s[40:43], s73 offen sc1
    buffer_load_dwordx4 v[192:195], v29, s[40:43], s73 offen sc1
    buffer_load_dwordx4 v[196:199], v30, s[40:43], s73 offen sc1
    ds_read_b64_tr_b16 v[92:93], v16 offset:0
    ds_read_b64_tr_b16 v[94:95], v16 offset:2048
    ds_read_b64_tr_b16 v[96:97], v17 offset:0
    ds_read_b64_tr_b16 v[98:99], v17 offset:2048
    ds_read_b64_tr_b16 v[100:101], v18 offset:0
    ds_read_b64_tr_b16 v[102:103], v18 offset:2048
    ds_read_b64_tr_b16 v[104:105], v19 offset:0
    ds_read_b64_tr_b16 v[106:107], v19 offset:2048
    ds_read_b64_tr_b16 v[108:109], v16 offset:8192
    ds_read_b64_tr_b16 v[110:111], v16 offset:10240
    ds_read_b64_tr_b16 v[112:113], v17 offset:8192
    ds_read_b64_tr_b16 v[114:115], v17 offset:10240
    ds_read_b64_tr_b16 v[116:117], v18 offset:8192
    ds_read_b64_tr_b16 v[118:119], v18 offset:10240
    ds_read_b64_tr_b16 v[120:121], v19 offset:8192
    ds_read_b64_tr_b16 v[122:123], v19 offset:10240
    s_waitcnt vmcnt(12) lgkmcnt(8)
    ds_read_b64_tr_b16 v[124:125], v16 offset:16384
    v_mfma_f32_16x16x32_bf16 v[32:35], v[92:95], v[140:143], 0
    ds_read_b64_tr_b16 v[126:127], v16 offset:18432
    v_mfma_f32_16x16x32_bf16 v[36:39], v[96:99], v[140:143], 0
    ds_read_b64_tr_b16 v[128:129], v17 offset:16384
    v_mfma_f32_16x16x32_bf16 v[40:43], v[100:103], v[140:143], 0
    ds_read_b64_tr_b16 v[130:131], v17 offset:18432
    v_mfma_f32_16x16x32_bf16 v[44:47], v[104:107], v[140:143], 0
    ds_read_b64_tr_b16 v[132:133], v18 offset:16384
    v_mfma_f32_16x16x32_bf16 v[48:51], v[92:95], v[144:147], 0
    ds_read_b64_tr_b16 v[134:135], v18 offset:18432
    v_mfma_f32_16x16x32_bf16 v[52:55], v[96:99], v[144:147], 0
    ds_read_b64_tr_b16 v[136:137], v19 offset:16384
    v_mfma_f32_16x16x32_bf16 v[56:59], v[100:103], v[144:147], 0
    ds_read_b64_tr_b16 v[138:139], v19 offset:18432
    v_mfma_f32_16x16x32_bf16 v[60:63], v[104:107], v[144:147], 0
    s_mov_b32 s73, 10240
    buffer_load_dwordx4 v[200:203], v28, s[40:43], s73 offen sc1
    v_mfma_f32_16x16x32_bf16 v[64:67], v[92:95], v[148:151], 0
    buffer_load_dwordx4 v[204:207], v29, s[40:43], s73 offen sc1
    v_mfma_f32_16x16x32_bf16 v[68:71], v[96:99], v[148:151], 0
    buffer_load_dwordx4 v[208:211], v30, s[40:43], s73 offen sc1
    v_mfma_f32_16x16x32_bf16 v[72:75], v[100:103], v[148:151], 0
    v_mfma_f32_16x16x32_bf16 v[76:79], v[104:107], v[148:151], 0
    s_waitcnt vmcnt(12) lgkmcnt(8)
    ds_read_b64_tr_b16 v[92:93], v16 offset:24576
    v_mfma_f32_16x16x32_bf16 v[32:35], v[108:111], v[152:155], v[32:35]
    ds_read_b64_tr_b16 v[94:95], v16 offset:26624
    v_mfma_f32_16x16x32_bf16 v[36:39], v[112:115], v[152:155], v[36:39]
    ds_read_b64_tr_b16 v[96:97], v17 offset:24576
    v_mfma_f32_16x16x32_bf16 v[40:43], v[116:119], v[152:155], v[40:43]
    ds_read_b64_tr_b16 v[98:99], v17 offset:26624
    v_mfma_f32_16x16x32_bf16 v[44:47], v[120:123], v[152:155], v[44:47]
    ds_read_b64_tr_b16 v[100:101], v18 offset:24576
    v_mfma_f32_16x16x32_bf16 v[48:51], v[108:111], v[156:159], v[48:51]
    ds_read_b64_tr_b16 v[102:103], v18 offset:26624
    v_mfma_f32_16x16x32_bf16 v[52:55], v[112:115], v[156:159], v[52:55]
    ds_read_b64_tr_b16 v[104:105], v19 offset:24576
    v_mfma_f32_16x16x32_bf16 v[56:59], v[116:119], v[156:159], v[56:59]
    ds_read_b64_tr_b16 v[106:107], v19 offset:26624
    v_mfma_f32_16x16x32_bf16 v[60:63], v[120:123], v[156:159], v[60:63]
    s_mov_b32 s73, 12288
    buffer_load_dwordx4 v[140:143], v28, s[40:43], s73 offen sc1
    v_mfma_f32_16x16x32_bf16 v[64:67], v[108:111], v[160:163], v[64:67]
    buffer_load_dwordx4 v[144:147], v29, s[40:43], s73 offen sc1
    v_mfma_f32_16x16x32_bf16 v[68:71], v[112:115], v[160:163], v[68:71]
    buffer_load_dwordx4 v[148:151], v30, s[40:43], s73 offen sc1
    v_mfma_f32_16x16x32_bf16 v[72:75], v[116:119], v[160:163], v[72:75]
    v_mfma_f32_16x16x32_bf16 v[76:79], v[120:123], v[160:163], v[76:79]
    s_waitcnt vmcnt(12) lgkmcnt(8)
    ds_read_b64_tr_b16 v[108:109], v16 offset:32768
    v_mfma_f32_16x16x32_bf16 v[32:35], v[124:127], v[164:167], v[32:35]
    ds_read_b64_tr_b16 v[110:111], v16 offset:34816
    v_mfma_f32_16x16x32_bf16 v[36:39], v[128:131], v[164:167], v[36:39]
    ds_read_b64_tr_b16 v[112:113], v17 offset:32768
    v_mfma_f32_16x16x32_bf16 v[40:43], v[132:135], v[164:167], v[40:43]
    ds_read_b64_tr_b16 v[114:115], v17 offset:34816
    v_mfma_f32_16x16x32_bf16 v[44:47], v[136:139], v[164:167], v[44:47]
    ds_read_b64_tr_b16 v[116:117], v18 offset:32768
    v_mfma_f32_16x16x32_bf16 v[48:51], v[124:127], v[168:171], v[48:51]
    ds_read_b64_tr_b16 v[118:119], v18 offset:34816
    v_mfma_f32_16x16x32_bf16 v[52:55], v[128:131], v[168:171], v[52:55]
    ds_read_b64_tr_b16 v[120:121], v19 offset:32768
    v_mfma_f32_16x16x32_bf16 v[56:59], v[132:135], v[168:171], v[56:59]
    ds_read_b64_tr_b16 v[122:123], v19 offset:34816
    v_mfma_f32_16x16x32_bf16 v[60:63], v[136:139], v[168:171], v[60:63]
    s_mov_b32 s73, 14336
    buffer_load_dwordx4 v[152:155], v28, s[40:43], s73 offen sc1
    v_mfma_f32_16x16x32_bf16 v[64:67], v[124:127], v[172:175], v[64:67]
    buffer_load_dwordx4 v[156:159], v29, s[40:43], s73 offen sc1
    v_mfma_f32_16x16x32_bf16 v[68:71], v[128:131], v[172:175], v[68:71]
    buffer_load_dwordx4 v[160:163], v30, s[40:43], s73 offen sc1
    v_mfma_f32_16x16x32_bf16 v[72:75], v[132:135], v[172:175], v[72:75]
    v_mfma_f32_16x16x32_bf16 v[76:79], v[136:139], v[172:175], v[76:79]
    s_waitcnt vmcnt(12) lgkmcnt(8)
    ds_read_b64_tr_b16 v[124:125], v16 offset:40960
    v_mfma_f32_16x16x32_bf16 v[32:35], v[92:95], v[176:179], v[32:35]
    ds_read_b64_tr_b16 v[126:127], v16 offset:43008
    v_mfma_f32_16x16x32_bf16 v[36:39], v[96:99], v[176:179], v[36:39]
    ds_read_b64_tr_b16 v[128:129], v17 offset:40960
    v_mfma_f32_16x16x32_bf16 v[40:43], v[100:103], v[176:179], v[40:43]
    ds_read_b64_tr_b16 v[130:131], v17 offset:43008
    v_mfma_f32_16x16x32_bf16 v[44:47], v[104:107], v[176:179], v[44:47]
    ds_read_b64_tr_b16 v[132:133], v18 offset:40960
    v_mfma_f32_16x16x32_bf16 v[48:51], v[92:95], v[180:183], v[48:51]
    ds_read_b64_tr_b16 v[134:135], v18 offset:43008
    v_mfma_f32_16x16x32_bf16 v[52:55], v[96:99], v[180:183], v[52:55]
    ds_read_b64_tr_b16 v[136:137], v19 offset:40960
    v_mfma_f32_16x16x32_bf16 v[56:59], v[100:103], v[180:183], v[56:59]
    ds_read_b64_tr_b16 v[138:139], v19 offset:43008
    v_mfma_f32_16x16x32_bf16 v[60:63], v[104:107], v[180:183], v[60:63]
    s_mov_b32 s73, 16384
    buffer_load_dwordx4 v[164:167], v28, s[40:43], s73 offen sc1
    v_mfma_f32_16x16x32_bf16 v[64:67], v[92:95], v[184:187], v[64:67]
    buffer_load_dwordx4 v[168:171], v29, s[40:43], s73 offen sc1
    v_mfma_f32_16x16x32_bf16 v[68:71], v[96:99], v[184:187], v[68:71]
    buffer_load_dwordx4 v[172:175], v30, s[40:43], s73 offen sc1
    v_mfma_f32_16x16x32_bf16 v[72:75], v[100:103], v[184:187], v[72:75]
    v_mfma_f32_16x16x32_bf16 v[76:79], v[104:107], v[184:187], v[76:79]
    s_waitcnt vmcnt(12) lgkmcnt(8)
    ds_read_b64_tr_b16 v[92:93], v16 offset:49152
    v_mfma_f32_16x16x32_bf16 v[32:35], v[108:111], v[188:191], v[32:35]
    ds_read_b64_tr_b16 v[94:95], v16 offset:51200
    v_mfma_f32_16x16x32_bf16 v[36:39], v[112:115], v[188:191], v[36:39]
    ds_read_b64_tr_b16 v[96:97], v17 offset:49152
    v_mfma_f32_16x16x32_bf16 v[40:43], v[116:119], v[188:191], v[40:43]
    ds_read_b64_tr_b16 v[98:99], v17 offset:51200
    v_mfma_f32_16x16x32_bf16 v[44:47], v[120:123], v[188:191], v[44:47]
    ds_read_b64_tr_b16 v[100:101], v18 offset:49152
    v_mfma_f32_16x16x32_bf16 v[48:51], v[108:111], v[192:195], v[48:51]
    ds_read_b64_tr_b16 v[102:103], v18 offset:51200
    v_mfma_f32_16x16x32_bf16 v[52:55], v[112:115], v[192:195], v[52:55]
    ds_read_b64_tr_b16 v[104:105], v19 offset:49152
    v_mfma_f32_16x16x32_bf16 v[56:59], v[116:119], v[192:195], v[56:59]
    ds_read_b64_tr_b16 v[106:107], v19 offset:51200
    v_mfma_f32_16x16x32_bf16 v[60:63], v[120:123], v[192:195], v[60:63]
    s_mov_b32 s73, 18432
    buffer_load_dwordx4 v[176:179], v28, s[40:43], s73 offen sc1
    v_mfma_f32_16x16x32_bf16 v[64:67], v[108:111], v[196:199], v[64:67]
    buffer_load_dwordx4 v[180:183], v29, s[40:43], s73 offen sc1
    v_mfma_f32_16x16x32_bf16 v[68:71], v[112:115], v[196:199], v[68:71]
    buffer_load_dwordx4 v[184:187], v30, s[40:43], s73 offen sc1
    v_mfma_f32_16x16x32_bf16 v[72:75], v[116:119], v[196:199], v[72:75]
    v_mfma_f32_16x16x32_bf16 v[76:79], v[120:123], v[196:199], v[76:79]
    s_waitcnt vmcnt(12) lgkmcnt(8)
    ds_read_b64_tr_b16 v[108:109], v20 offset:0
    v_mfma_f32_16x16x32_bf16 v[32:35], v[124:127], v[200:203], v[32:35]
    ds_read_b64_tr_b16 v[110:111], v20 offset:2048
    v_mfma_f32_16x16x32_bf16 v[36:39], v[128:131], v[200:203], v[36:39]
    ds_read_b64_tr_b16 v[112:113], v21 offset:0
    v_mfma_f32_16x16x32_bf16 v[40:43], v[132:135], v[200:203], v[40:43]
    ds_read_b64_tr_b16 v[114:115], v21 offset:2048
    v_mfma_f32_16x16x32_bf16 v[44:47], v[136:139], v[200:203], v[44:47]
    ds_read_b64_tr_b16 v[116:117], v22 offset:0
    v_mfma_f32_16x16x32_bf16 v[48:51], v[124:127], v[204:207], v[48:51]
    ds_read_b64_tr_b16 v[118:119], v22 offset:2048
    v_mfma_f32_16x16x32_bf16 v[52:55], v[128:131], v[204:207], v[52:55]
    ds_read_b64_tr_b16 v[120:121], v23 offset:0
    v_mfma_f32_16x16x32_bf16 v[56:59], v[132:135], v[204:207], v[56:59]
    ds_read_b64_tr_b16 v[122:123], v23 offset:2048
    v_mfma_f32_16x16x32_bf16 v[60:63], v[136:139], v[204:207], v[60:63]
    s_mov_b32 s73, 20480
    buffer_load_dwordx4 v[188:191], v28, s[40:43], s73 offen sc1
    v_mfma_f32_16x16x32_bf16 v[64:67], v[124:127], v[208:211], v[64:67]
    buffer_load_dwordx4 v[192:195], v29, s[40:43], s73 offen sc1
    v_mfma_f32_16x16x32_bf16 v[68:71], v[128:131], v[208:211], v[68:71]
    buffer_load_dwordx4 v[196:199], v30, s[40:43], s73 offen sc1
    v_mfma_f32_16x16x32_bf16 v[72:75], v[132:135], v[208:211], v[72:75]
    v_mfma_f32_16x16x32_bf16 v[76:79], v[136:139], v[208:211], v[76:79]
    s_waitcnt vmcnt(12) lgkmcnt(8)
    ds_read_b64_tr_b16 v[124:125], v20 offset:8192
    v_mfma_f32_16x16x32_bf16 v[32:35], v[92:95], v[140:143], v[32:35]
    ds_read_b64_tr_b16 v[126:127], v20 offset:10240
    v_mfma_f32_16x16x32_bf16 v[36:39], v[96:99], v[140:143], v[36:39]
    ds_read_b64_tr_b16 v[128:129], v21 offset:8192
    v_mfma_f32_16x16x32_bf16 v[40:43], v[100:103], v[140:143], v[40:43]
    ds_read_b64_tr_b16 v[130:131], v21 offset:10240
    v_mfma_f32_16x16x32_bf16 v[44:47], v[104:107], v[140:143], v[44:47]
    ds_read_b64_tr_b16 v[132:133], v22 offset:8192
    v_mfma_f32_16x16x32_bf16 v[48:51], v[92:95], v[144:147], v[48:51]
    ds_read_b64_tr_b16 v[134:135], v22 offset:10240
    v_mfma_f32_16x16x32_bf16 v[52:55], v[96:99], v[144:147], v[52:55]
    ds_read_b64_tr_b16 v[136:137], v23 offset:8192
    v_mfma_f32_16x16x32_bf16 v[56:59], v[100:103], v[144:147], v[56:59]
    ds_read_b64_tr_b16 v[138:139], v23 offset:10240
    v_mfma_f32_16x16x32_bf16 v[60:63], v[104:107], v[144:147], v[60:63]
    s_mov_b32 s73, 22528
    buffer_load_dwordx4 v[200:203], v28, s[40:43], s73 offen sc1
    v_mfma_f32_16x16x32_bf16 v[64:67], v[92:95], v[148:151], v[64:67]
    buffer_load_dwordx4 v[204:207], v29, s[40:43], s73 offen sc1
    v_mfma_f32_16x16x32_bf16 v[68:71], v[96:99], v[148:151], v[68:71]
    buffer_load_dwordx4 v[208:211], v30, s[40:43], s73 offen sc1
    v_mfma_f32_16x16x32_bf16 v[72:75], v[100:103], v[148:151], v[72:75]
    v_mfma_f32_16x16x32_bf16 v[76:79], v[104:107], v[148:151], v[76:79]
    s_waitcnt vmcnt(12) lgkmcnt(8)
    ds_read_b64_tr_b16 v[92:93], v20 offset:16384
    v_mfma_f32_16x16x32_bf16 v[32:35], v[108:111], v[152:155], v[32:35]
    ds_read_b64_tr_b16 v[94:95], v20 offset:18432
    v_mfma_f32_16x16x32_bf16 v[36:39], v[112:115], v[152:155], v[36:39]
    ds_read_b64_tr_b16 v[96:97], v21 offset:16384
    v_mfma_f32_16x16x32_bf16 v[40:43], v[116:119], v[152:155], v[40:43]
    ds_read_b64_tr_b16 v[98:99], v21 offset:18432
    v_mfma_f32_16x16x32_bf16 v[44:47], v[120:123], v[152:155], v[44:47]
    ds_read_b64_tr_b16 v[100:101], v22 offset:16384
    v_mfma_f32_16x16x32_bf16 v[48:51], v[108:111], v[156:159], v[48:51]
    ds_read_b64_tr_b16 v[102:103], v22 offset:18432
    v_mfma_f32_16x16x32_bf16 v[52:55], v[112:115], v[156:159], v[52:55]
    ds_read_b64_tr_b16 v[104:105], v23 offset:16384
    v_mfma_f32_16x16x32_bf16 v[56:59], v[116:119], v[156:159], v[56:59]
    ds_read_b64_tr_b16 v[106:107], v23 offset:18432
    v_mfma_f32_16x16x32_bf16 v[60:63], v[120:123], v[156:159], v[60:63]
    s_mov_b32 s73, 24576
    buffer_load_dwordx4 v[140:143], v28, s[40:43], s73 offen sc1
    v_mfma_f32_16x16x32_bf16 v[64:67], v[108:111], v[160:163], v[64:67]
    buffer_load_dwordx4 v[144:147], v29, s[40:43], s73 offen sc1
    v_mfma_f32_16x16x32_bf16 v[68:71], v[112:115], v[160:163], v[68:71]
    buffer_load_dwordx4 v[148:151], v30, s[40:43], s73 offen sc1
    v_mfma_f32_16x16x32_bf16 v[72:75], v[116:119], v[160:163], v[72:75]
    v_mfma_f32_16x16x32_bf16 v[76:79], v[120:123], v[160:163], v[76:79]
    s_waitcnt vmcnt(12) lgkmcnt(8)
    s_barrier
    ds_read_b64_tr_b16 v[108:109], v20 offset:24576
    v_mfma_f32_16x16x32_bf16 v[32:35], v[124:127], v[164:167], v[32:35]
    ds_read_b64_tr_b16 v[110:111], v20 offset:26624
    v_mfma_f32_16x16x32_bf16 v[36:39], v[128:131], v[164:167], v[36:39]
    ds_read_b64_tr_b16 v[112:113], v21 offset:24576
    v_mfma_f32_16x16x32_bf16 v[40:43], v[132:135], v[164:167], v[40:43]
    ds_read_b64_tr_b16 v[114:115], v21 offset:26624
    v_mfma_f32_16x16x32_bf16 v[44:47], v[136:139], v[164:167], v[44:47]
    ds_read_b64_tr_b16 v[116:117], v22 offset:24576
    v_mfma_f32_16x16x32_bf16 v[48:51], v[124:127], v[168:171], v[48:51]
    ds_read_b64_tr_b16 v[118:119], v22 offset:26624
    v_mfma_f32_16x16x32_bf16 v[52:55], v[128:131], v[168:171], v[52:55]
    ds_read_b64_tr_b16 v[120:121], v23 offset:24576
    v_mfma_f32_16x16x32_bf16 v[56:59], v[132:135], v[168:171], v[56:59]
    ds_read_b64_tr_b16 v[122:123], v23 offset:26624
    v_mfma_f32_16x16x32_bf16 v[60:63], v[136:139], v[168:171], v[60:63]
    s_mov_b32 s73, 26624
    buffer_load_dwordx4 v[152:155], v28, s[40:43], s73 offen sc1
    v_mfma_f32_16x16x32_bf16 v[64:67], v[124:127], v[172:175], v[64:67]
    buffer_load_dwordx4 v[156:159], v29, s[40:43], s73 offen sc1
    v_mfma_f32_16x16x32_bf16 v[68:71], v[128:131], v[172:175], v[68:71]
    buffer_load_dwordx4 v[160:163], v30, s[40:43], s73 offen sc1
    v_mfma_f32_16x16x32_bf16 v[72:75], v[132:135], v[172:175], v[72:75]
    v_mfma_f32_16x16x32_bf16 v[76:79], v[136:139], v[172:175], v[76:79]
    s_waitcnt vmcnt(12) lgkmcnt(8)
    ds_read_b64_tr_b16 v[124:125], v20 offset:32768
    v_mfma_f32_16x16x32_bf16 v[32:35], v[92:95], v[176:179], v[32:35]
    ds_read_b64_tr_b16 v[126:127], v20 offset:34816
    v_mfma_f32_16x16x32_bf16 v[36:39], v[96:99], v[176:179], v[36:39]
    ds_read_b64_tr_b16 v[128:129], v21 offset:32768
    v_mfma_f32_16x16x32_bf16 v[40:43], v[100:103], v[176:179], v[40:43]
    ds_read_b64_tr_b16 v[130:131], v21 offset:34816
    v_mfma_f32_16x16x32_bf16 v[44:47], v[104:107], v[176:179], v[44:47]
    ds_read_b64_tr_b16 v[132:133], v22 offset:32768
    v_mfma_f32_16x16x32_bf16 v[48:51], v[92:95], v[180:183], v[48:51]
    ds_read_b64_tr_b16 v[134:135], v22 offset:34816
    v_mfma_f32_16x16x32_bf16 v[52:55], v[96:99], v[180:183], v[52:55]
    ds_read_b64_tr_b16 v[136:137], v23 offset:32768
    v_mfma_f32_16x16x32_bf16 v[56:59], v[100:103], v[180:183], v[56:59]
    ds_read_b64_tr_b16 v[138:139], v23 offset:34816
    v_mfma_f32_16x16x32_bf16 v[60:63], v[104:107], v[180:183], v[60:63]
    s_mov_b32 s73, 28672
    buffer_load_dwordx4 v[164:167], v28, s[40:43], s73 offen sc1
    v_mfma_f32_16x16x32_bf16 v[64:67], v[92:95], v[184:187], v[64:67]
    buffer_load_dwordx4 v[168:171], v29, s[40:43], s73 offen sc1
    v_mfma_f32_16x16x32_bf16 v[68:71], v[96:99], v[184:187], v[68:71]
    buffer_load_dwordx4 v[172:175], v30, s[40:43], s73 offen sc1
    v_mfma_f32_16x16x32_bf16 v[72:75], v[100:103], v[184:187], v[72:75]
    v_mfma_f32_16x16x32_bf16 v[76:79], v[104:107], v[184:187], v[76:79]
    s_waitcnt vmcnt(12) lgkmcnt(8)
    ds_read_b64_tr_b16 v[92:93], v20 offset:40960
    v_mfma_f32_16x16x32_bf16 v[32:35], v[108:111], v[188:191], v[32:35]
    ds_read_b64_tr_b16 v[94:95], v20 offset:43008
    v_mfma_f32_16x16x32_bf16 v[36:39], v[112:115], v[188:191], v[36:39]
    ds_read_b64_tr_b16 v[96:97], v21 offset:40960
    v_mfma_f32_16x16x32_bf16 v[40:43], v[116:119], v[188:191], v[40:43]
    ds_read_b64_tr_b16 v[98:99], v21 offset:43008
    v_mfma_f32_16x16x32_bf16 v[44:47], v[120:123], v[188:191], v[44:47]
    ds_read_b64_tr_b16 v[100:101], v22 offset:40960
    v_mfma_f32_16x16x32_bf16 v[48:51], v[108:111], v[192:195], v[48:51]
    ds_read_b64_tr_b16 v[102:103], v22 offset:43008
    v_mfma_f32_16x16x32_bf16 v[52:55], v[112:115], v[192:195], v[52:55]
    ds_read_b64_tr_b16 v[104:105], v23 offset:40960
    v_mfma_f32_16x16x32_bf16 v[56:59], v[116:119], v[192:195], v[56:59]
    ds_read_b64_tr_b16 v[106:107], v23 offset:43008
    v_mfma_f32_16x16x32_bf16 v[60:63], v[120:123], v[192:195], v[60:63]
    s_mov_b32 s73, 30720
    buffer_load_dwordx4 v[176:179], v28, s[40:43], s73 offen sc1
    v_mfma_f32_16x16x32_bf16 v[64:67], v[108:111], v[196:199], v[64:67]
    buffer_load_dwordx4 v[180:183], v29, s[40:43], s73 offen sc1
    v_mfma_f32_16x16x32_bf16 v[68:71], v[112:115], v[196:199], v[68:71]
    buffer_load_dwordx4 v[184:187], v30, s[40:43], s73 offen sc1
    v_mfma_f32_16x16x32_bf16 v[72:75], v[116:119], v[196:199], v[72:75]
    v_mfma_f32_16x16x32_bf16 v[76:79], v[120:123], v[196:199], v[76:79]
    s_waitcnt vmcnt(12) lgkmcnt(8)
    ds_read_b64_tr_b16 v[108:109], v20 offset:49152
    v_mfma_f32_16x16x32_bf16 v[32:35], v[124:127], v[200:203], v[32:35]
    ds_read_b64_tr_b16 v[110:111], v20 offset:51200
    v_mfma_f32_16x16x32_bf16 v[36:39], v[128:131], v[200:203], v[36:39]
    ds_read_b64_tr_b16 v[112:113], v21 offset:49152
    v_mfma_f32_16x16x32_bf16 v[40:43], v[132:135], v[200:203], v[40:43]
    ds_read_b64_tr_b16 v[114:115], v21 offset:51200
    v_mfma_f32_16x16x32_bf16 v[44:47], v[136:139], v[200:203], v[44:47]
    ds_read_b64_tr_b16 v[116:117], v22 offset:49152
    v_mfma_f32_16x16x32_bf16 v[48:51], v[124:127], v[204:207], v[48:51]
    ds_read_b64_tr_b16 v[118:119], v22 offset:51200
    v_mfma_f32_16x16x32_bf16 v[52:55], v[128:131], v[204:207], v[52:55]
    ds_read_b64_tr_b16 v[120:121], v23 offset:49152
    v_mfma_f32_16x16x32_bf16 v[56:59], v[132:135], v[204:207], v[56:59]
    ds_read_b64_tr_b16 v[122:123], v23 offset:51200
    v_mfma_f32_16x16x32_bf16 v[60:63], v[136:139], v[204:207], v[60:63]
    s_mov_b32 s73, 32768
    buffer_load_dwordx4 v[188:191], v28, s[40:43], s73 offen sc1
    v_mfma_f32_16x16x32_bf16 v[64:67], v[124:127], v[208:211], v[64:67]
    buffer_load_dwordx4 v[192:195], v29, s[40:43], s73 offen sc1
    v_mfma_f32_16x16x32_bf16 v[68:71], v[128:131], v[208:211], v[68:71]
    buffer_load_dwordx4 v[196:199], v30, s[40:43], s73 offen sc1
    v_mfma_f32_16x16x32_bf16 v[72:75], v[132:135], v[208:211], v[72:75]
    v_mfma_f32_16x16x32_bf16 v[76:79], v[136:139], v[208:211], v[76:79]
    s_waitcnt vmcnt(12) lgkmcnt(8)
    ds_read_b64_tr_b16 v[124:125], v24 offset:0
    v_mfma_f32_16x16x32_bf16 v[32:35], v[92:95], v[140:143], v[32:35]
    ds_read_b64_tr_b16 v[126:127], v24 offset:2048
    v_mfma_f32_16x16x32_bf16 v[36:39], v[96:99], v[140:143], v[36:39]
    ds_read_b64_tr_b16 v[128:129], v25 offset:0
    v_mfma_f32_16x16x32_bf16 v[40:43], v[100:103], v[140:143], v[40:43]
    ds_read_b64_tr_b16 v[130:131], v25 offset:2048
    v_mfma_f32_16x16x32_bf16 v[44:47], v[104:107], v[140:143], v[44:47]
    ds_read_b64_tr_b16 v[132:133], v26 offset:0
    v_mfma_f32_16x16x32_bf16 v[48:51], v[92:95], v[144:147], v[48:51]
    ds_read_b64_tr_b16 v[134:135], v26 offset:2048
    v_mfma_f32_16x16x32_bf16 v[52:55], v[96:99], v[144:147], v[52:55]
    ds_read_b64_tr_b16 v[136:137], v27 offset:0
    v_mfma_f32_16x16x32_bf16 v[56:59], v[100:103], v[144:147], v[56:59]
    ds_read_b64_tr_b16 v[138:139], v27 offset:2048
    v_mfma_f32_16x16x32_bf16 v[60:63], v[104:107], v[144:147], v[60:63]
    s_mov_b32 s73, 34816
    buffer_load_dwordx4 v[200:203], v28, s[40:43], s73 offen sc1
    v_mfma_f32_16x16x32_bf16 v[64:67], v[92:95], v[148:151], v[64:67]
    buffer_load_dwordx4 v[204:207], v29, s[40:43], s73 offen sc1
    v_mfma_f32_16x16x32_bf16 v[68:71], v[96:99], v[148:151], v[68:71]
    buffer_load_dwordx4 v[208:211], v30, s[40:43], s73 offen sc1
    v_mfma_f32_16x16x32_bf16 v[72:75], v[100:103], v[148:151], v[72:75]
    v_mfma_f32_16x16x32_bf16 v[76:79], v[104:107], v[148:151], v[76:79]
    s_waitcnt vmcnt(12) lgkmcnt(8)
    ds_read_b64_tr_b16 v[92:93], v24 offset:8192
    v_mfma_f32_16x16x32_bf16 v[32:35], v[108:111], v[152:155], v[32:35]
    ds_read_b64_tr_b16 v[94:95], v24 offset:10240
    v_mfma_f32_16x16x32_bf16 v[36:39], v[112:115], v[152:155], v[36:39]
    ds_read_b64_tr_b16 v[96:97], v25 offset:8192
    v_mfma_f32_16x16x32_bf16 v[40:43], v[116:119], v[152:155], v[40:43]
    ds_read_b64_tr_b16 v[98:99], v25 offset:10240
    v_mfma_f32_16x16x32_bf16 v[44:47], v[120:123], v[152:155], v[44:47]
    ds_read_b64_tr_b16 v[100:101], v26 offset:8192
    v_mfma_f32_16x16x32_bf16 v[48:51], v[108:111], v[156:159], v[48:51]
    ds_read_b64_tr_b16 v[102:103], v26 offset:10240
    v_mfma_f32_16x16x32_bf16 v[52:55], v[112:115], v[156:159], v[52:55]
    ds_read_b64_tr_b16 v[104:105], v27 offset:8192
    v_mfma_f32_16x16x32_bf16 v[56:59], v[116:119], v[156:159], v[56:59]
    ds_read_b64_tr_b16 v[106:107], v27 offset:10240
    v_mfma_f32_16x16x32_bf16 v[60:63], v[120:123], v[156:159], v[60:63]
    s_mov_b32 s73, 36864
    buffer_load_dwordx4 v[140:143], v28, s[40:43], s73 offen sc1
    v_mfma_f32_16x16x32_bf16 v[64:67], v[108:111], v[160:163], v[64:67]
    buffer_load_dwordx4 v[144:147], v29, s[40:43], s73 offen sc1
    v_mfma_f32_16x16x32_bf16 v[68:71], v[112:115], v[160:163], v[68:71]
    buffer_load_dwordx4 v[148:151], v30, s[40:43], s73 offen sc1
    v_mfma_f32_16x16x32_bf16 v[72:75], v[116:119], v[160:163], v[72:75]
    v_mfma_f32_16x16x32_bf16 v[76:79], v[120:123], v[160:163], v[76:79]
    s_waitcnt vmcnt(12) lgkmcnt(8)
    ds_read_b64_tr_b16 v[108:109], v24 offset:16384
    v_mfma_f32_16x16x32_bf16 v[32:35], v[124:127], v[164:167], v[32:35]
    ds_read_b64_tr_b16 v[110:111], v24 offset:18432
    v_mfma_f32_16x16x32_bf16 v[36:39], v[128:131], v[164:167], v[36:39]
    ds_read_b64_tr_b16 v[112:113], v25 offset:16384
    v_mfma_f32_16x16x32_bf16 v[40:43], v[132:135], v[164:167], v[40:43]
    ds_read_b64_tr_b16 v[114:115], v25 offset:18432
    v_mfma_f32_16x16x32_bf16 v[44:47], v[136:139], v[164:167], v[44:47]
    ds_read_b64_tr_b16 v[116:117], v26 offset:16384
    v_mfma_f32_16x16x32_bf16 v[48:51], v[124:127], v[168:171], v[48:51]
    ds_read_b64_tr_b16 v[118:119], v26 offset:18432
    v_mfma_f32_16x16x32_bf16 v[52:55], v[128:131], v[168:171], v[52:55]
    ds_read_b64_tr_b16 v[120:121], v27 offset:16384
    v_mfma_f32_16x16x32_bf16 v[56:59], v[132:135], v[168:171], v[56:59]
    ds_read_b64_tr_b16 v[122:123], v27 offset:18432
    v_mfma_f32_16x16x32_bf16 v[60:63], v[136:139], v[168:171], v[60:63]
    s_mov_b32 s73, 38912
    buffer_load_dwordx4 v[152:155], v28, s[40:43], s73 offen sc1
    v_mfma_f32_16x16x32_bf16 v[64:67], v[124:127], v[172:175], v[64:67]
    buffer_load_dwordx4 v[156:159], v29, s[40:43], s73 offen sc1
    v_mfma_f32_16x16x32_bf16 v[68:71], v[128:131], v[172:175], v[68:71]
    buffer_load_dwordx4 v[160:163], v30, s[40:43], s73 offen sc1
    v_mfma_f32_16x16x32_bf16 v[72:75], v[132:135], v[172:175], v[72:75]
    v_mfma_f32_16x16x32_bf16 v[76:79], v[136:139], v[172:175], v[76:79]
    s_waitcnt vmcnt(12) lgkmcnt(8)
    ds_read_b64_tr_b16 v[124:125], v24 offset:24576
    v_mfma_f32_16x16x32_bf16 v[32:35], v[92:95], v[176:179], v[32:35]
    ds_read_b64_tr_b16 v[126:127], v24 offset:26624
    v_mfma_f32_16x16x32_bf16 v[36:39], v[96:99], v[176:179], v[36:39]
    ds_read_b64_tr_b16 v[128:129], v25 offset:24576
    v_mfma_f32_16x16x32_bf16 v[40:43], v[100:103], v[176:179], v[40:43]
    ds_read_b64_tr_b16 v[130:131], v25 offset:26624
    v_mfma_f32_16x16x32_bf16 v[44:47], v[104:107], v[176:179], v[44:47]
    ds_read_b64_tr_b16 v[132:133], v26 offset:24576
    v_mfma_f32_16x16x32_bf16 v[48:51], v[92:95], v[180:183], v[48:51]
    ds_read_b64_tr_b16 v[134:135], v26 offset:26624
    v_mfma_f32_16x16x32_bf16 v[52:55], v[96:99], v[180:183], v[52:55]
    ds_read_b64_tr_b16 v[136:137], v27 offset:24576
    v_mfma_f32_16x16x32_bf16 v[56:59], v[100:103], v[180:183], v[56:59]
    ds_read_b64_tr_b16 v[138:139], v27 offset:26624
    v_mfma_f32_16x16x32_bf16 v[60:63], v[104:107], v[180:183], v[60:63]
    s_mov_b32 s73, 40960
    buffer_load_dwordx4 v[164:167], v28, s[40:43], s73 offen sc1
    v_mfma_f32_16x16x32_bf16 v[64:67], v[92:95], v[184:187], v[64:67]
    buffer_load_dwordx4 v[168:171], v29, s[40:43], s73 offen sc1
    v_mfma_f32_16x16x32_bf16 v[68:71], v[96:99], v[184:187], v[68:71]
    buffer_load_dwordx4 v[172:175], v30, s[40:43], s73 offen sc1
    v_mfma_f32_16x16x32_bf16 v[72:75], v[100:103], v[184:187], v[72:75]
    v_mfma_f32_16x16x32_bf16 v[76:79], v[104:107], v[184:187], v[76:79]
    s_barrier
    s_waitcnt vmcnt(12) lgkmcnt(8)
    ds_read_b64_tr_b16 v[92:93], v16 offset:0
    v_mfma_f32_16x16x32_bf16 v[32:35], v[108:111], v[188:191], v[32:35]
    ds_read_b64_tr_b16 v[94:95], v16 offset:2048
    v_mfma_f32_16x16x32_bf16 v[36:39], v[112:115], v[188:191], v[36:39]
    ds_read_b64_tr_b16 v[96:97], v17 offset:0
    v_mfma_f32_16x16x32_bf16 v[40:43], v[116:119], v[188:191], v[40:43]
    ds_read_b64_tr_b16 v[98:99], v17 offset:2048
    v_mfma_f32_16x16x32_bf16 v[44:47], v[120:123], v[188:191], v[44:47]
    ds_read_b64_tr_b16 v[100:101], v18 offset:0
    v_mfma_f32_16x16x32_bf16 v[48:51], v[108:111], v[192:195], v[48:51]
    ds_read_b64_tr_b16 v[102:103], v18 offset:2048
    v_mfma_f32_16x16x32_bf16 v[52:55], v[112:115], v[192:195], v[52:55]
    ds_read_b64_tr_b16 v[104:105], v19 offset:0
    v_mfma_f32_16x16x32_bf16 v[56:59], v[116:119], v[192:195], v[56:59]
    ds_read_b64_tr_b16 v[106:107], v19 offset:2048
    v_mfma_f32_16x16x32_bf16 v[60:63], v[120:123], v[192:195], v[60:63]
    s_mov_b32 s73, 43008
    buffer_load_dwordx4 v[176:179], v28, s[40:43], s73 offen sc1
    v_mfma_f32_16x16x32_bf16 v[64:67], v[108:111], v[196:199], v[64:67]
    buffer_load_dwordx4 v[180:183], v29, s[40:43], s73 offen sc1
    v_mfma_f32_16x16x32_bf16 v[68:71], v[112:115], v[196:199], v[68:71]
    buffer_load_dwordx4 v[184:187], v30, s[40:43], s73 offen sc1
    v_mfma_f32_16x16x32_bf16 v[72:75], v[116:119], v[196:199], v[72:75]
    v_mfma_f32_16x16x32_bf16 v[76:79], v[120:123], v[196:199], v[76:79]
    s_waitcnt vmcnt(12) lgkmcnt(8)
    ds_read_b64_tr_b16 v[108:109], v16 offset:8192
    v_mfma_f32_16x16x32_bf16 v[32:35], v[124:127], v[200:203], v[32:35]
    ds_read_b64_tr_b16 v[110:111], v16 offset:10240
    v_mfma_f32_16x16x32_bf16 v[36:39], v[128:131], v[200:203], v[36:39]
    ds_read_b64_tr_b16 v[112:113], v17 offset:8192
    v_mfma_f32_16x16x32_bf16 v[40:43], v[132:135], v[200:203], v[40:43]
    ds_read_b64_tr_b16 v[114:115], v17 offset:10240
    v_mfma_f32_16x16x32_bf16 v[44:47], v[136:139], v[200:203], v[44:47]
    ds_read_b64_tr_b16 v[116:117], v18 offset:8192
    v_mfma_f32_16x16x32_bf16 v[48:51], v[124:127], v[204:207], v[48:51]
    ds_read_b64_tr_b16 v[118:119], v18 offset:10240
    v_mfma_f32_16x16x32_bf16 v[52:55], v[128:131], v[204:207], v[52:55]
    ds_read_b64_tr_b16 v[120:121], v19 offset:8192
    v_mfma_f32_16x16x32_bf16 v[56:59], v[132:135], v[204:207], v[56:59]
    ds_read_b64_tr_b16 v[122:123], v19 offset:10240
    v_mfma_f32_16x16x32_bf16 v[60:63], v[136:139], v[204:207], v[60:63]
    s_mov_b32 s73, 45056
    buffer_load_dwordx4 v[188:191], v28, s[40:43], s73 offen sc1
    v_mfma_f32_16x16x32_bf16 v[64:67], v[124:127], v[208:211], v[64:67]
    buffer_load_dwordx4 v[192:195], v29, s[40:43], s73 offen sc1
    v_mfma_f32_16x16x32_bf16 v[68:71], v[128:131], v[208:211], v[68:71]
    buffer_load_dwordx4 v[196:199], v30, s[40:43], s73 offen sc1
    v_mfma_f32_16x16x32_bf16 v[72:75], v[132:135], v[208:211], v[72:75]
    v_mfma_f32_16x16x32_bf16 v[76:79], v[136:139], v[208:211], v[76:79]
    s_waitcnt vmcnt(12) lgkmcnt(8)
    ds_read_b64_tr_b16 v[124:125], v16 offset:16384
    v_mfma_f32_16x16x32_bf16 v[32:35], v[92:95], v[140:143], v[32:35]
    ds_read_b64_tr_b16 v[126:127], v16 offset:18432
    v_mfma_f32_16x16x32_bf16 v[36:39], v[96:99], v[140:143], v[36:39]
    ds_read_b64_tr_b16 v[128:129], v17 offset:16384
    v_mfma_f32_16x16x32_bf16 v[40:43], v[100:103], v[140:143], v[40:43]
    ds_read_b64_tr_b16 v[130:131], v17 offset:18432
    v_mfma_f32_16x16x32_bf16 v[44:47], v[104:107], v[140:143], v[44:47]
    ds_read_b64_tr_b16 v[132:133], v18 offset:16384
    v_mfma_f32_16x16x32_bf16 v[48:51], v[92:95], v[144:147], v[48:51]
    ds_read_b64_tr_b16 v[134:135], v18 offset:18432
    v_mfma_f32_16x16x32_bf16 v[52:55], v[96:99], v[144:147], v[52:55]
    ds_read_b64_tr_b16 v[136:137], v19 offset:16384
    v_mfma_f32_16x16x32_bf16 v[56:59], v[100:103], v[144:147], v[56:59]
    ds_read_b64_tr_b16 v[138:139], v19 offset:18432
    v_mfma_f32_16x16x32_bf16 v[60:63], v[104:107], v[144:147], v[60:63]
    s_mov_b32 s73, 47104
    buffer_load_dwordx4 v[200:203], v28, s[40:43], s73 offen sc1
    v_mfma_f32_16x16x32_bf16 v[64:67], v[92:95], v[148:151], v[64:67]
    buffer_load_dwordx4 v[204:207], v29, s[40:43], s73 offen sc1
    v_mfma_f32_16x16x32_bf16 v[68:71], v[96:99], v[148:151], v[68:71]
    buffer_load_dwordx4 v[208:211], v30, s[40:43], s73 offen sc1
    v_mfma_f32_16x16x32_bf16 v[72:75], v[100:103], v[148:151], v[72:75]
    v_mfma_f32_16x16x32_bf16 v[76:79], v[104:107], v[148:151], v[76:79]
    s_waitcnt vmcnt(12) lgkmcnt(8)
    ds_read_b64_tr_b16 v[92:93], v16 offset:24576
    v_mfma_f32_16x16x32_bf16 v[32:35], v[108:111], v[152:155], v[32:35]
    ds_read_b64_tr_b16 v[94:95], v16 offset:26624
    v_mfma_f32_16x16x32_bf16 v[36:39], v[112:115], v[152:155], v[36:39]
    ds_read_b64_tr_b16 v[96:97], v17 offset:24576
    v_mfma_f32_16x16x32_bf16 v[40:43], v[116:119], v[152:155], v[40:43]
    ds_read_b64_tr_b16 v[98:99], v17 offset:26624
    v_mfma_f32_16x16x32_bf16 v[44:47], v[120:123], v[152:155], v[44:47]
    ds_read_b64_tr_b16 v[100:101], v18 offset:24576
    v_mfma_f32_16x16x32_bf16 v[48:51], v[108:111], v[156:159], v[48:51]
    ds_read_b64_tr_b16 v[102:103], v18 offset:26624
    v_mfma_f32_16x16x32_bf16 v[52:55], v[112:115], v[156:159], v[52:55]
    ds_read_b64_tr_b16 v[104:105], v19 offset:24576
    v_mfma_f32_16x16x32_bf16 v[56:59], v[116:119], v[156:159], v[56:59]
    ds_read_b64_tr_b16 v[106:107], v19 offset:26624
    v_mfma_f32_16x16x32_bf16 v[60:63], v[120:123], v[156:159], v[60:63]
    s_mov_b32 s73, 49152
    buffer_load_dwordx4 v[140:143], v28, s[40:43], s73 offen sc1
    v_mfma_f32_16x16x32_bf16 v[64:67], v[108:111], v[160:163], v[64:67]
    buffer_load_dwordx4 v[144:147], v29, s[40:43], s73 offen sc1
    v_mfma_f32_16x16x32_bf16 v[68:71], v[112:115], v[160:163], v[68:71]
    buffer_load_dwordx4 v[148:151], v30, s[40:43], s73 offen sc1
    v_mfma_f32_16x16x32_bf16 v[72:75], v[116:119], v[160:163], v[72:75]
    v_mfma_f32_16x16x32_bf16 v[76:79], v[120:123], v[160:163], v[76:79]
    s_waitcnt vmcnt(12) lgkmcnt(8)
    ds_read_b64_tr_b16 v[108:109], v16 offset:32768
    v_mfma_f32_16x16x32_bf16 v[32:35], v[124:127], v[164:167], v[32:35]
    ds_read_b64_tr_b16 v[110:111], v16 offset:34816
    v_mfma_f32_16x16x32_bf16 v[36:39], v[128:131], v[164:167], v[36:39]
    ds_read_b64_tr_b16 v[112:113], v17 offset:32768
    v_mfma_f32_16x16x32_bf16 v[40:43], v[132:135], v[164:167], v[40:43]
    ds_read_b64_tr_b16 v[114:115], v17 offset:34816
    v_mfma_f32_16x16x32_bf16 v[44:47], v[136:139], v[164:167], v[44:47]
    ds_read_b64_tr_b16 v[116:117], v18 offset:32768
    v_mfma_f32_16x16x32_bf16 v[48:51], v[124:127], v[168:171], v[48:51]
    ds_read_b64_tr_b16 v[118:119], v18 offset:34816
    v_mfma_f32_16x16x32_bf16 v[52:55], v[128:131], v[168:171], v[52:55]
    ds_read_b64_tr_b16 v[120:121], v19 offset:32768
    v_mfma_f32_16x16x32_bf16 v[56:59], v[132:135], v[168:171], v[56:59]
    ds_read_b64_tr_b16 v[122:123], v19 offset:34816
    v_mfma_f32_16x16x32_bf16 v[60:63], v[136:139], v[168:171], v[60:63]
    s_mov_b32 s73, 51200
    buffer_load_dwordx4 v[152:155], v28, s[40:43], s73 offen sc1
    v_mfma_f32_16x16x32_bf16 v[64:67], v[124:127], v[172:175], v[64:67]
    buffer_load_dwordx4 v[156:159], v29, s[40:43], s73 offen sc1
    v_mfma_f32_16x16x32_bf16 v[68:71], v[128:131], v[172:175], v[68:71]
    buffer_load_dwordx4 v[160:163], v30, s[40:43], s73 offen sc1
    v_mfma_f32_16x16x32_bf16 v[72:75], v[132:135], v[172:175], v[72:75]
    v_mfma_f32_16x16x32_bf16 v[76:79], v[136:139], v[172:175], v[76:79]
    s_waitcnt vmcnt(12) lgkmcnt(8)
    ds_read_b64_tr_b16 v[124:125], v16 offset:40960
    v_mfma_f32_16x16x32_bf16 v[32:35], v[92:95], v[176:179], v[32:35]
    ds_read_b64_tr_b16 v[126:127], v16 offset:43008
    v_mfma_f32_16x16x32_bf16 v[36:39], v[96:99], v[176:179], v[36:39]
    ds_read_b64_tr_b16 v[128:129], v17 offset:40960
    v_mfma_f32_16x16x32_bf16 v[40:43], v[100:103], v[176:179], v[40:43]
    ds_read_b64_tr_b16 v[130:131], v17 offset:43008
    v_mfma_f32_16x16x32_bf16 v[44:47], v[104:107], v[176:179], v[44:47]
    ds_read_b64_tr_b16 v[132:133], v18 offset:40960
    v_mfma_f32_16x16x32_bf16 v[48:51], v[92:95], v[180:183], v[48:51]
    ds_read_b64_tr_b16 v[134:135], v18 offset:43008
    v_mfma_f32_16x16x32_bf16 v[52:55], v[96:99], v[180:183], v[52:55]
    ds_read_b64_tr_b16 v[136:137], v19 offset:40960
    v_mfma_f32_16x16x32_bf16 v[56:59], v[100:103], v[180:183], v[56:59]
    ds_read_b64_tr_b16 v[138:139], v19 offset:43008
    v_mfma_f32_16x16x32_bf16 v[60:63], v[104:107], v[180:183], v[60:63]
    s_mov_b32 s73, 53248
    buffer_load_dwordx4 v[164:167], v28, s[40:43], s73 offen sc1
    v_mfma_f32_16x16x32_bf16 v[64:67], v[92:95], v[184:187], v[64:67]
    buffer_load_dwordx4 v[168:171], v29, s[40:43], s73 offen sc1
    v_mfma_f32_16x16x32_bf16 v[68:71], v[96:99], v[184:187], v[68:71]
    buffer_load_dwordx4 v[172:175], v30, s[40:43], s73 offen sc1
    v_mfma_f32_16x16x32_bf16 v[72:75], v[100:103], v[184:187], v[72:75]
    v_mfma_f32_16x16x32_bf16 v[76:79], v[104:107], v[184:187], v[76:79]
    s_waitcnt vmcnt(12) lgkmcnt(8)
    ds_read_b64_tr_b16 v[92:93], v16 offset:49152
    ds_read_b64_tr_b16 v[94:95], v16 offset:51200
    v_mfma_f32_16x16x32_bf16 v[32:35], v[108:111], v[188:191], v[32:35]
    ds_read_b64_tr_b16 v[96:97], v17 offset:49152
    ds_read_b64_tr_b16 v[98:99], v17 offset:51200
    v_mfma_f32_16x16x32_bf16 v[36:39], v[112:115], v[188:191], v[36:39]
    ds_read_b64_tr_b16 v[100:101], v18 offset:49152
    ds_read_b64_tr_b16 v[102:103], v18 offset:51200
    v_mfma_f32_16x16x32_bf16 v[40:43], v[116:119], v[188:191], v[40:43]
    ds_read_b64_tr_b16 v[104:105], v19 offset:49152
    ds_read_b64_tr_b16 v[106:107], v19 offset:51200
    v_mfma_f32_16x16x32_bf16 v[44:47], v[120:123], v[188:191], v[44:47]
    s_mov_b32 s73, 0
    buffer_load_dwordx2 v[80:81], v31, s[48:51], s73 offen sc1
    buffer_load_dwordx2 v[82:83], v31, s[48:51], s73 offen offset:512 sc1
    v_mfma_f32_16x16x32_bf16 v[48:51], v[108:111], v[192:195], v[48:51]
    s_mov_b32 s73, 20480
    buffer_load_dwordx2 v[84:85], v31, s[48:51], s73 offen sc1
    buffer_load_dwordx2 v[86:87], v31, s[48:51], s73 offen offset:512 sc1
    v_mfma_f32_16x16x32_bf16 v[52:55], v[112:115], v[192:195], v[52:55]
    s_mov_b32 s73, 40960
    buffer_load_dwordx2 v[88:89], v31, s[48:51], s73 offen sc1
    buffer_load_dwordx2 v[90:91], v31, s[48:51], s73 offen offset:512 sc1
    v_mfma_f32_16x16x32_bf16 v[56:59], v[116:119], v[192:195], v[56:59]
    v_mfma_f32_16x16x32_bf16 v[60:63], v[120:123], v[192:195], v[60:63]
    v_mfma_f32_16x16x32_bf16 v[64:67], v[108:111], v[196:199], v[64:67]
    v_mfma_f32_16x16x32_bf16 v[68:71], v[112:115], v[196:199], v[68:71]
    v_mfma_f32_16x16x32_bf16 v[72:75], v[116:119], v[196:199], v[72:75]
    v_mfma_f32_16x16x32_bf16 v[76:79], v[120:123], v[196:199], v[76:79]
    s_waitcnt vmcnt(15) lgkmcnt(8)
    ds_read_b64_tr_b16 v[108:109], v20 offset:0
    v_mfma_f32_16x16x32_bf16 v[32:35], v[124:127], v[200:203], v[32:35]
    ds_read_b64_tr_b16 v[110:111], v20 offset:2048
    v_mfma_f32_16x16x32_bf16 v[36:39], v[128:131], v[200:203], v[36:39]
    ds_read_b64_tr_b16 v[112:113], v21 offset:0
    v_mfma_f32_16x16x32_bf16 v[40:43], v[132:135], v[200:203], v[40:43]
    ds_read_b64_tr_b16 v[114:115], v21 offset:2048
    v_mfma_f32_16x16x32_bf16 v[44:47], v[136:139], v[200:203], v[44:47]
    ds_read_b64_tr_b16 v[116:117], v22 offset:0
    v_mfma_f32_16x16x32_bf16 v[48:51], v[124:127], v[204:207], v[48:51]
    ds_read_b64_tr_b16 v[118:119], v22 offset:2048
    v_mfma_f32_16x16x32_bf16 v[52:55], v[128:131], v[204:207], v[52:55]
    ds_read_b64_tr_b16 v[120:121], v23 offset:0
    v_mfma_f32_16x16x32_bf16 v[56:59], v[132:135], v[204:207], v[56:59]
    ds_read_b64_tr_b16 v[122:123], v23 offset:2048
    v_mfma_f32_16x16x32_bf16 v[60:63], v[136:139], v[204:207], v[60:63]
    v_mfma_f32_16x16x32_bf16 v[64:67], v[124:127], v[208:211], v[64:67]
    v_mfma_f32_16x16x32_bf16 v[68:71], v[128:131], v[208:211], v[68:71]
    v_mfma_f32_16x16x32_bf16 v[72:75], v[132:135], v[208:211], v[72:75]
    v_mfma_f32_16x16x32_bf16 v[76:79], v[136:139], v[208:211], v[76:79]
    s_waitcnt vmcnt(12) lgkmcnt(8)
    ds_read_b64_tr_b16 v[124:125], v20 offset:8192
    v_mfma_f32_16x16x32_bf16 v[32:35], v[92:95], v[140:143], v[32:35]
    ds_read_b64_tr_b16 v[126:127], v20 offset:10240
    v_mfma_f32_16x16x32_bf16 v[36:39], v[96:99], v[140:143], v[36:39]
    ds_read_b64_tr_b16 v[128:129], v21 offset:8192
    v_mfma_f32_16x16x32_bf16 v[40:43], v[100:103], v[140:143], v[40:43]
    ds_read_b64_tr_b16 v[130:131], v21 offset:10240
    v_mfma_f32_16x16x32_bf16 v[44:47], v[104:107], v[140:143], v[44:47]
    ds_read_b64_tr_b16 v[132:133], v22 offset:8192
    v_mfma_f32_16x16x32_bf16 v[48:51], v[92:95], v[144:147], v[48:51]
    ds_read_b64_tr_b16 v[134:135], v22 offset:10240
    v_mfma_f32_16x16x32_bf16 v[52:55], v[96:99], v[144:147], v[52:55]
    ds_read_b64_tr_b16 v[136:137], v23 offset:8192
    v_mfma_f32_16x16x32_bf16 v[56:59], v[100:103], v[144:147], v[56:59]
    ds_read_b64_tr_b16 v[138:139], v23 offset:10240
    v_mfma_f32_16x16x32_bf16 v[60:63], v[104:107], v[144:147], v[60:63]
    v_mfma_f32_16x16x32_bf16 v[64:67], v[92:95], v[148:151], v[64:67]
    v_mfma_f32_16x16x32_bf16 v[68:71], v[96:99], v[148:151], v[68:71]
    v_mfma_f32_16x16x32_bf16 v[72:75], v[100:103], v[148:151], v[72:75]
    v_mfma_f32_16x16x32_bf16 v[76:79], v[104:107], v[148:151], v[76:79]
    s_waitcnt vmcnt(9) lgkmcnt(8)
    v_mfma_f32_16x16x32_bf16 v[32:35], v[108:111], v[152:155], v[32:35]
    v_mfma_f32_16x16x32_bf16 v[36:39], v[112:115], v[152:155], v[36:39]
    v_mfma_f32_16x16x32_bf16 v[40:43], v[116:119], v[152:155], v[40:43]
    v_mfma_f32_16x16x32_bf16 v[44:47], v[120:123], v[152:155], v[44:47]
    v_mfma_f32_16x16x32_bf16 v[48:51], v[108:111], v[156:159], v[48:51]
    v_mfma_f32_16x16x32_bf16 v[52:55], v[112:115], v[156:159], v[52:55]
    v_mfma_f32_16x16x32_bf16 v[56:59], v[116:119], v[156:159], v[56:59]
    v_mfma_f32_16x16x32_bf16 v[60:63], v[120:123], v[156:159], v[60:63]
    v_mfma_f32_16x16x32_bf16 v[64:67], v[108:111], v[160:163], v[64:67]
    v_mfma_f32_16x16x32_bf16 v[68:71], v[112:115], v[160:163], v[68:71]
    v_mfma_f32_16x16x32_bf16 v[72:75], v[116:119], v[160:163], v[72:75]
    v_mfma_f32_16x16x32_bf16 v[76:79], v[120:123], v[160:163], v[76:79]
    s_waitcnt vmcnt(6) lgkmcnt(0)
    v_mfma_f32_16x16x32_bf16 v[32:35], v[124:127], v[164:167], v[32:35]
    v_mfma_f32_16x16x32_bf16 v[36:39], v[128:131], v[164:167], v[36:39]
    v_mfma_f32_16x16x32_bf16 v[40:43], v[132:135], v[164:167], v[40:43]
    v_mfma_f32_16x16x32_bf16 v[44:47], v[136:139], v[164:167], v[44:47]
    v_mfma_f32_16x16x32_bf16 v[48:51], v[124:127], v[168:171], v[48:51]
    v_mfma_f32_16x16x32_bf16 v[52:55], v[128:131], v[168:171], v[52:55]
    v_mfma_f32_16x16x32_bf16 v[56:59], v[132:135], v[168:171], v[56:59]
    v_mfma_f32_16x16x32_bf16 v[60:63], v[136:139], v[168:171], v[60:63]
    v_mfma_f32_16x16x32_bf16 v[64:67], v[124:127], v[172:175], v[64:67]
    v_mfma_f32_16x16x32_bf16 v[68:71], v[128:131], v[172:175], v[68:71]
    v_mfma_f32_16x16x32_bf16 v[72:75], v[132:135], v[172:175], v[72:75]
    v_mfma_f32_16x16x32_bf16 v[76:79], v[136:139], v[172:175], v[76:79]
    s_waitcnt vmcnt(0)
    s_cmp_eq_u32 s37, 0
    s_cbranch_scc0 kh1_115
    ds_write_b128 v9, v[40:43] offset:0
    ds_write_b128 v9, v[44:47] offset:1024
    ds_write_b128 v9, v[56:59] offset:2048
    ds_write_b128 v9, v[60:63] offset:3072
    ds_write_b128 v9, v[72:75] offset:4096
    ds_write_b128 v9, v[76:79] offset:5120
    v_lshlrev_b32 v92, 16, v80
    v_and_b32 v93, 0xffff0000, v80
    v_pk_add_f32 v[92:93], v[92:93], v[32:33]
    v_lshlrev_b32 v94, 16, v81
    v_and_b32 v95, 0xffff0000, v81
    v_pk_add_f32 v[94:95], v[94:95], v[34:35]
    v_lshlrev_b32 v96, 16, v82
    v_and_b32 v97, 0xffff0000, v82
    v_pk_add_f32 v[96:97], v[96:97], v[36:37]
    v_lshlrev_b32 v98, 16, v83
    v_and_b32 v99, 0xffff0000, v83
    v_pk_add_f32 v[98:99], v[98:99], v[38:39]
    v_lshlrev_b32 v100, 16, v84
    v_and_b32 v101, 0xffff0000, v84
    v_pk_add_f32 v[100:101], v[100:101], v[48:49]
    v_lshlrev_b32 v102, 16, v85
    v_and_b32 v103, 0xffff0000, v85
    v_pk_add_f32 v[102:103], v[102:103], v[50:51]
    v_lshlrev_b32 v104, 16, v86
    v_and_b32 v105, 0xffff0000, v86
    v_pk_add_f32 v[104:105], v[104:105], v[52:53]
    v_lshlrev_b32 v106, 16, v87
    v_and_b32 v107, 0xffff0000, v87
    v_pk_add_f32 v[106:107], v[106:107], v[54:55]
    v_lshlrev_b32 v108, 16, v88
    v_and_b32 v109, 0xffff0000, v88
    v_pk_add_f32 v[108:109], v[108:109], v[64:65]
    v_lshlrev_b32 v110, 16, v89
    v_and_b32 v111, 0xffff0000, v89
    v_pk_add_f32 v[110:111], v[110:111], v[66:67]
    v_lshlrev_b32 v112, 16, v90
    v_and_b32 v113, 0xffff0000, v90
    v_pk_add_f32 v[112:113], v[112:113], v[68:69]
    v_lshlrev_b32 v114, 16, v91
    v_and_b32 v115, 0xffff0000, v91
    v_pk_add_f32 v[114:115], v[114:115], v[70:71]
    s_branch khj_116
kh1_115:
    ds_write_b128 v9, v[32:35] offset:0
    ds_write_b128 v9, v[36:39] offset:1024
    ds_write_b128 v9, v[48:51] offset:2048
    ds_write_b128 v9, v[52:55] offset:3072
    ds_write_b128 v9, v[64:67] offset:4096
    ds_write_b128 v9, v[68:71] offset:5120
    v_lshlrev_b32 v92, 16, v80
    v_and_b32 v93, 0xffff0000, v80
    v_pk_add_f32 v[92:93], v[92:93], v[40:41]
    v_lshlrev_b32 v94, 16, v81
    v_and_b32 v95, 0xffff0000, v81
    v_pk_add_f32 v[94:95], v[94:95], v[42:43]
    v_lshlrev_b32 v96, 16, v82
    v_and_b32 v97, 0xffff0000, v82
    v_pk_add_f32 v[96:97], v[96:97], v[44:45]
    v_lshlrev_b32 v98, 16, v83
    v_and_b32 v99, 0xffff0000, v83
    v_pk_add_f32 v[98:99], v[98:99], v[46:47]
    v_lshlrev_b32 v100, 16, v84
    v_and_b32 v101, 0xffff0000, v84
    v_pk_add_f32 v[100:101], v[100:101], v[56:57]
    v_lshlrev_b32 v102, 16, v85
    v_and_b32 v103, 0xffff0000, v85
    v_pk_add_f32 v[102:103], v[102:103], v[58:59]
    v_lshlrev_b32 v104, 16, v86
    v_and_b32 v105, 0xffff0000, v86
    v_pk_add_f32 v[104:105], v[104:105], v[60:61]
    v_lshlrev_b32 v106, 16, v87
    v_and_b32 v107, 0xffff0000, v87
    v_pk_add_f32 v[106:107], v[106:107], v[62:63]
    v_lshlrev_b32 v108, 16, v88
    v_and_b32 v109, 0xffff0000, v88
    v_pk_add_f32 v[108:109], v[108:109], v[72:73]
    v_lshlrev_b32 v110, 16, v89
    v_and_b32 v111, 0xffff0000, v89
    v_pk_add_f32 v[110:111], v[110:111], v[74:75]
    v_lshlrev_b32 v112, 16, v90
    v_and_b32 v113, 0xffff0000, v90
    v_pk_add_f32 v[112:113], v[112:113], v[76:77]
    v_lshlrev_b32 v114, 16, v91
    v_and_b32 v115, 0xffff0000, v91
    v_pk_add_f32 v[114:115], v[114:115], v[78:79]
khj_116:
    s_waitcnt lgkmcnt(0)
    s_barrier
    ds_read_b128 v[140:143], v10 offset:0
    ds_read_b128 v[144:147], v10 offset:1024
    ds_read_b128 v[148:151], v10 offset:2048
    ds_read_b128 v[152:155], v10 offset:3072
    ds_read_b128 v[156:159], v10 offset:4096
    ds_read_b128 v[160:163], v10 offset:5120
    s_waitcnt lgkmcnt(4)
    v_pk_add_f32 v[92:93], v[92:93], v[140:141]
    v_pk_add_f32 v[94:95], v[94:95], v[142:143]
    v_pk_add_f32 v[96:97], v[96:97], v[144:145]
    v_pk_add_f32 v[98:99], v[98:99], v[146:147]
    v_cvt_pk_bf16_f32 v164, v92, v93
    v_cvt_pk_bf16_f32 v165, v94, v95
    v_cvt_pk_bf16_f32 v166, v96, v97
    v_cvt_pk_bf16_f32 v167, v98, v99
    s_nop 0
    v_permlane16_swap_b32 v164, v166
    v_permlane16_swap_b32 v165, v167
    buffer_store_dwordx4 v[164:167], v4, s[52:55], 0 offen sc1
    s_waitcnt lgkmcnt(2)
    v_pk_add_f32 v[100:101], v[100:101], v[148:149]
    v_pk_add_f32 v[102:103], v[102:103], v[150:151]
    v_pk_add_f32 v[104:105], v[104:105], v[152:153]
    v_pk_add_f32 v[106:107], v[106:107], v[154:155]
    v_cvt_pk_bf16_f32 v168, v100, v101
    v_cvt_pk_bf16_f32 v169, v102, v103
    v_cvt_pk_bf16_f32 v170, v104, v105
    v_cvt_pk_bf16_f32 v171, v106, v107
    s_nop 0
    v_permlane16_swap_b32 v168, v170
    v_permlane16_swap_b32 v169, v171
    buffer_store_dwordx4 v[168:171], v5, s[52:55], 0 offen sc1
    s_waitcnt lgkmcnt(0)
    v_pk_add_f32 v[108:109], v[108:109], v[156:157]
    v_pk_add_f32 v[110:111], v[110:111], v[158:159]
    v_pk_add_f32 v[112:113], v[112:113], v[160:161]
    v_pk_add_f32 v[114:115], v[114:115], v[162:163]
    v_cvt_pk_bf16_f32 v172, v108, v109
    v_cvt_pk_bf16_f32 v173, v110, v111
    v_cvt_pk_bf16_f32 v174, v112, v113
    v_cvt_pk_bf16_f32 v175, v114, v115
    s_nop 0
    v_permlane16_swap_b32 v172, v174
    v_permlane16_swap_b32 v173, v175
    buffer_store_dwordx4 v[172:175], v6, s[52:55], 0 offen sc1
cx_101:
    s_endpgm
slow_50:
    ds_read_b32 v19, v17 offset:60
    s_waitcnt lgkmcnt(0)
    v_readfirstlane_b32 s70, v19
    s_nop 0
    s_cmp_eq_u32 s70, 16843009
    s_cbranch_scc1 back_51
    s_sleep 1
    s_branch slow_50
slow_52:
    ds_read_b32 v19, v17 offset:0
    s_waitcnt lgkmcnt(0)
    v_readfirstlane_b32 s70, v19
    s_nop 0
    s_cmp_eq_u32 s70, 16843009
    s_cbranch_scc1 back_53
    s_sleep 1
    s_branch slow_52
slow_54:
    ds_read_b32 v19, v17 offset:4
    s_waitcnt lgkmcnt(0)
    v_readfirstlane_b32 s70, v19
    s_nop 0
    s_cmp_eq_u32 s70, 16843009
    s_cbranch_scc1 back_55
    s_sleep 1
    s_branch slow_54
slow_56:
    ds_read_b32 v19, v17 offset:8
    s_waitcnt lgkmcnt(0)
    v_readfirstlane_b32 s70, v19
    s_nop 0
    s_cmp_eq_u32 s70, 16843009
    s_cbranch_scc1 back_57
    s_sleep 1
    s_branch slow_56
slow_58:
    ds_read_b32 v19, v17 offset:12
    s_waitcnt lgkmcnt(0)
    v_readfirstlane_b32 s70, v19
    s_nop 0
    s_cmp_eq_u32 s70, 16843009
    s_cbranch_scc1 back_59
    s_sleep 1
    s_branch slow_58
slow_60:
    ds_read_b32 v19, v17 offset:16
    s_waitcnt lgkmcnt(0)
    v_readfirstlane_b32 s70, v19
    s_nop 0
    s_cmp_eq_u32 s70, 16843009
    s_cbranch_scc1 back_61
    s_sleep 1
    s_branch slow_60
slow_62:
    ds_read_b32 v19, v17 offset:132
    s_waitcnt lgkmcnt(0)
    v_readfirstlane_b32 s70, v19
    s_nop 0
    s_cmp_eq_u32 s70, 16843009
    s_cbranch_scc1 back_63
    s_sleep 0
    s_branch slow_62
slow_64:
    ds_read_b32 v19, v17 offset:20
    s_waitcnt lgkmcnt(0)
    v_readfirstlane_b32 s70, v19
    s_nop 0
    s_cmp_eq_u32 s70, 16843009
    s_cbranch_scc1 back_65
    s_sleep 1
    s_branch slow_64
slow_66:
    ds_read_b32 v19, v17 offset:24
    s_waitcnt lgkmcnt(0)
    v_readfirstlane_b32 s70, v19
    s_nop 0
    s_cmp_eq_u32 s70, 16843009
    s_cbranch_scc1 back_67
    s_sleep 1
    s_branch slow_66
slow_68:
    ds_read_b32 v19, v17 offset:28
    s_waitcnt lgkmcnt(0)
    v_readfirstlane_b32 s70, v19
    s_nop 0
    s_cmp_eq_u32 s70, 16843009
    s_cbranch_scc1 back_69
    s_sleep 1
    s_branch slow_68
slow_70:
    ds_read_b32 v19, v17 offset:32
    s_waitcnt lgkmcnt(0)
    v_readfirstlane_b32 s70, v19
    s_nop 0
    s_cmp_eq_u32 s70, 16843009
    s_cbranch_scc1 back_71
    s_sleep 1
    s_branch slow_70
slow_72:
    ds_read_b32 v19, v17 offset:36
    s_waitcnt lgkmcnt(0)
    v_readfirstlane_b32 s70, v19
    s_nop 0
    s_cmp_eq_u32 s70, 16843009
    s_cbranch_scc1 back_73
    s_sleep 1
    s_branch slow_72
slow_74:
    ds_read_b32 v19, v17 offset:140
    s_waitcnt lgkmcnt(0)
    v_readfirstlane_b32 s70, v19
    s_nop 0
    s_cmp_eq_u32 s70, 16843009
    s_cbranch_scc1 back_75
    s_sleep 0
    s_branch slow_74
slow_76:
    ds_read_b32 v19, v17 offset:40
    s_waitcnt lgkmcnt(0)
    v_readfirstlane_b32 s70, v19
    s_nop 0
    s_cmp_eq_u32 s70, 16843009
    s_cbranch_scc1 back_77
    s_sleep 1
    s_branch slow_76
slow_78:
    ds_read_b32 v19, v17 offset:44
    s_waitcnt lgkmcnt(0)
    v_readfirstlane_b32 s70, v19
    s_nop 0
    s_cmp_eq_u32 s70, 16843009
    s_cbranch_scc1 back_79
    s_sleep 1
    s_branch slow_78
slow_80:
    ds_read_b32 v19, v17 offset:48
    s_waitcnt lgkmcnt(0)
    v_readfirstlane_b32 s70, v19
    s_nop 0
    s_cmp_eq_u32 s70, 16843009
    s_cbranch_scc1 back_81
    s_sleep 1
    s_branch slow_80
slow_82:
    ds_read_b32 v19, v17 offset:52
    s_waitcnt lgkmcnt(0)
    v_readfirstlane_b32 s70, v19
    s_nop 0
    s_cmp_eq_u32 s70, 16843009
    s_cbranch_scc1 back_83
    s_sleep 1
    s_branch slow_82
slow_84:
    ds_read_b32 v19, v17 offset:56
    s_waitcnt lgkmcnt(0)
    v_readfirstlane_b32 s70, v19
    s_nop 0
    s_cmp_eq_u32 s70, 16843009
    s_cbranch_scc1 back_85
    s_sleep 1
    s_branch slow_84
slow_86:
    ds_read_b32 v19, v17 offset:144
    s_waitcnt lgkmcnt(0)
    v_readfirstlane_b32 s70, v19
    s_nop 0
    s_cmp_eq_u32 s70, 16843009
    s_cbranch_scc1 back_87
    s_sleep 0
    s_branch slow_86
slow_88:
    ds_read_b32 v19, v17 offset:152
    s_waitcnt lgkmcnt(0)
    v_readfirstlane_b32 s70, v19
    s_nop 0
    s_cmp_eq_u32 s70, 16843009
    s_cbranch_scc1 back_89
    s_sleep 0
    s_branch slow_88
slow_92:
    ds_read_b32 v19, v17 offset:156
    s_waitcnt lgkmcnt(0)
    v_readfirstlane_b32 s70, v19
    s_nop 0
    s_cmp_eq_u32 s70, 16843009
    s_cbranch_scc1 back_93
    s_sleep 0
    s_branch slow_92
code_end:
.section .rodata,"a"
.p2align 6
.amdhsa_kernel sequential_preLN__linear_kernel_hedgehog__glu_gated_geglu__prompt_kernel
  .amdhsa_next_free_vgpr 256
  .amdhsa_next_free_sgpr 80
  .amdhsa_accum_offset 256
  .amdhsa_group_segment_fixed_size 0
  .amdhsa_kernarg_size 88
  .amdhsa_user_sgpr_count 2
  .amdhsa_user_sgpr_kernarg_segment_ptr 1
  .amdhsa_system_sgpr_workgroup_id_x 1
  .amdhsa_float_denorm_mode_32 3
  .amdhsa_float_denorm_mode_16_64 3
.end_amdhsa_kernel
```
